```python
import torch

def _softmax(x, axis=-1):
    return torch.softmax(x, dim=axis)

def _gelu(x):
    return torch.nn.functional.gelu(x, approximate='tanh')

def _silu(x):
    return torch.nn.functional.silu(x)

def _sigmoid(x):
    return torch.sigmoid(x)

def _layernorm(x, axis=-1, eps=1e-05):
    m = x.mean(dim=axis, keepdim=True)
    v = x.var(dim=axis, keepdim=True, unbiased=False)
    return (x - m) / torch.sqrt(v + eps)

def _scatter_add(tgt, idx, src, axis=0):
    return tgt.clone().index_add_(axis, idx, src)

def _segment_sum(src, seg, n):
    out = torch.zeros((n,) + src.shape[1:], dtype=src.dtype)
    return out.index_add_(0, seg, src)

def _pad(x, pw):
    flat = tuple((v for pair in reversed(pw) for v in pair))
    return torch.nn.functional.pad(x, flat)
kernel_name = 'concat_heads__memory_aug_recurrent_mem_tr__linear_attn_block__prompt'

def setup_inputs():

    _w = lambda a: (lambda t: t.to(torch.bfloat16) if t.is_floating_point() else t)(torch.as_tensor(a))

    def _A_setup():
        B, S, Dm = (1, 2048, 448)
        H, Dh = (16, 256)
        M, seg = (8, 32)
        seg = min(seg, S)
        S = S // seg * seg
        return {'x': _w((lambda *s: torch.randn(*s, dtype=torch.bfloat16) * 0.05)(B, S, Dm)), 'mem0': _w((lambda *s: torch.randn(*s, dtype=torch.bfloat16) * 0.8)(B, M, Dm)), 'Wq': _w((lambda *s: torch.randn(*s, dtype=torch.bfloat16) * 1.6)(Dm, H, Dh) * Dm ** (-0.5)), 'Wk': _w((lambda *s: torch.randn(*s, dtype=torch.bfloat16) * 1.6)(Dm, H, Dh) * Dm ** (-0.5)), 'Wv': _w((lambda *s: torch.randn(*s, dtype=torch.bfloat16) * 0.8)(Dm, H, Dh) * Dm ** (-0.5)), 'Wo': _w((lambda *s: torch.randn(*s, dtype=torch.bfloat16) * 0.8)(H, Dh, Dm) * (H * Dh) ** (-0.5)), 'seg_len': seg}
    _A_in = _A_setup()

    def _B_setup():
        B, S, D = (1, 2048, 448)
        return {'x': _w((lambda *s: torch.randn(*s, dtype=torch.bfloat16) * 0.05)(B, S, D)), 'wqkv': _w((lambda *s: torch.randn(*s, dtype=torch.bfloat16) * 1.6)(D, 3 * D)), 'wo': _w((lambda *s: torch.randn(*s, dtype=torch.bfloat16) * 0.1)(D, D))}
    _B_in = _B_setup()
    return {'A_x': _A_in['x'], 'A_mem0': _A_in['mem0'], 'A_Wq': _A_in['Wq'], 'A_Wk': _A_in['Wk'], 'A_Wv': _A_in['Wv'], 'A_Wo': _A_in['Wo'], 'A_seg_len': _A_in['seg_len'], 'B_x': _B_in['x'], 'B_wqkv': _B_in['wqkv'], 'B_wo': _B_in['wo']}

def reference(A_x, A_mem0, A_Wq, A_Wk, A_Wv, A_Wo, A_seg_len, B_x, B_wqkv, B_wo):

    def _A_ref(x, mem0, Wq, Wk, Wv, Wo, seg_len):
        B, S, Dm = x.shape
        H, Dh = (Wq.shape[1], Wq.shape[2])
        M = mem0.shape[1]
        scale = Dh ** (-0.5)
        n_seg = S // seg_len
        L = M + seg_len
        idx = torch.arange(L)
        mask = (idx[:, None] < M) | (idx[:, None] >= idx[None, :])
        mem = mem0
        outs = []
        for s in range(n_seg):
            xs = x[:, s * seg_len:(s + 1) * seg_len, :].clone()
            h = torch.concatenate([mem, xs], axis=1)
            q = torch.einsum('btd,dhe->bhte', h, Wq)
            k = torch.einsum('btd,dhe->bhte', h, Wk)
            v = torch.einsum('btd,dhe->bhte', h, Wv)
            scores = torch.einsum('bhqe,bhke->bhqk', q, k) * scale
            scores = torch.where(mask[None, None], scores, -1000000000.0)
            p = _softmax(scores, axis=-1)
            o = torch.einsum('bhqk,bhke->bhqe', p, v)
            o = torch.einsum('bhte,hed->btd', o, Wo)
            mem = o[:, :M, :].clone()
            outs.append(o[:, M:, :])
        return torch.concatenate(outs, axis=1)

    def _B_ref(x, wqkv, wo):
        B, S, D = x.shape
        H = 16
        Dh = D // H
        qkv = (lambda x, *d: x.permute(*d))((x @ wqkv).reshape(B, S, 3, H, Dh), 2, 0, 3, 1, 4)
        q, k, v = (qkv[0], qkv[1], qkv[2])
        phi = lambda t: torch.where(t > 0, t + 1, torch.exp(t)) + 1e-06
        pq, pk = (phi(q), phi(k))
        kv = torch.einsum('bhsd,bhse->bhde', pk, v)
        z = torch.einsum('bhsd->bhd', pk)
        num = torch.einsum('bhqd,bhde->bhqe', pq, kv)
        den = torch.einsum('bhqd,bhd->bhq', pq, z)[..., None] + 1e-06
        o = num / den
        return (lambda x, *d: x.permute(*d))(o, 0, 2, 1, 3).reshape(B, S, D) @ wo
    a = _A_ref(A_x, A_mem0, A_Wq, A_Wk, A_Wv, A_Wo, A_seg_len)
    b = _B_ref(B_x, B_wqkv, B_wo)
    return torch.concatenate([a, b], axis=-1)
```

```asm
; @launch grid=(256,1,1) block=(256,1,1) lds=160000
.amdgcn_target "amdgcn-amd-amdhsa--gfx950"
.text
.globl concat_heads__memory_aug_recurrent_mem_tr__linear_attn_block__prompt_kernel
.p2align 8
.type concat_heads__memory_aug_recurrent_mem_tr__linear_attn_block__prompt_kernel,@function
concat_heads__memory_aug_recurrent_mem_tr__linear_attn_block__prompt_kernel:
    s_cmp_ge_u32 s2, 256
    s_cbranch_scc1 .role_none
    s_and_b32 s21, s2, 7
    s_lshr_b32 s20, s2, 3
    s_lshl_b32 s22, s21, 5
    s_add_u32 s20, s20, s22
    s_cmp_lt_u32 s20, 144
    s_cselect_b32 s22, 16, 32
    s_load_dwordx4 s[44:47], s[0:1], s22
    s_load_dwordx4 s[92:95], s[0:1], 88
    v_lshrrev_b32 v1, 6, v0
    s_getreg_b32 s10, hwreg(HW_REG_XCC_ID)
    s_mov_b32 s6, 0x10000000
    s_mov_b32 s7, 0x00020000
    v_readfirstlane_b32 s8, v1
    v_and_b32 v0, 63, v0
    v_lshlrev_b32 v9, 4, v0
    v_mov_b32 v19, 1
    v_mov_b32 v20, 1
    s_and_b32 s10, s10, 7
    s_mov_b32 s19, 0x100000
    s_cmp_lt_u32 s20, 32
    s_cbranch_scc1 .p1_fill
    s_sub_u32 s20, s20, 32
    s_mul_i32 s21, s20, 9363
    s_lshr_b32 s21, s21, 16
    s_mul_i32 s23, s21, 7
    s_sub_u32 s31, s20, s23
    s_and_b32 s30, s21, 15
    s_xor_b32 s21, s21, 16
    s_lshl_b32 s26, s30, 9
    s_mul_i32 s27, s8, 33792
    v_bfe_u32 v1, v0, 0, 5
    v_lshlrev_b32 v4, 4, v1
    v_bfe_u32 v1, v0, 5, 1
    v_lshl_add_u32 v4, v1, 17, v4
    v_add_u32 v5, 0x2000, v4
    v_add_u32 v6, 0x4000, v4
    v_add_u32 v7, 0x6000, v4
    s_add_u32 s22, s8, 0
    s_and_b32 s22, s22, 3
    s_lshl_b32 s32, s22, 15
    s_and_b32 s23, s22, 1
    s_mul_i32 s23, s23, 8448
    s_lshr_b32 s22, s22, 1
    s_mul_i32 s22, s22, 4224
    s_add_u32 s22, s22, s23
    s_add_u32 s36, s22, s27
    s_add_u32 s22, s8, 1
    s_and_b32 s22, s22, 3
    s_lshl_b32 s33, s22, 15
    s_and_b32 s23, s22, 1
    s_mul_i32 s23, s23, 8448
    s_lshr_b32 s22, s22, 1
    s_mul_i32 s22, s22, 4224
    s_add_u32 s22, s22, s23
    s_add_u32 s37, s22, s27
    s_add_u32 s22, s8, 2
    s_and_b32 s22, s22, 3
    s_lshl_b32 s34, s22, 15
    s_and_b32 s23, s22, 1
    s_mul_i32 s23, s23, 8448
    s_lshr_b32 s22, s22, 1
    s_mul_i32 s22, s22, 4224
    s_add_u32 s22, s22, s23
    s_add_u32 s38, s22, s27
    s_add_u32 s22, s8, 3
    s_and_b32 s22, s22, 3
    s_lshl_b32 s35, s22, 15
    s_and_b32 s23, s22, 1
    s_mul_i32 s23, s23, 8448
    s_lshr_b32 s22, s22, 1
    s_mul_i32 s22, s22, 4224
    s_add_u32 s22, s22, s23
    s_add_u32 s39, s22, s27
    s_lshr_b32 s24, s30, 2
    s_lshl_b32 s24, s24, 1
    s_cmp_ge_u32 s21, 16
    s_cselect_b32 s24, 0, s24
    s_add_u32 s24, s24, s31
    s_sub_u32 s23, s24, 7
    s_min_u32 s24, s24, s23
    s_lshl_b32 s24, s24, 1
    s_add_u32 s24, s24, s8
    s_add_u32 s22, s24, 0
    s_sub_u32 s23, s22, 14
    s_min_u32 s40, s22, s23
    s_add_u32 s22, s24, 4
    s_sub_u32 s23, s22, 14
    s_min_u32 s41, s22, s23
    s_add_u32 s22, s24, 8
    s_sub_u32 s23, s22, 14
    s_min_u32 s42, s22, s23
    s_add_u32 s22, s24, 12
    s_sub_u32 s23, s22, 14
    s_min_u32 s43, s22, s23
    s_and_b32 s22, s20, 0xe0
    s_bitcmp1_b32 s20, 4
    s_cselect_b32 s23, 31, 0
    s_add_u32 s22, s22, s23
    s_mul_i32 s22, s22, 9363
    s_bfe_u32 s22, s22, 0x40010
    s_lshl_b32 s22, s22, 9
    s_and_b32 s23, s20, 15
    s_lshl_b32 s23, s23, 2
    s_add_u32 s23, s23, s8
    s_mul_i32 s23, s23, 57344
    s_add_u32 s58, s22, s23
    v_min_u32 v17, 27, v0
    v_bfe_u32 v1, v17, 0, 2
    v_lshlrev_b32 v16, 7, v1
    v_bfe_u32 v1, v17, 2, 3
    v_lshl_add_u32 v16, v1, 13, v16
    s_cmp_ge_u32 s21, 16
    s_cbranch_scc1 .p1_a
    v_bfe_u32 v1, v0, 4, 2
    v_mul_u32_u24 v11, 7168, v1
    v_bfe_u32 v1, v0, 0, 4
    v_lshl_add_u32 v11, v1, 3, v11
    v_add_u32 v12, 3584, v11
    s_mul_i32 s24, s30, 229376
    s_lshl_b32 s25, s31, 7
    s_add_u32 s24, s24, s25
    s_mul_i32 s25, s8, 57344
    s_add_u32 s24, s24, s25
    s_add_u32 s25, s24, 28672
    s_waitcnt lgkmcnt(0)
    s_mov_b32 s4, s94
    s_and_b32 s5, s95, 0xffff
    s_and_b32 s93, s93, 0xffff
    s_mov_b32 s94, 256
    s_mov_b32 s95, 0x00020000
    s_mov_b32 s60, s46
    s_and_b32 s61, s47, 0xffff
    s_mov_b32 s62, 0x380000
    s_mov_b32 s63, 0x00020000
    s_mov_b32 s64, s44
    s_and_b32 s65, s45, 0xffff
    s_mov_b32 s66, 0x380000
    s_mov_b32 s67, 0x00020000
    buffer_load_dwordx2 v[24:25], v11, s[60:63], s24 offen nt
    buffer_load_dwordx2 v[26:27], v11, s[60:63], s24 offen offset:896 nt
    buffer_load_dwordx2 v[28:29], v11, s[60:63], s24 offen offset:1792 nt
    buffer_load_dwordx2 v[30:31], v11, s[60:63], s24 offen offset:2688 nt
    buffer_load_dwordx2 v[32:33], v12, s[60:63], s24 offen nt
    buffer_load_dwordx2 v[34:35], v12, s[60:63], s24 offen offset:896 nt
    buffer_load_dwordx2 v[36:37], v12, s[60:63], s24 offen offset:1792 nt
    buffer_load_dwordx2 v[38:39], v12, s[60:63], s24 offen offset:2688 nt
    buffer_load_dwordx2 v[40:41], v11, s[60:63], s25 offen nt
    buffer_load_dwordx2 v[42:43], v11, s[60:63], s25 offen offset:896 nt
    buffer_load_dwordx2 v[44:45], v11, s[60:63], s25 offen offset:1792 nt
    buffer_load_dwordx2 v[46:47], v11, s[60:63], s25 offen offset:2688 nt
    buffer_load_dwordx2 v[48:49], v12, s[60:63], s25 offen nt
    buffer_load_dwordx2 v[50:51], v12, s[60:63], s25 offen offset:896 nt
    buffer_load_dwordx2 v[52:53], v12, s[60:63], s25 offen offset:1792 nt
    buffer_load_dwordx2 v[54:55], v12, s[60:63], s25 offen offset:2688 nt
    s_nop 0
    s_lshl_b32 s28, s40, 18
    s_add_u32 s28, s28, s26
    s_add_u32 s22, s28, s32
    s_add_u32 m0, s36, 0
    s_nop 0
    buffer_load_dwordx4 v4, s[64:67], s22 offen nt lds
    s_add_u32 m0, s36, 1056
    s_nop 0
    buffer_load_dwordx4 v5, s[64:67], s22 offen nt lds
    s_add_u32 m0, s36, 2112
    s_nop 0
    buffer_load_dwordx4 v6, s[64:67], s22 offen nt lds
    s_add_u32 m0, s36, 3168
    s_nop 0
    buffer_load_dwordx4 v7, s[64:67], s22 offen nt lds
    s_add_u32 s22, s28, s33
    s_add_u32 m0, s37, 0
    s_nop 0
    buffer_load_dwordx4 v4, s[64:67], s22 offen nt lds
    s_add_u32 m0, s37, 1056
    s_nop 0
    buffer_load_dwordx4 v5, s[64:67], s22 offen nt lds
    s_add_u32 m0, s37, 2112
    s_nop 0
    buffer_load_dwordx4 v6, s[64:67], s22 offen nt lds
    s_add_u32 m0, s37, 3168
    s_nop 0
    buffer_load_dwordx4 v7, s[64:67], s22 offen nt lds
    s_add_u32 s22, s28, s34
    s_add_u32 m0, s38, 0
    s_nop 0
    buffer_load_dwordx4 v4, s[64:67], s22 offen nt lds
    s_add_u32 m0, s38, 1056
    s_nop 0
    buffer_load_dwordx4 v5, s[64:67], s22 offen nt lds
    s_add_u32 m0, s38, 2112
    s_nop 0
    buffer_load_dwordx4 v6, s[64:67], s22 offen nt lds
    s_add_u32 m0, s38, 3168
    s_nop 0
    buffer_load_dwordx4 v7, s[64:67], s22 offen nt lds
    s_add_u32 s22, s28, s35
    s_add_u32 m0, s39, 0
    s_nop 0
    buffer_load_dwordx4 v4, s[64:67], s22 offen nt lds
    s_add_u32 m0, s39, 1056
    s_nop 0
    buffer_load_dwordx4 v5, s[64:67], s22 offen nt lds
    s_add_u32 m0, s39, 2112
    s_nop 0
    buffer_load_dwordx4 v6, s[64:67], s22 offen nt lds
    s_add_u32 m0, s39, 3168
    s_nop 0
    buffer_load_dwordx4 v7, s[64:67], s22 offen nt lds
    buffer_load_dword v17, v16, s[64:67], s58 offen nt
    s_cmp_lg_u32 s8, 0
    s_cbranch_scc1 .tk_1
    s_lshl_b32 s22, s10, 5
    s_mov_b64 exec, 1
    buffer_atomic_add v19, off, s[92:95], s22 sc0
    s_mov_b64 exec, -1
.tk_1:
    s_mul_i32 s55, s30, 401408
    s_add_u32 s55, s55, 0x700000
    v_mov_b32 v2, 0x3f800000
    v_mov_b32 v3, v2
    s_lshl_b32 s22, s31, 2
    s_add_u32 s22, s22, 0
    s_mul_i32 s22, s22, 14336
    s_add_u32 s48, s22, s55
    s_lshl_b32 s22, s31, 2
    s_add_u32 s22, s22, 1
    s_mul_i32 s22, s22, 14336
    s_add_u32 s49, s22, s55
    s_lshl_b32 s22, s31, 2
    s_add_u32 s22, s22, 2
    s_mul_i32 s22, s22, 14336
    s_add_u32 s50, s22, s55
    s_lshl_b32 s22, s31, 2
    s_add_u32 s22, s22, 3
    s_mul_i32 s22, s22, 14336
    s_add_u32 s51, s22, s55
    s_lshl_b32 s22, s31, 2
    s_lshr_b32 s23, s30, 2
    s_add_u32 s22, s22, s23
    s_lshl_b32 s22, s22, 7
    s_add_u32 s54, s22, 0x4802000
    v_bfe_u32 v1, v0, 0, 3
    v_mul_u32_u24 v15, 1056, v1
    v_bfe_u32 v1, v0, 3, 1
    v_lshl_add_u32 v15, v1, 9, v15
    v_bfe_u32 v1, v0, 4, 2
    v_lshl_add_u32 v15, v1, 4, v15
    v_add_u32 v18, 118272, v15
    v_add_u32 v15, s27, v15
    s_mov_b32 s56, 0x05040100
    s_mov_b32 s57, 0x07060302
    s_lshl_b32 s22, s8, 7
    v_add_u32 v13, s22, v18
    s_waitcnt vmcnt(16)
    v_perm_b32 v56, v26, v24, s56
    v_perm_b32 v57, v30, v28, s56
    v_perm_b32 v58, v34, v32, s56
    v_perm_b32 v59, v38, v36, s56
    ds_write_b128 v13, v[56:59] offset:0
    v_perm_b32 v60, v26, v24, s57
    v_perm_b32 v61, v30, v28, s57
    v_perm_b32 v62, v34, v32, s57
    v_perm_b32 v63, v38, v36, s57
    ds_write_b128 v13, v[60:63] offset:8448
    v_perm_b32 v64, v27, v25, s56
    v_perm_b32 v65, v31, v29, s56
    v_perm_b32 v66, v35, v33, s56
    v_perm_b32 v67, v39, v37, s56
    ds_write_b128 v13, v[64:67] offset:16896
    v_perm_b32 v68, v27, v25, s57
    v_perm_b32 v69, v31, v29, s57
    v_perm_b32 v70, v35, v33, s57
    v_perm_b32 v71, v39, v37, s57
    ds_write_b128 v13, v[68:71] offset:25344
    v_perm_b32 v72, v42, v40, s56
    v_perm_b32 v73, v46, v44, s56
    v_perm_b32 v74, v50, v48, s56
    v_perm_b32 v75, v54, v52, s56
    ds_write_b128 v13, v[72:75] offset:64
    v_perm_b32 v76, v42, v40, s57
    v_perm_b32 v77, v46, v44, s57
    v_perm_b32 v78, v50, v48, s57
    v_perm_b32 v79, v54, v52, s57
    ds_write_b128 v13, v[76:79] offset:8512
    v_perm_b32 v80, v43, v41, s56
    v_perm_b32 v81, v47, v45, s56
    v_perm_b32 v82, v51, v49, s56
    v_perm_b32 v83, v55, v53, s56
    ds_write_b128 v13, v[80:83] offset:16960
    v_perm_b32 v84, v43, v41, s57
    v_perm_b32 v85, v47, v45, s57
    v_perm_b32 v86, v51, v49, s57
    v_perm_b32 v87, v55, v53, s57
    ds_write_b128 v13, v[84:87] offset:25408
    s_branch .p1_j
.p1_a:
    s_lshl_b32 s22, s8, 1
    s_sub_u32 s23, s31, s22
    s_add_u32 s22, s23, 7
    s_min_u32 s23, s22, s23
    s_mov_b32 s22, s8
    s_lshl_b32 s24, s23, 3
    s_mov_b32 s52, 0x06020400
    s_mov_b32 s53, 0x00c04440
    s_lshr_b64 s[52:53], s[52:53], s24
    s_and_b32 s52, s52, 0xff
    s_cmp_eq_u32 s23, 6
    s_cselect_b32 s24, 4, 96
    s_and_b32 s25, s22, 1
    s_mul_i32 s24, s24, s25
    s_add_u32 s52, s52, s24
    s_lshr_b32 s22, s22, 1
    s_mul_i32 s22, s22, 224
    s_add_u32 s52, s52, s22
    s_lshl_b32 s52, s52, 13
    s_add_u32 s52, s52, s26
    s_cmp_lt_u32 s23, 4
    s_cselect_b32 s53, 16, 2
    s_cselect_b32 s24, 32, 16
    s_lshl_b32 s53, s53, 13
    s_lshl_b32 s24, s24, 13
    s_add_u32 s53, s53, s52
    v_lshrrev_b32 v1, 5, v0
    v_mul_u32_u24 v1, s24, v1
    v_and_b32 v14, 31, v0
    v_lshl_add_u32 v14, v14, 4, v1
    s_mul_i32 s54, s8, 8448
    s_add_u32 s54, s54, 118272
    s_waitcnt lgkmcnt(0)
    s_mov_b32 s4, s94
    s_and_b32 s5, s95, 0xffff
    s_and_b32 s93, s93, 0xffff
    s_mov_b32 s94, 256
    s_mov_b32 s95, 0x00020000
    s_mov_b32 s60, s46
    s_and_b32 s61, s47, 0xffff
    s_mov_b32 s62, 0x380000
    s_mov_b32 s63, 0x00020000
    s_mov_b32 s64, s44
    s_and_b32 s65, s45, 0xffff
    s_mov_b32 s66, 0x380000
    s_mov_b32 s67, 0x00020000
    s_add_u32 m0, s54, 0
    s_add_u32 s23, s52, 0
    buffer_load_dwordx4 v14, s[60:63], s23 offen nt lds
    s_add_u32 m0, s54, 1056
    s_add_u32 s23, s52, 8192
    buffer_load_dwordx4 v14, s[60:63], s23 offen nt lds
    s_add_u32 m0, s54, 2112
    s_add_u32 s23, s52, 65536
    buffer_load_dwordx4 v14, s[60:63], s23 offen nt lds
    s_add_u32 m0, s54, 3168
    s_add_u32 s23, s52, 73728
    buffer_load_dwordx4 v14, s[60:63], s23 offen nt lds
    s_add_u32 m0, s54, 4224
    s_add_u32 s23, s53, 0
    buffer_load_dwordx4 v14, s[60:63], s23 offen nt lds
    s_add_u32 m0, s54, 5280
    s_add_u32 s23, s53, 8192
    buffer_load_dwordx4 v14, s[60:63], s23 offen nt lds
    s_add_u32 m0, s54, 6336
    s_add_u32 s23, s53, 65536
    buffer_load_dwordx4 v14, s[60:63], s23 offen nt lds
    s_add_u32 m0, s54, 7392
    s_add_u32 s23, s53, 73728
    buffer_load_dwordx4 v14, s[60:63], s23 offen nt lds
    s_nop 0
    s_lshl_b32 s28, s40, 18
    s_add_u32 s28, s28, s26
    s_add_u32 s22, s28, s32
    s_add_u32 m0, s36, 0
    s_nop 0
    buffer_load_dwordx4 v4, s[64:67], s22 offen nt lds
    s_add_u32 m0, s36, 1056
    s_nop 0
    buffer_load_dwordx4 v5, s[64:67], s22 offen nt lds
    s_add_u32 m0, s36, 2112
    s_nop 0
    buffer_load_dwordx4 v6, s[64:67], s22 offen nt lds
    s_add_u32 m0, s36, 3168
    s_nop 0
    buffer_load_dwordx4 v7, s[64:67], s22 offen nt lds
    s_add_u32 s22, s28, s33
    s_add_u32 m0, s37, 0
    s_nop 0
    buffer_load_dwordx4 v4, s[64:67], s22 offen nt lds
    s_add_u32 m0, s37, 1056
    s_nop 0
    buffer_load_dwordx4 v5, s[64:67], s22 offen nt lds
    s_add_u32 m0, s37, 2112
    s_nop 0
    buffer_load_dwordx4 v6, s[64:67], s22 offen nt lds
    s_add_u32 m0, s37, 3168
    s_nop 0
    buffer_load_dwordx4 v7, s[64:67], s22 offen nt lds
    s_add_u32 s22, s28, s34
    s_add_u32 m0, s38, 0
    s_nop 0
    buffer_load_dwordx4 v4, s[64:67], s22 offen nt lds
    s_add_u32 m0, s38, 1056
    s_nop 0
    buffer_load_dwordx4 v5, s[64:67], s22 offen nt lds
    s_add_u32 m0, s38, 2112
    s_nop 0
    buffer_load_dwordx4 v6, s[64:67], s22 offen nt lds
    s_add_u32 m0, s38, 3168
    s_nop 0
    buffer_load_dwordx4 v7, s[64:67], s22 offen nt lds
    s_add_u32 s22, s28, s35
    s_add_u32 m0, s39, 0
    s_nop 0
    buffer_load_dwordx4 v4, s[64:67], s22 offen nt lds
    s_add_u32 m0, s39, 1056
    s_nop 0
    buffer_load_dwordx4 v5, s[64:67], s22 offen nt lds
    s_add_u32 m0, s39, 2112
    s_nop 0
    buffer_load_dwordx4 v6, s[64:67], s22 offen nt lds
    s_add_u32 m0, s39, 3168
    s_nop 0
    buffer_load_dwordx4 v7, s[64:67], s22 offen nt lds
    buffer_load_dword v17, v16, s[64:67], s58 offen nt
    s_cmp_lg_u32 s8, 0
    s_cbranch_scc1 .tk_2
    s_lshl_b32 s22, s10, 5
    s_mov_b64 exec, 1
    buffer_atomic_add v19, off, s[92:95], s22 sc0
    s_mov_b64 exec, -1
.tk_2:
    s_mul_i32 s55, s30, 401408
    s_add_u32 s55, s55, 0x0
    v_mov_b32 v2, 0x3db8aa3b
    v_mov_b32 v3, v2
    s_add_u32 s22, s31, 7
    s_sub_u32 s23, s22, 7
    s_min_u32 s22, s22, s23
    s_add_u32 s22, s22, 0
    s_mul_i32 s22, s22, 14336
    s_add_u32 s48, s22, s55
    s_add_u32 s22, s31, 5
    s_sub_u32 s23, s22, 7
    s_min_u32 s22, s22, s23
    s_add_u32 s22, s22, 7
    s_mul_i32 s22, s22, 14336
    s_add_u32 s49, s22, s55
    s_add_u32 s22, s31, 3
    s_sub_u32 s23, s22, 7
    s_min_u32 s22, s22, s23
    s_add_u32 s22, s22, 14
    s_mul_i32 s22, s22, 14336
    s_add_u32 s50, s22, s55
    s_add_u32 s22, s31, 1
    s_sub_u32 s23, s22, 7
    s_min_u32 s22, s22, s23
    s_add_u32 s22, s22, 21
    s_mul_i32 s22, s22, 14336
    s_add_u32 s51, s22, s55
    s_lshl_b32 s22, s30, 7
    s_add_u32 s54, s22, 0x4800800
    v_bfe_u32 v1, v0, 0, 3
    v_mul_u32_u24 v15, 1056, v1
    v_bfe_u32 v1, v0, 3, 1
    v_lshl_add_u32 v15, v1, 9, v15
    v_bfe_u32 v1, v0, 4, 2
    v_lshl_add_u32 v15, v1, 4, v15
    v_add_u32 v18, 118272, v15
    v_add_u32 v15, s27, v15
.p1_j:
    s_cmp_eq_u32 s8, 3
    s_cbranch_scc1 .p1_v1
    s_nop 0
    s_lshl_b32 s28, s41, 18
    s_add_u32 s28, s28, s26
    s_add_u32 s22, s28, s32
    s_add_u32 m0, s36, 16896
    s_nop 0
    buffer_load_dwordx4 v4, s[64:67], s22 offen nt lds
    s_add_u32 m0, s36, 17952
    s_nop 0
    buffer_load_dwordx4 v5, s[64:67], s22 offen nt lds
    s_add_u32 m0, s36, 19008
    s_nop 0
    buffer_load_dwordx4 v6, s[64:67], s22 offen nt lds
    s_add_u32 m0, s36, 20064
    s_nop 0
    buffer_load_dwordx4 v7, s[64:67], s22 offen nt lds
    s_add_u32 s22, s28, s33
    s_add_u32 m0, s37, 16896
    s_nop 0
    buffer_load_dwordx4 v4, s[64:67], s22 offen nt lds
    s_add_u32 m0, s37, 17952
    s_nop 0
    buffer_load_dwordx4 v5, s[64:67], s22 offen nt lds
    s_add_u32 m0, s37, 19008
    s_nop 0
    buffer_load_dwordx4 v6, s[64:67], s22 offen nt lds
    s_add_u32 m0, s37, 20064
    s_nop 0
    buffer_load_dwordx4 v7, s[64:67], s22 offen nt lds
    s_add_u32 s22, s28, s34
    s_add_u32 m0, s38, 16896
    s_nop 0
    buffer_load_dwordx4 v4, s[64:67], s22 offen nt lds
    s_add_u32 m0, s38, 17952
    s_nop 0
    buffer_load_dwordx4 v5, s[64:67], s22 offen nt lds
    s_add_u32 m0, s38, 19008
    s_nop 0
    buffer_load_dwordx4 v6, s[64:67], s22 offen nt lds
    s_add_u32 m0, s38, 20064
    s_nop 0
    buffer_load_dwordx4 v7, s[64:67], s22 offen nt lds
    s_add_u32 s22, s28, s35
    s_add_u32 m0, s39, 16896
    s_nop 0
    buffer_load_dwordx4 v4, s[64:67], s22 offen nt lds
    s_add_u32 m0, s39, 17952
    s_nop 0
    buffer_load_dwordx4 v5, s[64:67], s22 offen nt lds
    s_add_u32 m0, s39, 19008
    s_nop 0
    buffer_load_dwordx4 v6, s[64:67], s22 offen nt lds
    s_add_u32 m0, s39, 20064
    s_nop 0
    buffer_load_dwordx4 v7, s[64:67], s22 offen nt lds
    s_waitcnt vmcnt(16)
    v_readfirstlane_b32 s23, v19
    s_lshr_b32 s23, s23, 30
    s_or_b32 s23, s23, s8
    s_cbranch_scc1 .p1_v2
    s_lshl_b32 s29, s10, 5
.ww_3:
    buffer_load_dword v21, off, s[92:95], s29 sc1
    s_sub_u32 s19, s19, 1
    s_cbranch_scc1 .abort
    s_waitcnt vmcnt(0)
    v_readfirstlane_b32 s23, v21
    s_bitcmp1_b32 s23, 30
    s_cbranch_scc1 .wwg_4
    s_sleep 4
    s_branch .ww_3
.wwg_4:
.p1_v1:
    s_waitcnt vmcnt(0)
.p1_v2:
    s_waitcnt lgkmcnt(0)
    s_barrier
    ds_read_b128 v[24:27], v15 offset:0
    ds_read_b128 v[28:31], v15 offset:8448
    ds_read_b128 v[128:131], v18 offset:0
    ds_read_b128 v[132:135], v18 offset:8448
    ds_read_b128 v[136:139], v18 offset:16896
    ds_read_b128 v[140:143], v18 offset:25344
    ds_read_b128 v[32:35], v15 offset:64
    ds_read_b128 v[36:39], v15 offset:8512
    ds_read_b128 v[144:147], v18 offset:64
    ds_read_b128 v[148:151], v18 offset:8512
    ds_read_b128 v[152:155], v18 offset:16960
    ds_read_b128 v[156:159], v18 offset:25408
    s_waitcnt lgkmcnt(6)
    v_mfma_f32_16x16x32_bf16 v[88:91], v[24:27], v[128:131], 0
    ds_read_b128 v[40:43], v15 offset:128
    v_mfma_f32_16x16x32_bf16 v[92:95], v[28:31], v[128:131], 0
    ds_read_b128 v[44:47], v15 offset:8576
    v_mfma_f32_16x16x32_bf16 v[96:99], v[24:27], v[132:135], 0
    ds_read_b128 v[160:163], v18 offset:128
    v_mfma_f32_16x16x32_bf16 v[100:103], v[28:31], v[132:135], 0
    ds_read_b128 v[164:167], v18 offset:8576
    v_mfma_f32_16x16x32_bf16 v[104:107], v[24:27], v[136:139], 0
    ds_read_b128 v[168:171], v18 offset:17024
    v_mfma_f32_16x16x32_bf16 v[108:111], v[28:31], v[136:139], 0
    ds_read_b128 v[172:175], v18 offset:25472
    v_mfma_f32_16x16x32_bf16 v[112:115], v[24:27], v[140:143], 0
    v_mfma_f32_16x16x32_bf16 v[116:119], v[28:31], v[140:143], 0
    s_waitcnt lgkmcnt(6)
    v_mfma_f32_16x16x32_bf16 v[88:91], v[32:35], v[144:147], v[88:91]
    ds_read_b128 v[48:51], v15 offset:192
    v_mfma_f32_16x16x32_bf16 v[92:95], v[36:39], v[144:147], v[92:95]
    ds_read_b128 v[52:55], v15 offset:8640
    v_mfma_f32_16x16x32_bf16 v[96:99], v[32:35], v[148:151], v[96:99]
    ds_read_b128 v[176:179], v18 offset:192
    v_mfma_f32_16x16x32_bf16 v[100:103], v[36:39], v[148:151], v[100:103]
    ds_read_b128 v[180:183], v18 offset:8640
    v_mfma_f32_16x16x32_bf16 v[104:107], v[32:35], v[152:155], v[104:107]
    ds_read_b128 v[184:187], v18 offset:17088
    v_mfma_f32_16x16x32_bf16 v[108:111], v[36:39], v[152:155], v[108:111]
    ds_read_b128 v[188:191], v18 offset:25536
    v_mfma_f32_16x16x32_bf16 v[112:115], v[32:35], v[156:159], v[112:115]
    v_mfma_f32_16x16x32_bf16 v[116:119], v[36:39], v[156:159], v[116:119]
    s_waitcnt lgkmcnt(6)
    v_mfma_f32_16x16x32_bf16 v[88:91], v[40:43], v[160:163], v[88:91]
    ds_read_b128 v[56:59], v15 offset:256
    v_mfma_f32_16x16x32_bf16 v[92:95], v[44:47], v[160:163], v[92:95]
    ds_read_b128 v[60:63], v15 offset:8704
    v_mfma_f32_16x16x32_bf16 v[96:99], v[40:43], v[164:167], v[96:99]
    ds_read_b128 v[192:195], v18 offset:256
    v_mfma_f32_16x16x32_bf16 v[100:103], v[44:47], v[164:167], v[100:103]
    ds_read_b128 v[196:199], v18 offset:8704
    v_mfma_f32_16x16x32_bf16 v[104:107], v[40:43], v[168:171], v[104:107]
    ds_read_b128 v[200:203], v18 offset:17152
    v_mfma_f32_16x16x32_bf16 v[108:111], v[44:47], v[168:171], v[108:111]
    ds_read_b128 v[204:207], v18 offset:25600
    v_mfma_f32_16x16x32_bf16 v[112:115], v[40:43], v[172:175], v[112:115]
    v_mfma_f32_16x16x32_bf16 v[116:119], v[44:47], v[172:175], v[116:119]
    s_waitcnt lgkmcnt(6)
    v_mfma_f32_16x16x32_bf16 v[88:91], v[48:51], v[176:179], v[88:91]
    ds_read_b128 v[64:67], v15 offset:320
    v_mfma_f32_16x16x32_bf16 v[92:95], v[52:55], v[176:179], v[92:95]
    ds_read_b128 v[68:71], v15 offset:8768
    v_mfma_f32_16x16x32_bf16 v[96:99], v[48:51], v[180:183], v[96:99]
    ds_read_b128 v[208:211], v18 offset:320
    v_mfma_f32_16x16x32_bf16 v[100:103], v[52:55], v[180:183], v[100:103]
    ds_read_b128 v[212:215], v18 offset:8768
    v_mfma_f32_16x16x32_bf16 v[104:107], v[48:51], v[184:187], v[104:107]
    ds_read_b128 v[216:219], v18 offset:17216
    v_mfma_f32_16x16x32_bf16 v[108:111], v[52:55], v[184:187], v[108:111]
    ds_read_b128 v[220:223], v18 offset:25664
    v_mfma_f32_16x16x32_bf16 v[112:115], v[48:51], v[188:191], v[112:115]
    v_mfma_f32_16x16x32_bf16 v[116:119], v[52:55], v[188:191], v[116:119]
    s_waitcnt lgkmcnt(6)
    v_mfma_f32_16x16x32_bf16 v[88:91], v[56:59], v[192:195], v[88:91]
    ds_read_b128 v[72:75], v15 offset:384
    v_mfma_f32_16x16x32_bf16 v[92:95], v[60:63], v[192:195], v[92:95]
    ds_read_b128 v[76:79], v15 offset:8832
    v_mfma_f32_16x16x32_bf16 v[96:99], v[56:59], v[196:199], v[96:99]
    ds_read_b128 v[224:227], v18 offset:384
    v_mfma_f32_16x16x32_bf16 v[100:103], v[60:63], v[196:199], v[100:103]
    ds_read_b128 v[228:231], v18 offset:8832
    v_mfma_f32_16x16x32_bf16 v[104:107], v[56:59], v[200:203], v[104:107]
    ds_read_b128 v[232:235], v18 offset:17280
    v_mfma_f32_16x16x32_bf16 v[108:111], v[60:63], v[200:203], v[108:111]
    ds_read_b128 v[236:239], v18 offset:25728
    v_mfma_f32_16x16x32_bf16 v[112:115], v[56:59], v[204:207], v[112:115]
    v_mfma_f32_16x16x32_bf16 v[116:119], v[60:63], v[204:207], v[116:119]
    s_waitcnt lgkmcnt(6)
    v_mfma_f32_16x16x32_bf16 v[88:91], v[64:67], v[208:211], v[88:91]
    ds_read_b128 v[80:83], v15 offset:448
    v_mfma_f32_16x16x32_bf16 v[92:95], v[68:71], v[208:211], v[92:95]
    ds_read_b128 v[84:87], v15 offset:8896
    v_mfma_f32_16x16x32_bf16 v[96:99], v[64:67], v[212:215], v[96:99]
    ds_read_b128 v[240:243], v18 offset:448
    v_mfma_f32_16x16x32_bf16 v[100:103], v[68:71], v[212:215], v[100:103]
    ds_read_b128 v[244:247], v18 offset:8896
    v_mfma_f32_16x16x32_bf16 v[104:107], v[64:67], v[216:219], v[104:107]
    ds_read_b128 v[248:251], v18 offset:17344
    v_mfma_f32_16x16x32_bf16 v[108:111], v[68:71], v[216:219], v[108:111]
    ds_read_b128 v[252:255], v18 offset:25792
    v_mfma_f32_16x16x32_bf16 v[112:115], v[64:67], v[220:223], v[112:115]
    v_mfma_f32_16x16x32_bf16 v[116:119], v[68:71], v[220:223], v[116:119]
    s_waitcnt lgkmcnt(6)
    v_mfma_f32_16x16x32_bf16 v[88:91], v[72:75], v[224:227], v[88:91]
    v_mfma_f32_16x16x32_bf16 v[92:95], v[76:79], v[224:227], v[92:95]
    v_mfma_f32_16x16x32_bf16 v[96:99], v[72:75], v[228:231], v[96:99]
    v_mfma_f32_16x16x32_bf16 v[100:103], v[76:79], v[228:231], v[100:103]
    v_mfma_f32_16x16x32_bf16 v[104:107], v[72:75], v[232:235], v[104:107]
    v_mfma_f32_16x16x32_bf16 v[108:111], v[76:79], v[232:235], v[108:111]
    v_mfma_f32_16x16x32_bf16 v[112:115], v[72:75], v[236:239], v[112:115]
    v_mfma_f32_16x16x32_bf16 v[116:119], v[76:79], v[236:239], v[116:119]
    s_waitcnt lgkmcnt(0)
    v_mfma_f32_16x16x32_bf16 v[88:91], v[80:83], v[240:243], v[88:91]
    v_mfma_f32_16x16x32_bf16 v[92:95], v[84:87], v[240:243], v[92:95]
    v_mfma_f32_16x16x32_bf16 v[96:99], v[80:83], v[244:247], v[96:99]
    v_mfma_f32_16x16x32_bf16 v[100:103], v[84:87], v[244:247], v[100:103]
    v_mfma_f32_16x16x32_bf16 v[104:107], v[80:83], v[248:251], v[104:107]
    v_mfma_f32_16x16x32_bf16 v[108:111], v[84:87], v[248:251], v[108:111]
    v_mfma_f32_16x16x32_bf16 v[112:115], v[80:83], v[252:255], v[112:115]
    v_mfma_f32_16x16x32_bf16 v[116:119], v[84:87], v[252:255], v[116:119]
    s_lshl_b32 s59, s40, 10
    v_add_u32 v10, s59, v9
    v_pk_mul_f32 v[88:89], v[88:89], v[2:3]
    v_pk_mul_f32 v[90:91], v[90:91], v[2:3]
    v_pk_mul_f32 v[92:93], v[92:93], v[2:3]
    v_pk_mul_f32 v[94:95], v[94:95], v[2:3]
    v_cvt_pk_bf16_f32 v120, v88, v89
    v_cvt_pk_bf16_f32 v121, v90, v91
    v_cvt_pk_bf16_f32 v122, v92, v93
    v_cvt_pk_bf16_f32 v123, v94, v95
    buffer_store_dwordx4 v[120:123], v10, s[4:7], s48 offen sc1
    v_pk_mul_f32 v[96:97], v[96:97], v[2:3]
    v_pk_mul_f32 v[98:99], v[98:99], v[2:3]
    v_pk_mul_f32 v[100:101], v[100:101], v[2:3]
    v_pk_mul_f32 v[102:103], v[102:103], v[2:3]
    v_cvt_pk_bf16_f32 v124, v96, v97
    v_cvt_pk_bf16_f32 v125, v98, v99
    v_cvt_pk_bf16_f32 v126, v100, v101
    v_cvt_pk_bf16_f32 v127, v102, v103
    buffer_store_dwordx4 v[124:127], v10, s[4:7], s49 offen sc1
    v_pk_mul_f32 v[104:105], v[104:105], v[2:3]
    v_pk_mul_f32 v[106:107], v[106:107], v[2:3]
    v_pk_mul_f32 v[108:109], v[108:109], v[2:3]
    v_pk_mul_f32 v[110:111], v[110:111], v[2:3]
    v_cvt_pk_bf16_f32 v120, v104, v105
    v_cvt_pk_bf16_f32 v121, v106, v107
    v_cvt_pk_bf16_f32 v122, v108, v109
    v_cvt_pk_bf16_f32 v123, v110, v111
    buffer_store_dwordx4 v[120:123], v10, s[4:7], s50 offen sc1
    v_pk_mul_f32 v[112:113], v[112:113], v[2:3]
    v_pk_mul_f32 v[114:115], v[114:115], v[2:3]
    v_pk_mul_f32 v[116:117], v[116:117], v[2:3]
    v_pk_mul_f32 v[118:119], v[118:119], v[2:3]
    v_cvt_pk_bf16_f32 v124, v112, v113
    v_cvt_pk_bf16_f32 v125, v114, v115
    v_cvt_pk_bf16_f32 v126, v116, v117
    v_cvt_pk_bf16_f32 v127, v118, v119
    buffer_store_dwordx4 v[124:127], v10, s[4:7], s51 offen sc1
    s_barrier
    s_cmp_ge_u32 s8, 2
    s_cselect_b32 s57, 0x40000000, 0
    s_mov_b32 s56, 1
    s_cmp_lg_u32 s8, 3
    s_cbranch_scc1 .p1_v3
    s_nop 0
    s_lshl_b32 s28, s41, 18
    s_add_u32 s28, s28, s26
    s_add_u32 s22, s28, s32
    s_add_u32 m0, s36, 16896
    s_nop 0
    buffer_load_dwordx4 v4, s[64:67], s22 offen nt lds
    s_add_u32 m0, s36, 17952
    s_nop 0
    buffer_load_dwordx4 v5, s[64:67], s22 offen nt lds
    s_add_u32 m0, s36, 19008
    s_nop 0
    buffer_load_dwordx4 v6, s[64:67], s22 offen nt lds
    s_add_u32 m0, s36, 20064
    s_nop 0
    buffer_load_dwordx4 v7, s[64:67], s22 offen nt lds
    s_add_u32 s22, s28, s33
    s_add_u32 m0, s37, 16896
    s_nop 0
    buffer_load_dwordx4 v4, s[64:67], s22 offen nt lds
    s_add_u32 m0, s37, 17952
    s_nop 0
    buffer_load_dwordx4 v5, s[64:67], s22 offen nt lds
    s_add_u32 m0, s37, 19008
    s_nop 0
    buffer_load_dwordx4 v6, s[64:67], s22 offen nt lds
    s_add_u32 m0, s37, 20064
    s_nop 0
    buffer_load_dwordx4 v7, s[64:67], s22 offen nt lds
    s_add_u32 s22, s28, s34
    s_add_u32 m0, s38, 16896
    s_nop 0
    buffer_load_dwordx4 v4, s[64:67], s22 offen nt lds
    s_add_u32 m0, s38, 17952
    s_nop 0
    buffer_load_dwordx4 v5, s[64:67], s22 offen nt lds
    s_add_u32 m0, s38, 19008
    s_nop 0
    buffer_load_dwordx4 v6, s[64:67], s22 offen nt lds
    s_add_u32 m0, s38, 20064
    s_nop 0
    buffer_load_dwordx4 v7, s[64:67], s22 offen nt lds
    s_add_u32 s22, s28, s35
    s_add_u32 m0, s39, 16896
    s_nop 0
    buffer_load_dwordx4 v4, s[64:67], s22 offen nt lds
    s_add_u32 m0, s39, 17952
    s_nop 0
    buffer_load_dwordx4 v5, s[64:67], s22 offen nt lds
    s_add_u32 m0, s39, 19008
    s_nop 0
    buffer_load_dwordx4 v6, s[64:67], s22 offen nt lds
    s_add_u32 m0, s39, 20064
    s_nop 0
    buffer_load_dwordx4 v7, s[64:67], s22 offen nt lds
    s_waitcnt vmcnt(16)
    v_mov_b32 v20, 0x1
    s_mov_b64 exec, 1
    buffer_atomic_add v20, off, s[4:7], s54
    s_mov_b64 exec, -1
    s_mov_b32 s56, 0
    s_waitcnt vmcnt(1)
.p1_v3:
    s_waitcnt vmcnt(4)
    ds_read_b128 v[24:27], v15 offset:16896
    ds_read_b128 v[28:31], v15 offset:25344
    ds_read_b128 v[32:35], v15 offset:16960
    ds_read_b128 v[36:39], v15 offset:25408
    ds_read_b128 v[40:43], v15 offset:17024
    ds_read_b128 v[44:47], v15 offset:25472
    ds_read_b128 v[48:51], v15 offset:17088
    ds_read_b128 v[52:55], v15 offset:25536
    ds_read_b128 v[56:59], v15 offset:17152
    ds_read_b128 v[60:63], v15 offset:25600
    ds_read_b128 v[64:67], v15 offset:17216
    ds_read_b128 v[68:71], v15 offset:25664
    ds_read_b128 v[72:75], v15 offset:17280
    ds_read_b128 v[76:79], v15 offset:25728
    s_waitcnt lgkmcnt(12)
    v_mfma_f32_16x16x32_bf16 v[88:91], v[24:27], v[128:131], 0
    ds_read_b128 v[80:83], v15 offset:17344
    v_mfma_f32_16x16x32_bf16 v[92:95], v[28:31], v[128:131], 0
    ds_read_b128 v[84:87], v15 offset:25792
    v_mfma_f32_16x16x32_bf16 v[96:99], v[24:27], v[132:135], 0
    s_lshl_b32 s28, s42, 18
    s_add_u32 s28, s28, s26
    s_add_u32 s22, s28, s32
    s_add_u32 m0, s36, 0
    v_mfma_f32_16x16x32_bf16 v[100:103], v[28:31], v[132:135], 0
    buffer_load_dwordx4 v4, s[64:67], s22 offen nt lds
    s_add_u32 m0, s36, 1056
    v_mfma_f32_16x16x32_bf16 v[104:107], v[24:27], v[136:139], 0
    buffer_load_dwordx4 v5, s[64:67], s22 offen nt lds
    s_add_u32 m0, s36, 2112
    v_mfma_f32_16x16x32_bf16 v[108:111], v[28:31], v[136:139], 0
    buffer_load_dwordx4 v6, s[64:67], s22 offen nt lds
    s_add_u32 m0, s36, 3168
    v_mfma_f32_16x16x32_bf16 v[112:115], v[24:27], v[140:143], 0
    buffer_load_dwordx4 v7, s[64:67], s22 offen nt lds
    s_add_u32 s22, s28, s33
    s_add_u32 m0, s37, 0
    v_mfma_f32_16x16x32_bf16 v[116:119], v[28:31], v[140:143], 0
    buffer_load_dwordx4 v4, s[64:67], s22 offen nt lds
    s_add_u32 m0, s37, 1056
    s_waitcnt lgkmcnt(12)
    v_mfma_f32_16x16x32_bf16 v[88:91], v[32:35], v[144:147], v[88:91]
    buffer_load_dwordx4 v5, s[64:67], s22 offen nt lds
    s_add_u32 m0, s37, 2112
    v_mfma_f32_16x16x32_bf16 v[92:95], v[36:39], v[144:147], v[92:95]
    buffer_load_dwordx4 v6, s[64:67], s22 offen nt lds
    s_add_u32 m0, s37, 3168
    v_mfma_f32_16x16x32_bf16 v[96:99], v[32:35], v[148:151], v[96:99]
    buffer_load_dwordx4 v7, s[64:67], s22 offen nt lds
    s_add_u32 s22, s28, s34
    s_add_u32 m0, s38, 0
    v_mfma_f32_16x16x32_bf16 v[100:103], v[36:39], v[148:151], v[100:103]
    buffer_load_dwordx4 v4, s[64:67], s22 offen nt lds
    s_add_u32 m0, s38, 1056
    v_mfma_f32_16x16x32_bf16 v[104:107], v[32:35], v[152:155], v[104:107]
    buffer_load_dwordx4 v5, s[64:67], s22 offen nt lds
    s_add_u32 m0, s38, 2112
    v_mfma_f32_16x16x32_bf16 v[108:111], v[36:39], v[152:155], v[108:111]
    buffer_load_dwordx4 v6, s[64:67], s22 offen nt lds
    s_add_u32 m0, s38, 3168
    v_mfma_f32_16x16x32_bf16 v[112:115], v[32:35], v[156:159], v[112:115]
    s_waitcnt vmcnt(11)
    v_mov_b32 v20, s56
    s_mov_b64 exec, 1
    buffer_atomic_add v20, off, s[4:7], s54
    s_mov_b64 exec, -1
    buffer_load_dwordx4 v7, s[64:67], s22 offen nt lds
    s_add_u32 s22, s28, s35
    s_add_u32 m0, s39, 0
    v_mfma_f32_16x16x32_bf16 v[116:119], v[36:39], v[156:159], v[116:119]
    buffer_load_dwordx4 v4, s[64:67], s22 offen nt lds
    s_add_u32 m0, s39, 1056
    s_waitcnt lgkmcnt(10)
    v_mfma_f32_16x16x32_bf16 v[88:91], v[40:43], v[160:163], v[88:91]
    buffer_load_dwordx4 v5, s[64:67], s22 offen nt lds
    s_add_u32 m0, s39, 2112
    v_mfma_f32_16x16x32_bf16 v[92:95], v[44:47], v[160:163], v[92:95]
    buffer_load_dwordx4 v6, s[64:67], s22 offen nt lds
    s_add_u32 m0, s39, 3168
    v_mfma_f32_16x16x32_bf16 v[96:99], v[40:43], v[164:167], v[96:99]
    buffer_load_dwordx4 v7, s[64:67], s22 offen nt lds
    v_mfma_f32_16x16x32_bf16 v[100:103], v[44:47], v[164:167], v[100:103]
    v_mfma_f32_16x16x32_bf16 v[104:107], v[40:43], v[168:171], v[104:107]
    v_mfma_f32_16x16x32_bf16 v[108:111], v[44:47], v[168:171], v[108:111]
    v_mfma_f32_16x16x32_bf16 v[112:115], v[40:43], v[172:175], v[112:115]
    v_mfma_f32_16x16x32_bf16 v[116:119], v[44:47], v[172:175], v[116:119]
    s_waitcnt lgkmcnt(0)
    v_mfma_f32_16x16x32_bf16 v[88:91], v[48:51], v[176:179], v[88:91]
    s_lshl_b32 s28, s43, 18
    s_add_u32 s28, s28, s26
    s_add_u32 s22, s28, s32
    s_add_u32 m0, s36, 16896
    v_or_b32 v4, s57, v4
    v_or_b32 v5, s57, v5
    v_or_b32 v6, s57, v6
    v_or_b32 v7, s57, v7
    v_mfma_f32_16x16x32_bf16 v[92:95], v[52:55], v[176:179], v[92:95]
    v_mfma_f32_16x16x32_bf16 v[96:99], v[48:51], v[180:183], v[96:99]
    buffer_load_dwordx4 v4, s[64:67], s22 offen nt lds
    s_add_u32 m0, s36, 17952
    v_mfma_f32_16x16x32_bf16 v[100:103], v[52:55], v[180:183], v[100:103]
    v_mfma_f32_16x16x32_bf16 v[104:107], v[48:51], v[184:187], v[104:107]
    buffer_load_dwordx4 v5, s[64:67], s22 offen nt lds
    s_add_u32 m0, s36, 19008
    v_mfma_f32_16x16x32_bf16 v[108:111], v[52:55], v[184:187], v[108:111]
    v_mfma_f32_16x16x32_bf16 v[112:115], v[48:51], v[188:191], v[112:115]
    buffer_load_dwordx4 v6, s[64:67], s22 offen nt lds
    s_add_u32 m0, s36, 20064
    v_mfma_f32_16x16x32_bf16 v[116:119], v[52:55], v[188:191], v[116:119]
    v_mfma_f32_16x16x32_bf16 v[88:91], v[56:59], v[192:195], v[88:91]
    buffer_load_dwordx4 v7, s[64:67], s22 offen nt lds
    s_add_u32 s22, s28, s33
    s_add_u32 m0, s37, 16896
    v_mfma_f32_16x16x32_bf16 v[92:95], v[60:63], v[192:195], v[92:95]
    v_mfma_f32_16x16x32_bf16 v[96:99], v[56:59], v[196:199], v[96:99]
    buffer_load_dwordx4 v4, s[64:67], s22 offen nt lds
    s_add_u32 m0, s37, 17952
    v_mfma_f32_16x16x32_bf16 v[100:103], v[60:63], v[196:199], v[100:103]
    v_mfma_f32_16x16x32_bf16 v[104:107], v[56:59], v[200:203], v[104:107]
    buffer_load_dwordx4 v5, s[64:67], s22 offen nt lds
    s_add_u32 m0, s37, 19008
    v_mfma_f32_16x16x32_bf16 v[108:111], v[60:63], v[200:203], v[108:111]
    v_mfma_f32_16x16x32_bf16 v[112:115], v[56:59], v[204:207], v[112:115]
    buffer_load_dwordx4 v6, s[64:67], s22 offen nt lds
    s_add_u32 m0, s37, 20064
    v_mfma_f32_16x16x32_bf16 v[116:119], v[60:63], v[204:207], v[116:119]
    v_mfma_f32_16x16x32_bf16 v[88:91], v[64:67], v[208:211], v[88:91]
    buffer_load_dwordx4 v7, s[64:67], s22 offen nt lds
    s_add_u32 s22, s28, s34
    s_add_u32 m0, s38, 16896
    v_mfma_f32_16x16x32_bf16 v[92:95], v[68:71], v[208:211], v[92:95]
    v_mfma_f32_16x16x32_bf16 v[96:99], v[64:67], v[212:215], v[96:99]
    buffer_load_dwordx4 v4, s[64:67], s22 offen nt lds
    s_add_u32 m0, s38, 17952
    v_mfma_f32_16x16x32_bf16 v[100:103], v[68:71], v[212:215], v[100:103]
    v_mfma_f32_16x16x32_bf16 v[104:107], v[64:67], v[216:219], v[104:107]
    buffer_load_dwordx4 v5, s[64:67], s22 offen nt lds
    s_add_u32 m0, s38, 19008
    v_mfma_f32_16x16x32_bf16 v[108:111], v[68:71], v[216:219], v[108:111]
    v_mfma_f32_16x16x32_bf16 v[112:115], v[64:67], v[220:223], v[112:115]
    buffer_load_dwordx4 v6, s[64:67], s22 offen nt lds
    s_add_u32 m0, s38, 20064
    v_mfma_f32_16x16x32_bf16 v[116:119], v[68:71], v[220:223], v[116:119]
    v_mfma_f32_16x16x32_bf16 v[88:91], v[72:75], v[224:227], v[88:91]
    buffer_load_dwordx4 v7, s[64:67], s22 offen nt lds
    s_add_u32 s22, s28, s35
    s_add_u32 m0, s39, 16896
    v_mfma_f32_16x16x32_bf16 v[92:95], v[76:79], v[224:227], v[92:95]
    v_mfma_f32_16x16x32_bf16 v[96:99], v[72:75], v[228:231], v[96:99]
    buffer_load_dwordx4 v4, s[64:67], s22 offen nt lds
    s_add_u32 m0, s39, 17952
    v_mfma_f32_16x16x32_bf16 v[100:103], v[76:79], v[228:231], v[100:103]
    v_mfma_f32_16x16x32_bf16 v[104:107], v[72:75], v[232:235], v[104:107]
    buffer_load_dwordx4 v5, s[64:67], s22 offen nt lds
    s_add_u32 m0, s39, 19008
    v_mfma_f32_16x16x32_bf16 v[108:111], v[76:79], v[232:235], v[108:111]
    v_mfma_f32_16x16x32_bf16 v[112:115], v[72:75], v[236:239], v[112:115]
    buffer_load_dwordx4 v6, s[64:67], s22 offen nt lds
    s_add_u32 m0, s39, 20064
    v_mfma_f32_16x16x32_bf16 v[116:119], v[76:79], v[236:239], v[116:119]
    v_mfma_f32_16x16x32_bf16 v[88:91], v[80:83], v[240:243], v[88:91]
    buffer_load_dwordx4 v7, s[64:67], s22 offen nt lds
    v_mfma_f32_16x16x32_bf16 v[92:95], v[84:87], v[240:243], v[92:95]
    v_mfma_f32_16x16x32_bf16 v[96:99], v[80:83], v[244:247], v[96:99]
    v_mfma_f32_16x16x32_bf16 v[100:103], v[84:87], v[244:247], v[100:103]
    v_mfma_f32_16x16x32_bf16 v[104:107], v[80:83], v[248:251], v[104:107]
    v_mfma_f32_16x16x32_bf16 v[108:111], v[84:87], v[248:251], v[108:111]
    v_mfma_f32_16x16x32_bf16 v[112:115], v[80:83], v[252:255], v[112:115]
    v_mfma_f32_16x16x32_bf16 v[116:119], v[84:87], v[252:255], v[116:119]
    s_waitcnt vmcnt(16)
    ds_read_b128 v[24:27], v15 offset:0
    ds_read_b128 v[28:31], v15 offset:8448
    ds_read_b128 v[32:35], v15 offset:64
    ds_read_b128 v[36:39], v15 offset:8512
    ds_read_b128 v[40:43], v15 offset:128
    ds_read_b128 v[44:47], v15 offset:8576
    ds_read_b128 v[48:51], v15 offset:192
    ds_read_b128 v[52:55], v15 offset:8640
    ds_read_b128 v[56:59], v15 offset:256
    ds_read_b128 v[60:63], v15 offset:8704
    ds_read_b128 v[64:67], v15 offset:320
    ds_read_b128 v[68:71], v15 offset:8768
    ds_read_b128 v[72:75], v15 offset:384
    ds_read_b128 v[76:79], v15 offset:8832
    s_lshl_b32 s59, s41, 10
    v_add_u32 v10, s59, v9
    v_pk_mul_f32 v[88:89], v[88:89], v[2:3]
    v_pk_mul_f32 v[90:91], v[90:91], v[2:3]
    v_pk_mul_f32 v[92:93], v[92:93], v[2:3]
    v_pk_mul_f32 v[94:95], v[94:95], v[2:3]
    v_cvt_pk_bf16_f32 v120, v88, v89
    v_cvt_pk_bf16_f32 v121, v90, v91
    v_cvt_pk_bf16_f32 v122, v92, v93
    v_cvt_pk_bf16_f32 v123, v94, v95
    buffer_store_dwordx4 v[120:123], v10, s[4:7], s48 offen sc1
    v_pk_mul_f32 v[96:97], v[96:97], v[2:3]
    v_pk_mul_f32 v[98:99], v[98:99], v[2:3]
    v_pk_mul_f32 v[100:101], v[100:101], v[2:3]
    v_pk_mul_f32 v[102:103], v[102:103], v[2:3]
    v_cvt_pk_bf16_f32 v124, v96, v97
    v_cvt_pk_bf16_f32 v125, v98, v99
    v_cvt_pk_bf16_f32 v126, v100, v101
    v_cvt_pk_bf16_f32 v127, v102, v103
    buffer_store_dwordx4 v[124:127], v10, s[4:7], s49 offen sc1
    v_pk_mul_f32 v[104:105], v[104:105], v[2:3]
    v_pk_mul_f32 v[106:107], v[106:107], v[2:3]
    v_pk_mul_f32 v[108:109], v[108:109], v[2:3]
    v_pk_mul_f32 v[110:111], v[110:111], v[2:3]
    v_cvt_pk_bf16_f32 v120, v104, v105
    v_cvt_pk_bf16_f32 v121, v106, v107
    v_cvt_pk_bf16_f32 v122, v108, v109
    v_cvt_pk_bf16_f32 v123, v110, v111
    buffer_store_dwordx4 v[120:123], v10, s[4:7], s50 offen sc1
    v_pk_mul_f32 v[112:113], v[112:113], v[2:3]
    v_pk_mul_f32 v[114:115], v[114:115], v[2:3]
    v_pk_mul_f32 v[116:117], v[116:117], v[2:3]
    v_pk_mul_f32 v[118:119], v[118:119], v[2:3]
    v_cvt_pk_bf16_f32 v124, v112, v113
    v_cvt_pk_bf16_f32 v125, v114, v115
    v_cvt_pk_bf16_f32 v126, v116, v117
    v_cvt_pk_bf16_f32 v127, v118, v119
    buffer_store_dwordx4 v[124:127], v10, s[4:7], s51 offen sc1
    s_waitcnt lgkmcnt(12)
    v_mfma_f32_16x16x32_bf16 v[88:91], v[24:27], v[128:131], 0
    ds_read_b128 v[80:83], v15 offset:448
    v_mfma_f32_16x16x32_bf16 v[92:95], v[28:31], v[128:131], 0
    ds_read_b128 v[84:87], v15 offset:8896
    v_mfma_f32_16x16x32_bf16 v[96:99], v[24:27], v[132:135], 0
    v_mfma_f32_16x16x32_bf16 v[100:103], v[28:31], v[132:135], 0
    v_mfma_f32_16x16x32_bf16 v[104:107], v[24:27], v[136:139], 0
    v_mfma_f32_16x16x32_bf16 v[108:111], v[28:31], v[136:139], 0
    v_mfma_f32_16x16x32_bf16 v[112:115], v[24:27], v[140:143], 0
    v_mfma_f32_16x16x32_bf16 v[116:119], v[28:31], v[140:143], 0
    s_waitcnt lgkmcnt(12)
    v_mfma_f32_16x16x32_bf16 v[88:91], v[32:35], v[144:147], v[88:91]
    v_mfma_f32_16x16x32_bf16 v[92:95], v[36:39], v[144:147], v[92:95]
    v_mfma_f32_16x16x32_bf16 v[96:99], v[32:35], v[148:151], v[96:99]
    v_mfma_f32_16x16x32_bf16 v[100:103], v[36:39], v[148:151], v[100:103]
    v_mfma_f32_16x16x32_bf16 v[104:107], v[32:35], v[152:155], v[104:107]
    v_mfma_f32_16x16x32_bf16 v[108:111], v[36:39], v[152:155], v[108:111]
    v_mfma_f32_16x16x32_bf16 v[112:115], v[32:35], v[156:159], v[112:115]
    v_mfma_f32_16x16x32_bf16 v[116:119], v[36:39], v[156:159], v[116:119]
    s_waitcnt lgkmcnt(10)
    v_mfma_f32_16x16x32_bf16 v[88:91], v[40:43], v[160:163], v[88:91]
    v_mfma_f32_16x16x32_bf16 v[92:95], v[44:47], v[160:163], v[92:95]
    v_mfma_f32_16x16x32_bf16 v[96:99], v[40:43], v[164:167], v[96:99]
    v_mfma_f32_16x16x32_bf16 v[100:103], v[44:47], v[164:167], v[100:103]
    v_mfma_f32_16x16x32_bf16 v[104:107], v[40:43], v[168:171], v[104:107]
    v_mfma_f32_16x16x32_bf16 v[108:111], v[44:47], v[168:171], v[108:111]
    v_mfma_f32_16x16x32_bf16 v[112:115], v[40:43], v[172:175], v[112:115]
    v_mfma_f32_16x16x32_bf16 v[116:119], v[44:47], v[172:175], v[116:119]
    s_waitcnt lgkmcnt(8)
    v_mfma_f32_16x16x32_bf16 v[88:91], v[48:51], v[176:179], v[88:91]
    v_mfma_f32_16x16x32_bf16 v[92:95], v[52:55], v[176:179], v[92:95]
    v_mfma_f32_16x16x32_bf16 v[96:99], v[48:51], v[180:183], v[96:99]
    v_mfma_f32_16x16x32_bf16 v[100:103], v[52:55], v[180:183], v[100:103]
    v_mfma_f32_16x16x32_bf16 v[104:107], v[48:51], v[184:187], v[104:107]
    v_mfma_f32_16x16x32_bf16 v[108:111], v[52:55], v[184:187], v[108:111]
    v_mfma_f32_16x16x32_bf16 v[112:115], v[48:51], v[188:191], v[112:115]
    v_mfma_f32_16x16x32_bf16 v[116:119], v[52:55], v[188:191], v[116:119]
    s_waitcnt lgkmcnt(6)
    v_mfma_f32_16x16x32_bf16 v[88:91], v[56:59], v[192:195], v[88:91]
    v_mfma_f32_16x16x32_bf16 v[92:95], v[60:63], v[192:195], v[92:95]
    v_mfma_f32_16x16x32_bf16 v[96:99], v[56:59], v[196:199], v[96:99]
    v_mfma_f32_16x16x32_bf16 v[100:103], v[60:63], v[196:199], v[100:103]
    v_mfma_f32_16x16x32_bf16 v[104:107], v[56:59], v[200:203], v[104:107]
    v_mfma_f32_16x16x32_bf16 v[108:111], v[60:63], v[200:203], v[108:111]
    v_mfma_f32_16x16x32_bf16 v[112:115], v[56:59], v[204:207], v[112:115]
    v_mfma_f32_16x16x32_bf16 v[116:119], v[60:63], v[204:207], v[116:119]
    s_waitcnt lgkmcnt(4)
    v_mfma_f32_16x16x32_bf16 v[88:91], v[64:67], v[208:211], v[88:91]
    v_mfma_f32_16x16x32_bf16 v[92:95], v[68:71], v[208:211], v[92:95]
    v_mfma_f32_16x16x32_bf16 v[96:99], v[64:67], v[212:215], v[96:99]
    v_mfma_f32_16x16x32_bf16 v[100:103], v[68:71], v[212:215], v[100:103]
    v_mfma_f32_16x16x32_bf16 v[104:107], v[64:67], v[216:219], v[104:107]
    v_mfma_f32_16x16x32_bf16 v[108:111], v[68:71], v[216:219], v[108:111]
    v_mfma_f32_16x16x32_bf16 v[112:115], v[64:67], v[220:223], v[112:115]
    v_mfma_f32_16x16x32_bf16 v[116:119], v[68:71], v[220:223], v[116:119]
    s_waitcnt lgkmcnt(2)
    v_mfma_f32_16x16x32_bf16 v[88:91], v[72:75], v[224:227], v[88:91]
    v_mfma_f32_16x16x32_bf16 v[92:95], v[76:79], v[224:227], v[92:95]
    v_mfma_f32_16x16x32_bf16 v[96:99], v[72:75], v[228:231], v[96:99]
    v_mfma_f32_16x16x32_bf16 v[100:103], v[76:79], v[228:231], v[100:103]
    v_mfma_f32_16x16x32_bf16 v[104:107], v[72:75], v[232:235], v[104:107]
    v_mfma_f32_16x16x32_bf16 v[108:111], v[76:79], v[232:235], v[108:111]
    v_mfma_f32_16x16x32_bf16 v[112:115], v[72:75], v[236:239], v[112:115]
    v_mfma_f32_16x16x32_bf16 v[116:119], v[76:79], v[236:239], v[116:119]
    s_waitcnt lgkmcnt(0)
    v_mfma_f32_16x16x32_bf16 v[88:91], v[80:83], v[240:243], v[88:91]
    v_mfma_f32_16x16x32_bf16 v[92:95], v[84:87], v[240:243], v[92:95]
    v_mfma_f32_16x16x32_bf16 v[96:99], v[80:83], v[244:247], v[96:99]
    v_mfma_f32_16x16x32_bf16 v[100:103], v[84:87], v[244:247], v[100:103]
    v_mfma_f32_16x16x32_bf16 v[104:107], v[80:83], v[248:251], v[104:107]
    v_mfma_f32_16x16x32_bf16 v[108:111], v[84:87], v[248:251], v[108:111]
    v_mfma_f32_16x16x32_bf16 v[112:115], v[80:83], v[252:255], v[112:115]
    v_mfma_f32_16x16x32_bf16 v[116:119], v[84:87], v[252:255], v[116:119]
    s_waitcnt vmcnt(0)
    v_mov_b32 v20, 0x100
    s_mov_b64 exec, 1
    buffer_atomic_add v20, off, s[4:7], s54
    s_mov_b64 exec, -1
    s_cmp_ge_u32 s8, 2
    s_cbranch_scc1 .p1_a0
    ds_read_b128 v[24:27], v15 offset:16896
    ds_read_b128 v[28:31], v15 offset:25344
    ds_read_b128 v[32:35], v15 offset:16960
    ds_read_b128 v[36:39], v15 offset:25408
    ds_read_b128 v[40:43], v15 offset:17024
    ds_read_b128 v[44:47], v15 offset:25472
    ds_read_b128 v[48:51], v15 offset:17088
    ds_read_b128 v[52:55], v15 offset:25536
    ds_read_b128 v[56:59], v15 offset:17152
    ds_read_b128 v[60:63], v15 offset:25600
    ds_read_b128 v[64:67], v15 offset:17216
    ds_read_b128 v[68:71], v15 offset:25664
    ds_read_b128 v[72:75], v15 offset:17280
    ds_read_b128 v[76:79], v15 offset:25728
    s_lshl_b32 s59, s42, 10
    v_add_u32 v10, s59, v9
    v_pk_mul_f32 v[88:89], v[88:89], v[2:3]
    v_pk_mul_f32 v[90:91], v[90:91], v[2:3]
    v_pk_mul_f32 v[92:93], v[92:93], v[2:3]
    v_pk_mul_f32 v[94:95], v[94:95], v[2:3]
    v_cvt_pk_bf16_f32 v120, v88, v89
    v_cvt_pk_bf16_f32 v121, v90, v91
    v_cvt_pk_bf16_f32 v122, v92, v93
    v_cvt_pk_bf16_f32 v123, v94, v95
    buffer_store_dwordx4 v[120:123], v10, s[4:7], s48 offen sc1
    v_pk_mul_f32 v[96:97], v[96:97], v[2:3]
    v_pk_mul_f32 v[98:99], v[98:99], v[2:3]
    v_pk_mul_f32 v[100:101], v[100:101], v[2:3]
    v_pk_mul_f32 v[102:103], v[102:103], v[2:3]
    v_cvt_pk_bf16_f32 v124, v96, v97
    v_cvt_pk_bf16_f32 v125, v98, v99
    v_cvt_pk_bf16_f32 v126, v100, v101
    v_cvt_pk_bf16_f32 v127, v102, v103
    buffer_store_dwordx4 v[124:127], v10, s[4:7], s49 offen sc1
    v_pk_mul_f32 v[104:105], v[104:105], v[2:3]
    v_pk_mul_f32 v[106:107], v[106:107], v[2:3]
    v_pk_mul_f32 v[108:109], v[108:109], v[2:3]
    v_pk_mul_f32 v[110:111], v[110:111], v[2:3]
    v_cvt_pk_bf16_f32 v120, v104, v105
    v_cvt_pk_bf16_f32 v121, v106, v107
    v_cvt_pk_bf16_f32 v122, v108, v109
    v_cvt_pk_bf16_f32 v123, v110, v111
    buffer_store_dwordx4 v[120:123], v10, s[4:7], s50 offen sc1
    v_pk_mul_f32 v[112:113], v[112:113], v[2:3]
    v_pk_mul_f32 v[114:115], v[114:115], v[2:3]
    v_pk_mul_f32 v[116:117], v[116:117], v[2:3]
    v_pk_mul_f32 v[118:119], v[118:119], v[2:3]
    v_cvt_pk_bf16_f32 v124, v112, v113
    v_cvt_pk_bf16_f32 v125, v114, v115
    v_cvt_pk_bf16_f32 v126, v116, v117
    v_cvt_pk_bf16_f32 v127, v118, v119
    buffer_store_dwordx4 v[124:127], v10, s[4:7], s51 offen sc1
    s_waitcnt lgkmcnt(12)
    v_mfma_f32_16x16x32_bf16 v[88:91], v[24:27], v[128:131], 0
    ds_read_b128 v[80:83], v15 offset:17344
    v_mfma_f32_16x16x32_bf16 v[92:95], v[28:31], v[128:131], 0
    ds_read_b128 v[84:87], v15 offset:25792
    v_mfma_f32_16x16x32_bf16 v[96:99], v[24:27], v[132:135], 0
    v_mfma_f32_16x16x32_bf16 v[100:103], v[28:31], v[132:135], 0
    v_mfma_f32_16x16x32_bf16 v[104:107], v[24:27], v[136:139], 0
    v_mfma_f32_16x16x32_bf16 v[108:111], v[28:31], v[136:139], 0
    v_mfma_f32_16x16x32_bf16 v[112:115], v[24:27], v[140:143], 0
    v_mfma_f32_16x16x32_bf16 v[116:119], v[28:31], v[140:143], 0
    s_waitcnt lgkmcnt(12)
    v_mfma_f32_16x16x32_bf16 v[88:91], v[32:35], v[144:147], v[88:91]
    v_mfma_f32_16x16x32_bf16 v[92:95], v[36:39], v[144:147], v[92:95]
    v_mfma_f32_16x16x32_bf16 v[96:99], v[32:35], v[148:151], v[96:99]
    v_mfma_f32_16x16x32_bf16 v[100:103], v[36:39], v[148:151], v[100:103]
    v_mfma_f32_16x16x32_bf16 v[104:107], v[32:35], v[152:155], v[104:107]
    v_mfma_f32_16x16x32_bf16 v[108:111], v[36:39], v[152:155], v[108:111]
    v_mfma_f32_16x16x32_bf16 v[112:115], v[32:35], v[156:159], v[112:115]
    v_mfma_f32_16x16x32_bf16 v[116:119], v[36:39], v[156:159], v[116:119]
    s_waitcnt lgkmcnt(10)
    v_mfma_f32_16x16x32_bf16 v[88:91], v[40:43], v[160:163], v[88:91]
    v_mfma_f32_16x16x32_bf16 v[92:95], v[44:47], v[160:163], v[92:95]
    v_mfma_f32_16x16x32_bf16 v[96:99], v[40:43], v[164:167], v[96:99]
    v_mfma_f32_16x16x32_bf16 v[100:103], v[44:47], v[164:167], v[100:103]
    v_mfma_f32_16x16x32_bf16 v[104:107], v[40:43], v[168:171], v[104:107]
    v_mfma_f32_16x16x32_bf16 v[108:111], v[44:47], v[168:171], v[108:111]
    v_mfma_f32_16x16x32_bf16 v[112:115], v[40:43], v[172:175], v[112:115]
    v_mfma_f32_16x16x32_bf16 v[116:119], v[44:47], v[172:175], v[116:119]
    s_waitcnt lgkmcnt(8)
    v_mfma_f32_16x16x32_bf16 v[88:91], v[48:51], v[176:179], v[88:91]
    v_mfma_f32_16x16x32_bf16 v[92:95], v[52:55], v[176:179], v[92:95]
    v_mfma_f32_16x16x32_bf16 v[96:99], v[48:51], v[180:183], v[96:99]
    v_mfma_f32_16x16x32_bf16 v[100:103], v[52:55], v[180:183], v[100:103]
    v_mfma_f32_16x16x32_bf16 v[104:107], v[48:51], v[184:187], v[104:107]
    v_mfma_f32_16x16x32_bf16 v[108:111], v[52:55], v[184:187], v[108:111]
    v_mfma_f32_16x16x32_bf16 v[112:115], v[48:51], v[188:191], v[112:115]
    v_mfma_f32_16x16x32_bf16 v[116:119], v[52:55], v[188:191], v[116:119]
    s_waitcnt lgkmcnt(6)
    v_mfma_f32_16x16x32_bf16 v[88:91], v[56:59], v[192:195], v[88:91]
    v_mfma_f32_16x16x32_bf16 v[92:95], v[60:63], v[192:195], v[92:95]
    v_mfma_f32_16x16x32_bf16 v[96:99], v[56:59], v[196:199], v[96:99]
    v_mfma_f32_16x16x32_bf16 v[100:103], v[60:63], v[196:199], v[100:103]
    v_mfma_f32_16x16x32_bf16 v[104:107], v[56:59], v[200:203], v[104:107]
    v_mfma_f32_16x16x32_bf16 v[108:111], v[60:63], v[200:203], v[108:111]
    v_mfma_f32_16x16x32_bf16 v[112:115], v[56:59], v[204:207], v[112:115]
    v_mfma_f32_16x16x32_bf16 v[116:119], v[60:63], v[204:207], v[116:119]
    s_waitcnt lgkmcnt(4)
    v_mfma_f32_16x16x32_bf16 v[88:91], v[64:67], v[208:211], v[88:91]
    v_mfma_f32_16x16x32_bf16 v[92:95], v[68:71], v[208:211], v[92:95]
    v_mfma_f32_16x16x32_bf16 v[96:99], v[64:67], v[212:215], v[96:99]
    v_mfma_f32_16x16x32_bf16 v[100:103], v[68:71], v[212:215], v[100:103]
    v_mfma_f32_16x16x32_bf16 v[104:107], v[64:67], v[216:219], v[104:107]
    v_mfma_f32_16x16x32_bf16 v[108:111], v[68:71], v[216:219], v[108:111]
    v_mfma_f32_16x16x32_bf16 v[112:115], v[64:67], v[220:223], v[112:115]
    v_mfma_f32_16x16x32_bf16 v[116:119], v[68:71], v[220:223], v[116:119]
    s_waitcnt lgkmcnt(2)
    v_mfma_f32_16x16x32_bf16 v[88:91], v[72:75], v[224:227], v[88:91]
    v_mfma_f32_16x16x32_bf16 v[92:95], v[76:79], v[224:227], v[92:95]
    v_mfma_f32_16x16x32_bf16 v[96:99], v[72:75], v[228:231], v[96:99]
    v_mfma_f32_16x16x32_bf16 v[100:103], v[76:79], v[228:231], v[100:103]
    v_mfma_f32_16x16x32_bf16 v[104:107], v[72:75], v[232:235], v[104:107]
    v_mfma_f32_16x16x32_bf16 v[108:111], v[76:79], v[232:235], v[108:111]
    v_mfma_f32_16x16x32_bf16 v[112:115], v[72:75], v[236:239], v[112:115]
    v_mfma_f32_16x16x32_bf16 v[116:119], v[76:79], v[236:239], v[116:119]
    s_waitcnt lgkmcnt(0)
    v_mfma_f32_16x16x32_bf16 v[88:91], v[80:83], v[240:243], v[88:91]
    v_mfma_f32_16x16x32_bf16 v[92:95], v[84:87], v[240:243], v[92:95]
    v_mfma_f32_16x16x32_bf16 v[96:99], v[80:83], v[244:247], v[96:99]
    v_mfma_f32_16x16x32_bf16 v[100:103], v[84:87], v[244:247], v[100:103]
    v_mfma_f32_16x16x32_bf16 v[104:107], v[80:83], v[248:251], v[104:107]
    v_mfma_f32_16x16x32_bf16 v[108:111], v[84:87], v[248:251], v[108:111]
    v_mfma_f32_16x16x32_bf16 v[112:115], v[80:83], v[252:255], v[112:115]
    v_mfma_f32_16x16x32_bf16 v[116:119], v[84:87], v[252:255], v[116:119]
    s_mov_b32 s42, s43
.p1_a0:
    s_nop 3
    s_lshl_b32 s59, s42, 10
    v_add_u32 v10, s59, v9
    v_pk_mul_f32 v[88:89], v[88:89], v[2:3]
    v_pk_mul_f32 v[90:91], v[90:91], v[2:3]
    v_pk_mul_f32 v[92:93], v[92:93], v[2:3]
    v_pk_mul_f32 v[94:95], v[94:95], v[2:3]
    v_cvt_pk_bf16_f32 v120, v88, v89
    v_cvt_pk_bf16_f32 v121, v90, v91
    v_cvt_pk_bf16_f32 v122, v92, v93
    v_cvt_pk_bf16_f32 v123, v94, v95
    buffer_store_dwordx4 v[120:123], v10, s[4:7], s48 offen sc1
    v_pk_mul_f32 v[96:97], v[96:97], v[2:3]
    v_pk_mul_f32 v[98:99], v[98:99], v[2:3]
    v_pk_mul_f32 v[100:101], v[100:101], v[2:3]
    v_pk_mul_f32 v[102:103], v[102:103], v[2:3]
    v_cvt_pk_bf16_f32 v124, v96, v97
    v_cvt_pk_bf16_f32 v125, v98, v99
    v_cvt_pk_bf16_f32 v126, v100, v101
    v_cvt_pk_bf16_f32 v127, v102, v103
    buffer_store_dwordx4 v[124:127], v10, s[4:7], s49 offen sc1
    v_pk_mul_f32 v[104:105], v[104:105], v[2:3]
    v_pk_mul_f32 v[106:107], v[106:107], v[2:3]
    v_pk_mul_f32 v[108:109], v[108:109], v[2:3]
    v_pk_mul_f32 v[110:111], v[110:111], v[2:3]
    v_cvt_pk_bf16_f32 v120, v104, v105
    v_cvt_pk_bf16_f32 v121, v106, v107
    v_cvt_pk_bf16_f32 v122, v108, v109
    v_cvt_pk_bf16_f32 v123, v110, v111
    buffer_store_dwordx4 v[120:123], v10, s[4:7], s50 offen sc1
    v_pk_mul_f32 v[112:113], v[112:113], v[2:3]
    v_pk_mul_f32 v[114:115], v[114:115], v[2:3]
    v_pk_mul_f32 v[116:117], v[116:117], v[2:3]
    v_pk_mul_f32 v[118:119], v[118:119], v[2:3]
    v_cvt_pk_bf16_f32 v124, v112, v113
    v_cvt_pk_bf16_f32 v125, v114, v115
    v_cvt_pk_bf16_f32 v126, v116, v117
    v_cvt_pk_bf16_f32 v127, v118, v119
    buffer_store_dwordx4 v[124:127], v10, s[4:7], s51 offen sc1
    s_waitcnt vmcnt(0)
    v_mov_b32 v20, 0x10000
    s_mov_b64 exec, 1
    buffer_atomic_add v20, off, s[4:7], s54
    s_mov_b64 exec, -1
    s_branch .p1_role
.p1_fill:
    s_load_dwordx2 s[42:43], s[0:1], 8
    s_mov_b32 s30, s20
    v_mov_b32 v4, -1
    v_mov_b32 v5, -1
    v_mov_b32 v6, -1
    v_mov_b32 v7, -1
    v_mov_b32 v12, 0
    v_mov_b32 v13, 0
    v_mov_b32 v14, 0
    v_mov_b32 v15, 0
    s_lshl_b32 s22, s8, 10
    v_add_u32 v8, s22, v9
    s_waitcnt lgkmcnt(0)
    s_mov_b32 s4, s94
    s_and_b32 s5, s95, 0xffff
    s_and_b32 s93, s93, 0xffff
    s_mov_b32 s94, 256
    s_mov_b32 s95, 0x00020000
    s_cmp_lg_u32 s8, 0
    s_cbranch_scc1 .tk_5
    s_lshl_b32 s22, s10, 5
    s_mov_b64 exec, 1
    buffer_atomic_add v19, off, s[92:95], s22 sc0
    s_mov_b64 exec, -1
.tk_5:
    s_lshl_b32 s22, s30, 2
    s_add_u32 s22, s22, s8
    s_cmp_lg_u32 s22, 3
    s_cbranch_scc1 .p1_m1
    v_mov_b32 v16, 0x40000000
    v_lshlrev_b32 v17, 7, v0
    s_mov_b32 s22, 0x4800000
    buffer_store_dwordx4 v[12:15], v17, s[4:7], s22 offen sc1
    s_mov_b32 s22, 0x4802000
    buffer_store_dwordx4 v[12:15], v17, s[4:7], s22 offen sc1
    v_lshlrev_b32 v18, 5, v0
    s_waitcnt vmcnt(0)
    s_mov_b64 exec, 0xff
    buffer_atomic_add v16, v18, s[92:95], 0 offen
    s_mov_b64 exec, -1
    s_branch .p1_m3
.p1_m1:
    s_waitcnt vmcnt(0)
.p1_m3:
    s_barrier
    s_sub_u32 s22, s30, 1
    s_cmp_ge_u32 s22, 2
    s_cbranch_scc1 .p1_m2
    s_lshl_b32 s22, s22, 2
    s_add_u32 s22, s22, s8
    s_min_u32 s22, s22, 6
    s_lshl_b32 s23, s22, 7
    s_lshl_b32 s22, s22, 10
    s_add_u32 s22, s22, 0x3ffc000
    s_add_u32 s24, s22, 8192
    s_mov_b32 s60, s42
    s_and_b32 s61, s43, 0xffff
    s_mov_b32 s62, 0x1c00
    s_mov_b32 s63, 0x00020000
    v_bfe_u32 v1, v0, 4, 2
    v_lshlrev_b32 v10, 5, v1
    v_bfe_u32 v1, v0, 1, 1
    v_lshl_add_u32 v10, v1, 2, v10
    v_bfe_u32 v1, v0, 2, 2
    s_mov_b32 s28, 1792
    v_mad_u32_u24 v10, v1, s28, v10
    v_bfe_u32 v1, v0, 0, 1
    s_mov_b32 s28, 896
    v_mad_u32_u24 v10, v1, s28, v10
    buffer_load_dword v24, v10, s[60:63], s23 offen offset:0
    buffer_load_dword v25, v10, s[60:63], s23 offen offset:8
    buffer_load_dword v26, v10, s[60:63], s23 offen offset:16
    buffer_load_dword v27, v10, s[60:63], s23 offen offset:24
    s_waitcnt vmcnt(0)
    v_min_u32 v24, -2, v24
    v_min_u32 v25, -2, v25
    v_min_u32 v26, -2, v26
    v_min_u32 v27, -2, v27
    buffer_store_dwordx4 v[24:27], v9, s[4:7], s22 offen sc1
    buffer_store_dwordx4 v[24:27], v9, s[4:7], s24 offen sc1
.p1_m2:
    s_lshl_b32 s22, s30, 2
    s_add_u32 s22, s22, s8
    s_lshl_b32 s22, s22, 13
    s_add_u32 s23, s22, 0x4000000
    s_add_u32 s24, s23, 4096
    s_and_b32 s25, s8, 1
    s_mul_i32 s25, s25, 3072
    s_sub_u32 s25, s22, s25
    s_add_u32 s25, s25, 0x4100000
    s_add_u32 s26, s25, 4096
    buffer_store_dwordx4 v[4:7], v9, s[4:7], s23 offen offset:0 sc1
    buffer_store_dwordx4 v[4:7], v9, s[4:7], s23 offen offset:1024 sc1
    buffer_store_dwordx4 v[4:7], v9, s[4:7], s23 offen offset:2048 sc1
    buffer_store_dwordx4 v[4:7], v9, s[4:7], s23 offen offset:3072 sc1
    buffer_store_dwordx4 v[4:7], v9, s[4:7], s24 offen offset:0 sc1
    buffer_store_dwordx4 v[4:7], v9, s[4:7], s24 offen offset:1024 sc1
    buffer_store_dwordx4 v[4:7], v9, s[4:7], s24 offen offset:2048 sc1
    buffer_store_dwordx4 v[4:7], v9, s[4:7], s25 offen offset:0 sc1
    buffer_store_dwordx4 v[4:7], v9, s[4:7], s25 offen offset:1024 sc1
    buffer_store_dwordx4 v[4:7], v9, s[4:7], s25 offen offset:2048 sc1
    buffer_store_dwordx4 v[4:7], v9, s[4:7], s25 offen offset:3072 sc1
    buffer_store_dwordx4 v[4:7], v9, s[4:7], s26 offen offset:0 sc1
    s_and_b32 s22, s30, 15
    s_lshl_b32 s22, s22, 12
    s_add_u32 s22, s22, 0x4810000
    buffer_store_dwordx4 v[12:15], v8, s[4:7], s22 offen sc1
    s_cmp_lg_u32 s8, 0
    s_cbranch_scc1 .p1_m4
    s_lshl_b32 s29, s10, 5
.ww_6:
    buffer_load_dword v21, off, s[92:95], s29 sc1
    s_sub_u32 s19, s19, 1
    s_cbranch_scc1 .abort
    s_waitcnt vmcnt(0)
    v_readfirstlane_b32 s23, v21
    s_bitcmp1_b32 s23, 30
    s_cbranch_scc1 .wwg_7
    s_sleep 2
    s_branch .ww_6
.wwg_7:
.p1_m4:
    s_waitcnt vmcnt(0)
    s_barrier
    s_cmp_lg_u32 s8, 0
    s_cbranch_scc1 .p1_role
    s_mov_b64 exec, 1
    buffer_atomic_add v20, off, s[92:95], 0 offset:132
    s_mov_b64 exec, -1
.p1_role:
    v_mov_b32 v1, 152064
    s_cmp_lg_u32 s8, 0
    s_cbranch_scc1 .p1_wait_role
    s_mov_b32 s22, s10
    s_mov_b32 s24, 0
    s_mov_b64 exec, 1
.p1_claim:
    v_readfirstlane_b32 s25, v19
    s_and_b32 s25, s25, 0xffff
    s_cmp_lt_u32 s25, 32
    s_cbranch_scc1 .p1_got
    s_add_u32 s22, s22, 1
    s_and_b32 s22, s22, 7
    s_add_u32 s24, s24, 1
    s_mov_b32 s9, 256
    s_cmp_ge_u32 s24, 8
    s_cbranch_scc1 .p1_pub
    s_lshl_b32 s23, s22, 5
    v_mov_b32 v19, 1
    buffer_atomic_add v19, off, s[92:95], s23 sc0
    s_waitcnt vmcnt(0)
    s_branch .p1_claim
.p1_got:
    s_lshl_b32 s9, s22, 5
    s_add_u32 s9, s9, s25
    s_sub_u32 s23, s9, 46
    s_cmp_lt_u32 s23, 16
    s_cselect_b32 s23, 194, 0
    s_cmp_ge_u32 s9, 240
    s_cselect_b32 s23, -194, s23
    s_add_u32 s9, s9, s23
    s_cmp_lg_u32 s22, 0
    s_cbranch_scc1 .p1_pub
    s_cmp_lg_u32 s10, 0
    s_cselect_b32 s25, 0x101, 1
    s_lshl_b32 s25, s25, 8
    v_mov_b32 v2, s25
    buffer_atomic_add v2, off, s[92:95], 0 offset:132
.p1_pub:
    v_mov_b32 v2, s9
    ds_write_b32 v1, v2
    s_mov_b64 exec, -1
    s_waitcnt lgkmcnt(0)
.p1_wait_role:
    s_barrier
    ds_read_b32 v2, v1
    s_waitcnt lgkmcnt(0)
    v_readfirstlane_b32 s9, v2
    s_cmp_lt_u32 s9, 16
    s_cbranch_scc1 .role_score
    s_cmp_lt_u32 s9, 30
    s_cbranch_scc1 .role_out
    s_cmp_eq_u32 s9, 30
    s_cbranch_scc1 .role_pf
    s_cmp_eq_u32 s9, 31
    s_cbranch_scc1 .role_pf2
    s_cmp_ge_u32 s9, 256
    s_cbranch_scc1 .role_none
    s_cmp_ge_u32 s9, 240
    s_cbranch_scc1 .role_fill
    s_cmp_ge_u32 s9, 192
    s_cbranch_scc1 .role_bw
    s_cmp_ge_u32 s9, 128
    s_cbranch_scc1 .role_tw
    s_and_b32 s22, s9, 31
    s_cmp_ge_u32 s22, 28
    s_cbranch_scc1 .role_none
    s_cmp_ge_u32 s9, 64
    s_cbranch_scc1 .role_sh
    s_branch .role_uw
.role_none:
    s_endpgm
.abort:
    s_load_dwordx2 s[4:5], s[0:1], 88
    s_mov_b32 s6, 256
    s_mov_b32 s7, 0x00020000
    s_mov_b64 exec, -1
    v_mov_b32 v1, 0
    v_mov_b32 v2, s9
    v_or_b32 v2, 0xdead0000, v2
    s_waitcnt lgkmcnt(0)
    s_and_b32 s5, s5, 0xffff
    buffer_store_dword v2, v1, s[4:7], 0 offen offset:8
    s_endpgm
.role_fill:
    s_sub_u32 s30, s9, 240
    s_lshl_b32 s22, s8, 10
    v_add_u32 v8, s22, v9
    v_mov_b32 v4, -1
    v_mov_b32 v5, -1
    v_mov_b32 v6, -1
    v_mov_b32 v7, -1
    v_mov_b32 v20, 0x1000000
    s_mul_i32 s22, s30, 163840
    s_add_u32 s22, s22, 0x4200000
    s_mov_b32 s24, 40
.fill_loop:
    buffer_store_dwordx4 v[4:7], v8, s[4:7], s22 offen sc1
    s_add_u32 s22, s22, 4096
    s_sub_u32 s24, s24, 1
    s_cmp_lg_u32 s24, 0
    s_cbranch_scc1 .fill_loop
    s_waitcnt vmcnt(0)
    s_barrier
    s_cmp_lg_u32 s8, 0
    s_cbranch_scc1 .fill_end
    s_mov_b64 exec, 1
    buffer_atomic_add v20, off, s[92:95], 0 offset:132
    s_mov_b64 exec, -1
.fill_end:
    s_endpgm
.role_pf:
.wd_8:
    buffer_load_dword v1, off, s[92:95], 0 offset:132 sc1
    s_sub_u32 s19, s19, 1
    s_cbranch_scc1 .abort
    s_waitcnt vmcnt(0)
    v_readfirstlane_b32 s101, v1
    s_and_b32 s100, s101, 0x20
    s_cmp_eq_u32 s100, 0x20
    s_cbranch_scc1 .wdg_9
    s_sleep 2
    s_branch .wd_8
.wdg_9:
    s_mov_b32 s11, 1
    v_lshlrev_b32 v1, 4, v0
    s_lshl_b32 s22, s8, 11
    s_min_u32 s22, s22, 5120
    v_add_u32 v1, s22, v1
    s_mov_b32 s12, 0x4000000
    s_mov_b32 s15, 0x4002000
.pf_loop_10:
.pm_11:
    buffer_load_dwordx4 v[4:7], v1, s[4:7], s12 offen sc1
    buffer_load_dwordx4 v[8:11], v1, s[4:7], s12 offen offset:1024 sc1
    s_waitcnt vmcnt(0)
    v_max3_u32 v2, v4, v8, v8
    v_cmp_eq_u32 vcc, -1, v2
    s_cbranch_vccz .pmg_12
    s_sub_u32 s19, s19, 1
    s_cbranch_scc1 .abort
    s_sleep 3
    s_branch .pm_11
.pmg_12:
    buffer_store_dwordx4 v[4:7], v1, s[4:7], s15 offen sc1
    buffer_store_dwordx4 v[8:11], v1, s[4:7], s15 offen offset:1024 sc1
    s_add_u32 s15, s15, 16384
    s_add_u32 s12, s12, 16384
    s_add_u32 s11, s11, 1
    s_waitcnt vmcnt(0)
    s_sleep 16
    s_cmp_lt_u32 s11, 63
    s_cbranch_scc1 .pf_loop_10
    s_endpgm
.role_pf2:
    s_cmp_lg_u32 s8, 0
    s_cbranch_scc1 .pf_end
    s_load_dwordx2 s[52:53], s[0:1], 0
    s_mov_b32 s54, 1835008
    s_mov_b32 s55, 0x00020000
    s_waitcnt lgkmcnt(0)
    s_and_b32 s53, s53, 0xffff
.wd_13:
    buffer_load_dword v1, off, s[92:95], 0 offset:132 sc1
    s_sub_u32 s19, s19, 1
    s_cbranch_scc1 .abort
    s_waitcnt vmcnt(0)
    v_readfirstlane_b32 s101, v1
    s_and_b32 s100, s101, 0x20
    s_cmp_eq_u32 s100, 0x20
    s_cbranch_scc1 .wdg_14
    s_sleep 2
    s_branch .wd_13
.wdg_14:
    s_mov_b32 s11, 0
    v_lshlrev_b32 v1, 7, v0
    v_mov_b32 v2, 0
    s_mov_b32 s17, 28672
    s_mov_b32 s12, 0x3ffc000
    s_mov_b32 s15, 0x4000000
    s_mov_b32 s14, 0x4100000
.pf_loop_15:
    s_cmp_lt_u32 s11, 3
    s_cbranch_scc1 .pf_go_17
.pf_poll_16:
    s_sub_u32 s19, s19, 1
    s_cbranch_scc1 .abort
    s_sleep 4
    buffer_load_dword v3, v2, s[4:7], s12 offen sc1
    s_waitcnt vmcnt(0)
    v_readfirstlane_b32 s22, v3
    s_cmp_eq_u32 s22, -1
    s_cbranch_scc1 .pf_poll_16
    s_add_u32 s12, s12, 16384
.pf_go_17:
    buffer_load_dword v4, v1, s[4:7], s15 offen sc1
    buffer_load_dword v5, v1, s[4:7], s14 offen sc1
    s_add_u32 s22, s14, 8192
    buffer_load_dword v6, v1, s[4:7], s22 offen sc1
    s_mov_b32 exec_hi, 0xffffff
    buffer_load_dword v7, v1, s[52:55], s17 offen
    s_add_u32 s17, s17, 7168
    buffer_load_dword v8, v1, s[52:55], s17 offen
    s_add_u32 s17, s17, 7168
    buffer_load_dword v9, v1, s[52:55], s17 offen
    s_add_u32 s17, s17, 7168
    buffer_load_dword v10, v1, s[52:55], s17 offen
    s_add_u32 s17, s17, 7168
    s_mov_b32 exec_hi, -1
    s_add_u32 s15, s15, 16384
    s_add_u32 s14, s14, 16384
    s_add_u32 s11, s11, 1
    s_cmp_lt_u32 s11, 63
    s_cbranch_scc1 .pf_loop_15
    s_waitcnt vmcnt(0)
.pf_end:
    s_endpgm
.role_score:
    s_load_dwordx2 s[52:53], s[0:1], 0
    v_lshlrev_b32 v9, 4, v0
    s_lshl_b32 s22, s8, 1
    s_add_u32 s23, s22, 0
    s_cmp_ge_u32 s23, 7
    s_cselect_b32 s24, 7, 0
    s_sub_u32 s23, s23, s24
    s_lshl_b32 s32, s23, 11
    s_add_u32 s23, s22, 1
    s_cmp_ge_u32 s23, 7
    s_cselect_b32 s24, 7, 0
    s_sub_u32 s23, s23, s24
    s_lshl_b32 s33, s23, 11
    s_add_u32 s23, s22, 2
    s_cmp_ge_u32 s23, 7
    s_cselect_b32 s24, 7, 0
    s_sub_u32 s23, s23, s24
    s_lshl_b32 s34, s23, 11
    s_add_u32 s23, s22, 3
    s_cmp_ge_u32 s23, 7
    s_cselect_b32 s24, 7, 0
    s_sub_u32 s23, s23, s24
    s_lshl_b32 s35, s23, 11
    s_add_u32 s23, s22, 4
    s_cmp_ge_u32 s23, 7
    s_cselect_b32 s24, 7, 0
    s_sub_u32 s23, s23, s24
    s_lshl_b32 s36, s23, 11
    s_add_u32 s23, s22, 5
    s_cmp_ge_u32 s23, 7
    s_cselect_b32 s24, 7, 0
    s_sub_u32 s23, s23, s24
    s_lshl_b32 s37, s23, 11
    s_add_u32 s23, s22, 6
    s_cmp_ge_u32 s23, 7
    s_cselect_b32 s24, 7, 0
    s_sub_u32 s23, s23, s24
    s_lshl_b32 s38, s23, 11
    s_lshl_b32 s22, s8, 11
    v_add_u32 v113, s22, v9
    s_lshr_b32 s23, s34, 1
    s_add_u32 s23, s23, 8192
    v_add_u32 v10, s23, v9
    s_lshr_b32 s23, s36, 1
    s_add_u32 s23, s23, 8192
    v_add_u32 v11, s23, v9
    s_lshr_b32 s23, s38, 1
    s_add_u32 s23, s23, 8192
    v_add_u32 v12, s23, v9
    s_lshr_b32 s23, s32, 1
    s_sub_u32 s23, s23, s22
    s_add_u32 s12, s23, 0x3ffc000
    s_lshr_b32 s23, s33, 1
    s_sub_u32 s23, s23, s22
    s_add_u32 s13, s23, 0x3ffc000
    s_lshr_b32 s23, s34, 1
    s_add_u32 s23, s23, 8192
    s_sub_u32 s40, s23, s22
    s_lshr_b32 s23, s36, 1
    s_add_u32 s23, s23, 8192
    s_sub_u32 s41, s23, s22
    s_lshr_b32 s23, s38, 1
    s_add_u32 s23, s23, 8192
    s_sub_u32 s42, s23, s22
    s_mul_i32 s22, s9, 401408
    s_mul_i32 s23, s8, 100352
    s_add_u32 s22, s22, s23
    s_add_u32 s22, s22, 0x0
    s_mul_i32 s21, s8, 8320
    s_add_u32 s21, s21, 16384
    s_lshr_b32 s24, s8, 1
    s_mul_i32 s15, s24, 448
    s_and_b32 s24, s8, 1
    s_mul_i32 s24, s24, 192
    s_add_u32 s15, s15, s24
    s_add_u32 s16, s15, 3584
    s_sub_u32 s24, 192, s24
    s_mov_b32 s54, 1835008
    s_mov_b32 s55, 0x00020000
    v_bfe_u32 v2, v0, 4, 1
    v_lshlrev_b32 v2, 3, v2
    v_xor_b32 v2, v2, v0
    v_and_b32 v2, 15, v2
    v_add_u32 v3, 4, v2
    v_lshrrev_b32 v3, 4, v3
    v_mul_u32_u24 v3, s24, v3
    v_lshl_add_u32 v3, v2, 4, v3
    s_add_u32 s24, s21, 128
    v_mov_b32 v98, v3
    v_bfe_u32 v1, v0, 4, 2
    s_mov_b32 s28, 7168
    v_mad_u32_u24 v98, v1, s28, v98
    v_mov_b32 v96, s21
    v_bfe_u32 v1, v0, 0, 3
    s_mov_b32 s28, 1040
    v_mad_u32_u24 v96, v1, s28, v96
    v_bfe_u32 v1, v0, 3, 1
    s_mov_b32 s28, 384
    v_mad_u32_u24 v96, v1, s28, v96
    v_bfe_u32 v1, v0, 5, 1
    v_lshl_add_u32 v96, v1, 5, v96
    v_bfe_u32 v1, v0, 4, 1
    v_lshl_add_u32 v96, v1, 2, v96
    v_mov_b32 v97, s24
    v_bfe_u32 v1, v0, 0, 3
    s_mov_b32 s28, 1040
    v_mad_u32_u24 v97, v1, s28, v97
    v_bfe_u32 v1, v0, 3, 1
    v_lshl_add_u32 v97, v1, 7, v97
    v_bfe_u32 v1, v0, 4, 1
    v_lshl_add_u32 v97, v1, 6, v97
    v_bfe_u32 v1, v0, 5, 1
    v_lshl_add_u32 v97, v1, 2, v97
    ds_write_b96 v113, v[96:98] offset:49664
    s_waitcnt lgkmcnt(0)
    s_and_b32 s53, s53, 0xffff
    s_add_u32 m0, s21, 0
    s_nop 0
    buffer_load_dwordx4 v98, s[52:55], s15 offen lds
    s_add_u32 m0, s21, 144
    s_nop 0
    buffer_load_dwordx4 v98, s[52:55], s15 offen offset:896 lds
    s_add_u32 m0, s21, 288
    s_nop 0
    buffer_load_dwordx4 v98, s[52:55], s15 offen offset:1792 lds
    s_add_u32 m0, s21, 432
    s_nop 0
    buffer_load_dwordx4 v98, s[52:55], s15 offen offset:2688 lds
    s_add_u32 m0, s21, 4160
    s_nop 0
    buffer_load_dwordx4 v98, s[52:55], s16 offen lds
    s_add_u32 m0, s21, 4304
    s_nop 0
    buffer_load_dwordx4 v98, s[52:55], s16 offen offset:896 lds
    s_add_u32 m0, s21, 4448
    s_nop 0
    buffer_load_dwordx4 v98, s[52:55], s16 offen offset:1792 lds
    s_add_u32 m0, s21, 4592
    s_nop 0
    buffer_load_dwordx4 v98, s[52:55], s16 offen offset:2688 lds
    s_add_u32 s32, s22, s32
    s_add_u32 s33, s22, s33
    s_add_u32 s34, s22, s34
    s_add_u32 s35, s22, s35
    s_add_u32 s36, s22, s36
    s_add_u32 s37, s22, s37
    s_add_u32 s38, s22, s38
    s_lshl_b32 s100, s9, 7
    s_add_u32 s100, s100, 0x4800800
.wd_18:
    buffer_load_dword v1, off, s[4:7], s100 sc1
    s_sub_u32 s19, s19, 1
    s_cbranch_scc1 .abort
    s_waitcnt vmcnt(0)
    v_readfirstlane_b32 s101, v1
    s_bfe_u32 s101, s101, 0x80000
    s_cmp_ge_u32 s101, 28
    s_cbranch_scc1 .wdg_19
    s_sleep 2
    s_branch .wd_18
.wdg_19:
    s_add_u32 s23, s32, 0
    buffer_load_dwordx4 a[0:3], v9, s[4:7], s23 offen
    buffer_load_dwordx4 a[4:7], v9, s[4:7], s23 offen offset:1024
    s_add_u32 s23, s33, 14336
    buffer_load_dwordx4 a[64:67], v9, s[4:7], s23 offen
    buffer_load_dwordx4 a[68:71], v9, s[4:7], s23 offen offset:1024
    s_add_u32 s23, s34, 28672
    buffer_load_dwordx4 a[128:131], v9, s[4:7], s23 offen
    buffer_load_dwordx4 a[132:135], v9, s[4:7], s23 offen offset:1024
    s_add_u32 s23, s35, 43008
    buffer_load_dwordx4 a[192:195], v9, s[4:7], s23 offen
    buffer_load_dwordx4 a[196:199], v9, s[4:7], s23 offen offset:1024
    s_add_u32 s23, s36, 57344
    buffer_load_dwordx4 v[120:123], v9, s[4:7], s23 offen
    buffer_load_dwordx4 v[124:127], v9, s[4:7], s23 offen offset:1024
    s_add_u32 s23, s37, 71680
    buffer_load_dwordx4 v[184:187], v9, s[4:7], s23 offen
    buffer_load_dwordx4 v[188:191], v9, s[4:7], s23 offen offset:1024
    s_add_u32 s23, s38, 86016
    buffer_load_dwordx4 v[248:251], v9, s[4:7], s23 offen
    buffer_load_dwordx4 v[252:255], v9, s[4:7], s23 offen offset:1024
    s_add_u32 s23, s33, 0
    buffer_load_dwordx4 a[8:11], v9, s[4:7], s23 offen
    buffer_load_dwordx4 a[12:15], v9, s[4:7], s23 offen offset:1024
    s_add_u32 s23, s34, 14336
    buffer_load_dwordx4 a[72:75], v9, s[4:7], s23 offen
    buffer_load_dwordx4 a[76:79], v9, s[4:7], s23 offen offset:1024
    s_add_u32 s23, s35, 28672
    buffer_load_dwordx4 a[136:139], v9, s[4:7], s23 offen
    buffer_load_dwordx4 a[140:143], v9, s[4:7], s23 offen offset:1024
    s_waitcnt vmcnt(4)
    buffer_load_dword v1, off, s[4:7], s100 sc1
    s_add_u32 s23, s36, 43008
    buffer_load_dwordx4 a[200:203], v9, s[4:7], s23 offen
    buffer_load_dwordx4 a[204:207], v9, s[4:7], s23 offen offset:1024
    s_add_u32 s23, s37, 57344
    buffer_load_dwordx4 v[128:131], v9, s[4:7], s23 offen
    buffer_load_dwordx4 v[132:135], v9, s[4:7], s23 offen offset:1024
    s_add_u32 s23, s38, 71680
    buffer_load_dwordx4 v[192:195], v9, s[4:7], s23 offen
    buffer_load_dwordx4 v[196:199], v9, s[4:7], s23 offen offset:1024
    s_add_u32 s23, s32, 86016
    buffer_load_dwordx4 v[200:203], v9, s[4:7], s23 offen
    buffer_load_dwordx4 v[204:207], v9, s[4:7], s23 offen offset:1024
    s_waitcnt vmcnt(8)
.stl_20:
    v_readfirstlane_b32 s101, v1
    s_bfe_u32 s101, s101, 0x80008
    s_cmp_lt_u32 s101, 28
    s_cbranch_scc1 .stf_21
    s_add_u32 s23, s34, 0
    buffer_load_dwordx4 a[16:19], v9, s[4:7], s23 offen
    buffer_load_dwordx4 a[20:23], v9, s[4:7], s23 offen offset:1024
    s_add_u32 s23, s35, 14336
    buffer_load_dwordx4 a[80:83], v9, s[4:7], s23 offen
    buffer_load_dwordx4 a[84:87], v9, s[4:7], s23 offen offset:1024
    s_add_u32 s23, s36, 28672
    buffer_load_dwordx4 a[144:147], v9, s[4:7], s23 offen
    buffer_load_dwordx4 a[148:151], v9, s[4:7], s23 offen offset:1024
    s_add_u32 s23, s37, 43008
    buffer_load_dwordx4 a[208:211], v9, s[4:7], s23 offen
    buffer_load_dwordx4 a[212:215], v9, s[4:7], s23 offen offset:1024
    s_add_u32 s23, s38, 57344
    buffer_load_dwordx4 v[136:139], v9, s[4:7], s23 offen
    buffer_load_dwordx4 v[140:143], v9, s[4:7], s23 offen offset:1024
    s_add_u32 s23, s32, 71680
    buffer_load_dwordx4 v[144:147], v9, s[4:7], s23 offen
    buffer_load_dwordx4 v[148:151], v9, s[4:7], s23 offen offset:1024
    s_add_u32 s23, s33, 86016
    buffer_load_dwordx4 v[208:211], v9, s[4:7], s23 offen
    buffer_load_dwordx4 v[212:215], v9, s[4:7], s23 offen offset:1024
    s_add_u32 s23, s35, 0
    buffer_load_dwordx4 a[24:27], v9, s[4:7], s23 offen
    buffer_load_dwordx4 a[28:31], v9, s[4:7], s23 offen offset:1024
    s_add_u32 s23, s36, 14336
    buffer_load_dwordx4 a[88:91], v9, s[4:7], s23 offen
    buffer_load_dwordx4 a[92:95], v9, s[4:7], s23 offen offset:1024
    s_add_u32 s23, s37, 28672
    buffer_load_dwordx4 a[152:155], v9, s[4:7], s23 offen
    buffer_load_dwordx4 a[156:159], v9, s[4:7], s23 offen offset:1024
    s_waitcnt vmcnt(4)
    buffer_load_dword v1, off, s[4:7], s100 sc1
    s_add_u32 s23, s38, 43008
    buffer_load_dwordx4 a[216:219], v9, s[4:7], s23 offen
    buffer_load_dwordx4 a[220:223], v9, s[4:7], s23 offen offset:1024
    s_add_u32 s23, s32, 57344
    buffer_load_dwordx4 a[224:227], v9, s[4:7], s23 offen
    buffer_load_dwordx4 a[228:231], v9, s[4:7], s23 offen offset:1024
    s_add_u32 s23, s33, 71680
    buffer_load_dwordx4 v[152:155], v9, s[4:7], s23 offen
    buffer_load_dwordx4 v[156:159], v9, s[4:7], s23 offen offset:1024
    s_add_u32 s23, s34, 86016
    buffer_load_dwordx4 v[216:219], v9, s[4:7], s23 offen
    buffer_load_dwordx4 v[220:223], v9, s[4:7], s23 offen offset:1024
    s_waitcnt vmcnt(8)
.stl_22:
    v_readfirstlane_b32 s101, v1
    s_bfe_u32 s101, s101, 0x80010
    s_cmp_lt_u32 s101, 28
    s_cbranch_scc1 .stf_23
    s_add_u32 s23, s36, 0
    buffer_load_dwordx4 a[32:35], v9, s[4:7], s23 offen
    buffer_load_dwordx4 a[36:39], v9, s[4:7], s23 offen offset:1024
    s_add_u32 s23, s37, 14336
    buffer_load_dwordx4 a[96:99], v9, s[4:7], s23 offen
    buffer_load_dwordx4 a[100:103], v9, s[4:7], s23 offen offset:1024
    s_add_u32 s23, s38, 28672
    buffer_load_dwordx4 a[160:163], v9, s[4:7], s23 offen
    buffer_load_dwordx4 a[164:167], v9, s[4:7], s23 offen offset:1024
    s_add_u32 s23, s32, 43008
    buffer_load_dwordx4 a[168:171], v9, s[4:7], s23 offen
    buffer_load_dwordx4 a[172:175], v9, s[4:7], s23 offen offset:1024
    s_add_u32 s23, s33, 57344
    buffer_load_dwordx4 a[232:235], v9, s[4:7], s23 offen
    buffer_load_dwordx4 a[236:239], v9, s[4:7], s23 offen offset:1024
    s_add_u32 s23, s34, 71680
    buffer_load_dwordx4 v[160:163], v9, s[4:7], s23 offen
    buffer_load_dwordx4 v[164:167], v9, s[4:7], s23 offen offset:1024
    s_add_u32 s23, s35, 86016
    buffer_load_dwordx4 v[224:227], v9, s[4:7], s23 offen
    buffer_load_dwordx4 v[228:231], v9, s[4:7], s23 offen offset:1024
    s_add_u32 s23, s37, 0
    buffer_load_dwordx4 a[40:43], v9, s[4:7], s23 offen
    buffer_load_dwordx4 a[44:47], v9, s[4:7], s23 offen offset:1024
    s_add_u32 s23, s38, 14336
    buffer_load_dwordx4 a[104:107], v9, s[4:7], s23 offen
    buffer_load_dwordx4 a[108:111], v9, s[4:7], s23 offen offset:1024
    s_add_u32 s23, s32, 28672
    buffer_load_dwordx4 a[112:115], v9, s[4:7], s23 offen
    buffer_load_dwordx4 a[116:119], v9, s[4:7], s23 offen offset:1024
    s_add_u32 s23, s33, 43008
    buffer_load_dwordx4 a[176:179], v9, s[4:7], s23 offen
    buffer_load_dwordx4 a[180:183], v9, s[4:7], s23 offen offset:1024
    s_add_u32 s23, s34, 57344
    buffer_load_dwordx4 a[240:243], v9, s[4:7], s23 offen
    buffer_load_dwordx4 a[244:247], v9, s[4:7], s23 offen offset:1024
    s_add_u32 s23, s35, 71680
    buffer_load_dwordx4 v[168:171], v9, s[4:7], s23 offen
    buffer_load_dwordx4 v[172:175], v9, s[4:7], s23 offen offset:1024
    s_add_u32 s23, s36, 86016
    buffer_load_dwordx4 v[232:235], v9, s[4:7], s23 offen
    buffer_load_dwordx4 v[236:239], v9, s[4:7], s23 offen offset:1024
    s_add_u32 s23, s38, 0
    buffer_load_dwordx4 a[48:51], v9, s[4:7], s23 offen
    buffer_load_dwordx4 a[52:55], v9, s[4:7], s23 offen offset:1024
    s_add_u32 s23, s32, 14336
    buffer_load_dwordx4 a[56:59], v9, s[4:7], s23 offen
    buffer_load_dwordx4 a[60:63], v9, s[4:7], s23 offen offset:1024
    s_add_u32 s23, s33, 28672
    buffer_load_dwordx4 a[120:123], v9, s[4:7], s23 offen
    buffer_load_dwordx4 a[124:127], v9, s[4:7], s23 offen offset:1024
    s_add_u32 s23, s34, 43008
    buffer_load_dwordx4 a[184:187], v9, s[4:7], s23 offen
    buffer_load_dwordx4 a[188:191], v9, s[4:7], s23 offen offset:1024
    s_add_u32 s23, s35, 57344
    buffer_load_dwordx4 a[248:251], v9, s[4:7], s23 offen
    buffer_load_dwordx4 a[252:255], v9, s[4:7], s23 offen offset:1024
    s_add_u32 s23, s36, 71680
    buffer_load_dwordx4 v[176:179], v9, s[4:7], s23 offen
    buffer_load_dwordx4 v[180:183], v9, s[4:7], s23 offen offset:1024
    s_add_u32 s23, s37, 86016
    buffer_load_dwordx4 v[240:243], v9, s[4:7], s23 offen
    buffer_load_dwordx4 v[244:247], v9, s[4:7], s23 offen offset:1024
    v_and_b32 v1, 2, v0
    v_mov_b32 v2, 0x4444
    v_mov_b32 v3, 0xeeee
    v_cmp_eq_u32 vcc, 0, v1
    s_nop 1
    v_cndmask_b32 v112, v3, v2, vcc
    v_bfe_u32 v1, v0, 2, 2
    v_bfe_u32 v2, v0, 4, 2
    v_xor_b32 v1, v1, v2
    v_and_b32 v2, 3, v0
    v_lshl_or_b32 v3, v1, 2, v2
    v_mov_b32 v4, 0x3f80
    v_mov_b32 v5, 0x3f800000
    v_cmp_eq_u32 vcc, 0, v3
    v_cmp_eq_u32 s[22:23], 1, v3
    s_nop 1
    v_cndmask_b32 v6, 0, v4, vcc
    v_cndmask_b32 v7, 0, v5, s[22:23]
    v_or_b32 v108, v6, v7
    v_cmp_eq_u32 vcc, 2, v3
    v_cmp_eq_u32 s[22:23], 3, v3
    s_nop 1
    v_cndmask_b32 v6, 0, v4, vcc
    v_cndmask_b32 v7, 0, v5, s[22:23]
    v_or_b32 v109, v6, v7
    s_and_b32 s24, s8, 1
    s_cmp_eq_u32 s24, 1
    s_cselect_b64 s[22:23], -1, 0
    v_cndmask_b32 v110, v108, v109, s[22:23]
    v_mov_b32 v111, 0
    s_lshr_b32 s25, s8, 1
    s_mul_i32 s25, s25, 28
    s_mul_i32 s26, s24, 12
    s_add_u32 s25, s25, s26
    s_lshl_b32 s25, s25, 7
    s_add_u32 s25, s25, 8192
    s_sub_u32 s26, 16, s26
    s_lshl_b32 s26, s26, 7
    v_mov_b32 v114, s25
    v_bfe_u32 v1, v0, 5, 1
    v_lshl_add_u32 v114, v1, 8, v114
    v_bfe_u32 v1, v0, 1, 2
    v_lshl_add_u32 v114, v1, 6, v114
    v_bfe_u32 v1, v0, 4, 1
    v_lshl_add_u32 v114, v1, 5, v114
    v_bfe_u32 v1, v0, 0, 1
    v_lshl_add_u32 v114, v1, 4, v114
    s_add_u32 s25, s25, 1024
    v_mov_b32 v115, s25
    v_bfe_u32 v1, v0, 1, 2
    v_lshl_add_u32 v115, v1, 6, v115
    v_bfe_u32 v1, v0, 5, 1
    v_lshl_add_u32 v115, v1, 5, v115
    v_bfe_u32 v1, v0, 0, 1
    v_lshl_add_u32 v115, v1, 4, v115
    v_bfe_u32 v1, v0, 4, 1
    v_mad_u32_u24 v115, v1, s26, v115
    s_lshl_b32 s22, s9, 9
    s_lshl_b32 s23, s8, 6
    s_add_u32 s22, s22, s23
    s_lshr_b32 s23, s9, 2
    s_lshl_b32 s23, s23, 9
    s_lshl_b32 s24, s8, 5
    s_add_u32 s23, s23, s24
    s_and_b32 s24, s9, 1
    s_lshl_b32 s24, s24, 4
    s_add_u32 s23, s23, s24
    s_and_b32 s24, s9, 2
    s_lshl_b32 s24, s24, 1
    s_add_u32 s23, s23, s24
    s_add_u32 s23, s23, 8192
    s_mul_i32 s24, s8, 448
    s_add_u32 s25, s24, 64
    v_and_b32 v2, 16, v0
    v_cmp_ne_u32 vcc, 0, v2
    v_mov_b32 v2, s22
    v_bfe_u32 v1, v0, 3, 1
    v_lshl_add_u32 v2, v1, 8, v2
    v_bfe_u32 v1, v0, 2, 1
    v_lshl_add_u32 v2, v1, 5, v2
    v_bfe_u32 v1, v0, 5, 1
    v_lshl_add_u32 v2, v1, 4, v2
    v_bfe_u32 v1, v0, 0, 2
    v_lshl_add_u32 v2, v1, 2, v2
    v_mov_b32 v3, s23
    v_bfe_u32 v1, v0, 0, 2
    v_lshl_add_u32 v3, v1, 7, v3
    v_bfe_u32 v1, v0, 5, 1
    v_lshl_add_u32 v3, v1, 3, v3
    v_cndmask_b32 v116, v2, v3, vcc
    v_mov_b32 v2, s25
    v_bfe_u32 v1, v0, 5, 1
    s_mov_b32 s28, 224
    v_mad_u32_u24 v2, v1, s28, v2
    v_bfe_u32 v1, v0, 0, 1
    v_lshl_add_u32 v2, v1, 6, v2
    v_bfe_u32 v1, v0, 3, 1
    v_lshl_add_u32 v2, v1, 5, v2
    v_bfe_u32 v1, v0, 1, 1
    v_lshl_add_u32 v2, v1, 4, v2
    v_bfe_u32 v1, v0, 2, 1
    v_lshl_add_u32 v2, v1, 3, v2
    v_mov_b32 v3, s24
    v_bfe_u32 v1, v0, 5, 1
    s_mov_b32 s28, 224
    v_mad_u32_u24 v3, v1, s28, v3
    v_bfe_u32 v1, v0, 0, 2
    v_lshl_add_u32 v3, v1, 3, v3
    v_cndmask_b32 v118, v2, v3, vcc
    s_mul_i32 s24, s8, 1792
    v_mov_b32 v117, s24
    v_bfe_u32 v1, v0, 4, 2
    s_mov_b32 s28, 448
    v_mad_u32_u24 v117, v1, s28, v117
    v_bfe_u32 v1, v0, 0, 4
    v_lshl_add_u32 v117, v1, 2, v117
    s_mov_b32 s11, 0
    s_mov_b32 s14, 0x4100000
.wd_24:
    buffer_load_dword v1, off, s[92:95], 0 offset:132 sc1
    s_sub_u32 s19, s19, 1
    s_cbranch_scc1 .abort
    s_waitcnt vmcnt(0)
    v_readfirstlane_b32 s101, v1
    s_and_b32 s100, s101, 0x2020
    s_cmp_eq_u32 s100, 0x2020
    s_cbranch_scc1 .wdg_25
    s_sleep 2
    s_branch .wd_24
.wdg_25:
    s_bfe_u32 s18, s101, 0x80010
    v_mov_b32 v28, 0
    v_mov_b32 v29, 0
    v_mov_b32 v30, 0
    v_mov_b32 v31, 0
    v_mov_b32 v32, 0
    v_mov_b32 v33, 0
    v_mov_b32 v34, 0
    v_mov_b32 v35, 0
    v_mov_b32 v36, 0
    v_mov_b32 v37, 0
    v_mov_b32 v38, 0
    v_mov_b32 v39, 0
    v_mov_b32 v40, 0
    v_mov_b32 v41, 0
    v_mov_b32 v42, 0
    v_mov_b32 v43, 0
    v_mov_b32 v44, 0
    v_mov_b32 v45, 0
    v_mov_b32 v46, 0
    v_mov_b32 v47, 0
    v_mov_b32 v48, 0
    v_mov_b32 v49, 0
    v_mov_b32 v50, 0
    v_mov_b32 v51, 0
    v_mov_b32 v52, 0
    v_mov_b32 v53, 0
    v_mov_b32 v54, 0
    v_mov_b32 v55, 0
    v_mov_b32 v2, -1
    v_mov_b32 v3, -1
    ds_write_b64 v118, v[2:3] offset:0
    ds_write_b64 v118, v[2:3] offset:1792
    ds_write_b64 v118, v[2:3] offset:3584
    ds_write_b64 v118, v[2:3] offset:5376
    s_movk_i32 s45, 2000
.sc_loop_26:
    ds_read_b96 v[96:98], v113 offset:49664
    v_mov_b32 v99, 0
    v_mov_b32 v100, 0
    v_mov_b32 v101, 0
    v_mov_b32 v102, 0
    v_mov_b32 v103, 0
    v_mov_b32 v104, 0
    v_mov_b32 v105, 0
    v_mov_b32 v106, 0
    v_mov_b32 v107, 0
    v_add_u32 v8, s40, v113
    v_add_u32 v16, s41, v113
    v_add_u32 v24, s42, v113
    s_add_u32 s15, s15, 28672
    s_add_u32 s16, s16, 28672
    s_waitcnt vmcnt(0) lgkmcnt(0)
    ds_read2_b32 v[64:65], v96 offset0:0 offset1:2
    ds_read2_b32 v[66:67], v96 offset0:4 offset1:6
    ds_read2_b32 v[68:69], v96 offset0:16 offset1:18
    ds_read2_b32 v[70:71], v96 offset0:20 offset1:22
    ds_read2_b32 v[72:73], v96 offset0:128 offset1:130
    ds_read2_b32 v[74:75], v96 offset0:132 offset1:134
    ds_read2_b32 v[76:77], v96 offset0:144 offset1:146
    ds_read2_b32 v[78:79], v96 offset0:148 offset1:150
    ds_read2_b32 v[80:81], v97 offset0:0 offset1:2
    ds_read2_b32 v[82:83], v97 offset0:4 offset1:6
    ds_read2_b32 v[84:85], v97 offset0:8 offset1:10
    ds_read2_b32 v[86:87], v97 offset0:12 offset1:14
    ds_read2_b32 v[88:89], v97 offset0:128 offset1:130
    ds_read2_b32 v[90:91], v97 offset0:132 offset1:134
    ds_read2_b32 v[92:93], v97 offset0:136 offset1:138
    ds_read2_b32 v[94:95], v97 offset0:140 offset1:142
    buffer_load_dwordx4 v[0:3], v113, s[4:7], s12 offen sc1
    buffer_load_dwordx4 v[4:7], v113, s[4:7], s13 offen sc1
    s_nop 15
    s_nop 7
    buffer_load_dwordx4 v[0:3], v113, s[4:7], s12 offen sc1
    buffer_load_dwordx4 v[4:7], v113, s[4:7], s13 offen sc1
    s_nop 15
    s_nop 7
.sp_27:
    buffer_load_dwordx4 v[0:3], v113, s[4:7], s12 offen sc1
    buffer_load_dwordx4 v[4:7], v113, s[4:7], s13 offen sc1
    s_sub_u32 s19, s19, 1
    s_cbranch_scc1 .abort
    v_mov_b64 v[28:29], 0
    v_mov_b64 v[30:31], 0
    s_waitcnt vmcnt(4)
    v_max_u32 v119, v0, v4
    v_cmp_eq_u32 vcc, -1, v119
    v_smfmac_f32_16x16x64_bf16 v[28:31], v[0:3], a[0:7], v112
    s_cbranch_vccnz .sp_27
    ds_write_b128 v113, v[0:3] offset:8192
    v_smfmac_f32_16x16x64_bf16 v[32:35], v[0:3], a[56:63], v112
    ds_write_b128 v113, v[4:7] offset:9216
    v_smfmac_f32_16x16x64_bf16 v[36:39], v[0:3], a[112:119], v112
    v_mov_b32 v96, 0
    v_smfmac_f32_16x16x64_bf16 v[40:43], v[0:3], a[168:175], v112
    v_mov_b32 v97, 0
    v_smfmac_f32_16x16x64_bf16 v[44:47], v[0:3], a[224:231], v112
    v_smfmac_f32_16x16x64_bf16 v[48:51], v[0:3], v[144:151], v112
    s_waitcnt lgkmcnt(0)
    s_barrier
    ds_read_b128 v[12:15], v8 offset:1024
    v_smfmac_f32_16x16x64_bf16 v[52:55], v[0:3], v[200:207], v112
    ds_read_b128 v[8:11], v8
    ds_read_b128 v[20:23], v16 offset:1024
    ds_read_b128 v[16:19], v16
    v_smfmac_f32_16x16x64_bf16 v[28:31], v[4:7], a[8:15], v112
    ds_read_b128 v[24:27], v24
    ds_read_b128 v[56:59], v114
    ds_read_b128 v[60:63], v114 offset:512
    s_add_u32 m0, s21, 0
    v_smfmac_f32_16x16x64_bf16 v[32:35], v[4:7], a[64:71], v112
    buffer_load_dwordx4 v98, s[52:55], s15 offen lds
    v_smfmac_f32_16x16x64_bf16 v[36:39], v[4:7], a[120:127], v112
    v_smfmac_f32_16x16x64_bf16 v[40:43], v[4:7], a[176:183], v112
    s_add_u32 m0, s21, 144
    v_smfmac_f32_16x16x64_bf16 v[44:47], v[4:7], a[232:239], v112
    buffer_load_dwordx4 v98, s[52:55], s15 offen offset:896 lds
    v_smfmac_f32_16x16x64_bf16 v[48:51], v[4:7], v[152:159], v112
    v_smfmac_f32_16x16x64_bf16 v[52:55], v[4:7], v[208:215], v112
    s_waitcnt lgkmcnt(0)
    s_add_u32 m0, s21, 288
    v_smfmac_f32_16x16x64_bf16 v[28:31], v[8:11], a[16:23], v112
    buffer_load_dwordx4 v98, s[52:55], s15 offen offset:1792 lds
    v_smfmac_f32_16x16x64_bf16 v[28:31], v[12:15], a[24:31], v112
    v_smfmac_f32_16x16x64_bf16 v[28:31], v[16:19], a[32:39], v112
    s_add_u32 m0, s21, 432
    v_smfmac_f32_16x16x64_bf16 v[28:31], v[20:23], a[40:47], v112
    buffer_load_dwordx4 v98, s[52:55], s15 offen offset:2688 lds
    v_smfmac_f32_16x16x64_bf16 v[28:31], v[24:27], a[48:55], v112
    v_smfmac_f32_16x16x64_bf16 v[32:35], v[8:11], a[72:79], v112
    s_add_u32 m0, s21, 4160
    s_waitcnt vmcnt(4)
    ds_read_b128 v[0:3], v115
    ds_read_b128 v[4:7], v115 offset:256
    v_smfmac_f32_16x16x64_bf16 v[32:35], v[12:15], a[80:87], v112
    buffer_load_dwordx4 v98, s[52:55], s16 offen lds
    v_add_f32 v28, v28, v30
    v_smfmac_f32_16x16x64_bf16 v[32:35], v[16:19], a[88:95], v112
    v_add_f32 v29, v29, v31
    v_smfmac_f32_16x16x64_bf16 v[32:35], v[20:23], a[96:103], v112
    s_add_u32 m0, s21, 4304
    v_cvt_pk_bf16_f32 v30, v28, v29
    v_smfmac_f32_16x16x64_bf16 v[32:35], v[24:27], a[104:111], v112
    buffer_load_dwordx4 v98, s[52:55], s16 offen offset:896 lds
    v_smfmac_f32_16x16x64_bf16 v[36:39], v[8:11], a[128:135], v112
    v_smfmac_f32_16x16x64_bf16 v[36:39], v[12:15], a[136:143], v112
    s_add_u32 m0, s21, 4448
    v_add_f32 v32, v32, v34
    v_smfmac_f32_16x16x64_bf16 v[36:39], v[16:19], a[144:151], v112
    buffer_load_dwordx4 v98, s[52:55], s16 offen offset:1792 lds
    v_add_f32 v33, v33, v35
    v_smfmac_f32_16x16x64_bf16 v[36:39], v[20:23], a[152:159], v112
    v_cvt_pk_bf16_f32 v31, v32, v33
    v_smfmac_f32_16x16x64_bf16 v[36:39], v[24:27], a[160:167], v112
    s_add_u32 m0, s21, 4592
    v_mfma_f32_16x16x16_bf16 v[32:35], v[30:31], v[108:109], 0
    buffer_load_dwordx4 v98, s[52:55], s16 offen offset:2688 lds
    s_waitcnt lgkmcnt(0)
    v_smfmac_f32_16x16x64_bf16 v[40:43], v[8:11], a[184:191], v112
    v_add_f32 v36, v36, v38
    v_smfmac_f32_16x16x64_bf16 v[40:43], v[12:15], a[192:199], v112
    v_add_f32 v37, v37, v39
    v_smfmac_f32_16x16x64_bf16 v[40:43], v[16:19], a[200:207], v112
    v_cvt_pk_bf16_f32 v38, v36, v37
    v_smfmac_f32_16x16x64_bf16 v[40:43], v[20:23], a[208:215], v112
    v_cvt_pk_bf16_f32 v28, v32, v33
    v_smfmac_f32_16x16x64_bf16 v[40:43], v[24:27], a[216:223], v112
    v_cvt_pk_bf16_f32 v29, v34, v35
    v_smfmac_f32_16x16x64_bf16 v[44:47], v[8:11], a[240:247], v112
    v_mov_b32 v33, 0
    v_smfmac_f32_16x16x64_bf16 v[44:47], v[12:15], a[248:255], v112
    v_add_f32 v40, v40, v42
    v_smfmac_f32_16x16x64_bf16 v[44:47], v[16:19], v[120:127], v112
    v_add_f32 v41, v41, v43
    v_smfmac_f32_16x16x64_bf16 v[44:47], v[20:23], v[128:135], v112
    v_cvt_pk_bf16_f32 v39, v40, v41
    v_smfmac_f32_16x16x64_bf16 v[44:47], v[24:27], v[136:143], v112
    s_add_u32 s12, s12, 16384
    s_add_u32 s13, s13, 16384
    v_mov_b32 v98, 0
    v_mfma_f32_16x16x16_bf16 v[40:43], v[38:39], v[108:109], 0
    v_smfmac_f32_16x16x64_bf16 v[48:51], v[8:11], v[160:167], v112
    v_add_f32 v44, v44, v46
    v_smfmac_f32_16x16x64_bf16 v[48:51], v[12:15], v[168:175], v112
    v_add_f32 v45, v45, v47
    v_smfmac_f32_16x16x64_bf16 v[48:51], v[16:19], v[176:183], v112
    v_cvt_pk_bf16_f32 v46, v44, v45
    v_smfmac_f32_16x16x64_bf16 v[48:51], v[20:23], v[184:191], v112
    v_cvt_pk_bf16_f32 v30, v40, v41
    v_smfmac_f32_16x16x64_bf16 v[48:51], v[24:27], v[192:199], v112
    v_cvt_pk_bf16_f32 v31, v42, v43
    v_smfmac_f32_16x16x64_bf16 v[52:55], v[8:11], v[216:223], v112
    v_smfmac_f32_16x16x64_bf16 v[52:55], v[12:15], v[224:231], v112
    v_add_f32 v48, v48, v50
    v_smfmac_f32_16x16x64_bf16 v[52:55], v[16:19], v[232:239], v112
    v_add_f32 v49, v49, v51
    v_smfmac_f32_16x16x64_bf16 v[52:55], v[20:23], v[240:247], v112
    v_cvt_pk_bf16_f32 v47, v48, v49
    v_smfmac_f32_16x16x64_bf16 v[52:55], v[24:27], v[248:255], v112
    v_smfmac_f32_16x16x64_bf16 v[100:103], v[28:31], v[64:71], v112
    v_mfma_f32_16x16x16_bf16 v[48:51], v[46:47], v[108:109], 0
    v_add_f32 v52, v52, v54
    v_add_f32 v53, v53, v55
    v_cvt_pk_bf16_f32 v32, v52, v53
    v_smfmac_f32_16x16x64_bf16 v[96:99], v[28:31], v[56:63], v112
    v_mfma_f32_16x16x16_bf16 v[52:55], v[32:33], v[110:111], 0
    v_cvt_pk_bf16_f32 v36, v48, v49
    v_cvt_pk_bf16_f32 v37, v50, v51
    v_smfmac_f32_16x16x64_bf16 v[104:107], v[28:31], v[72:79], v112
    s_nop 3
    v_cvt_pk_bf16_f32 v38, v52, v53
    v_cvt_pk_bf16_f32 v39, v54, v55
    s_nop 1
    v_smfmac_f32_16x16x64_bf16 v[100:103], v[36:39], v[80:87], v112
    v_smfmac_f32_16x16x64_bf16 v[96:99], v[36:39], v[0:7], v112
    v_smfmac_f32_16x16x64_bf16 v[104:107], v[36:39], v[88:95], v112
    v_add_f32 v100, v100, v102
    v_add_f32 v101, v101, v103
    ds_write2_b32 v117, v100, v101 offset0:16 offset1:72
    v_add_f32 v96, v96, v98
    v_add_f32 v97, v97, v99
    ds_write2_b32 v117, v96, v97 offset0:0 offset1:56
    v_add_f32 v104, v104, v106
    v_add_f32 v105, v105, v107
    ds_write2_b32 v117, v104, v105 offset0:32 offset1:88
    v_mov_b32 v28, 0
    v_mov_b32 v29, 0
    v_mov_b32 v30, 0
    v_mov_b32 v31, 0
.sc_rt_28:
    ds_read_b64 v[56:57], v118 offset:0
    v_mov_b32 v32, 0
    ds_read_b64 v[58:59], v118 offset:1792
    v_mov_b32 v33, 0
    ds_read_b64 v[60:61], v118 offset:3584
    v_mov_b32 v34, 0
    ds_read_b64 v[62:63], v118 offset:5376
    v_mov_b32 v35, 0
    s_nop 1
    v_mov_b32 v36, 0
    s_nop 1
    v_mov_b32 v37, 0
    s_waitcnt lgkmcnt(2)
    v_pk_add_f32 v[56:57], v[56:57], v[58:59]
    s_waitcnt lgkmcnt(0)
    v_pk_add_f32 v[60:61], v[60:61], v[62:63]
    v_pk_add_f32 v[56:57], v[56:57], v[60:61]
    v_max_f32 v58, v56, v57
    v_cmp_u_f32 vcc, v56, v57
    s_cmp_eq_u32 s18, 0
    v_max_f32_dpp v58, v58, v58 row_ror:8 row_mask:0xf bank_mask:0xf
    s_cmp_eq_u32 s18, 0
    s_nop 0
    v_max_f32_dpp v58, v58, v58 row_ror:4 row_mask:0xf bank_mask:0xf
    s_cbranch_vccnz .sc_rf_29
.sc_rb_30:
    s_nop 0
    v_max_f32_dpp v58, v58, v58 row_ror:2 row_mask:0xf bank_mask:0xf
    s_nop 1
    v_max_f32_dpp v58, v58, v58 row_ror:1 row_mask:0xf bank_mask:0xf
    v_mov_b32 v59, v58
    s_nop 1
    v_permlane16_swap_b32 v58, v59
    v_max_f32 v58, v58, v59
    v_sub_f32 v56, v56, v58
    v_sub_f32 v57, v57, v58
    v_exp_f32 v56, v56
    v_exp_f32 v57, v57
    s_nop 0
    v_add_f32 v58, v56, v57
    s_nop 1
    v_add_f32_dpp v58, v58, v58 row_ror:8 row_mask:0x5 bank_mask:0xf
    s_nop 1
    v_add_f32_dpp v58, v58, v58 row_ror:4 row_mask:0x5 bank_mask:0xf
    s_nop 1
    v_add_f32_dpp v58, v58, v58 row_ror:2 row_mask:0xf bank_mask:0xf
    s_nop 1
    v_add_f32_dpp v58, v58, v58 row_ror:1 row_mask:0xf bank_mask:0xf
    v_mov_b32 v59, v58
    s_nop 1
    v_permlane16_swap_b32 v58, v59
    v_add_f32 v58, v58, v59
    v_rcp_f32 v58, v58
    s_nop 0
    v_mul_f32 v56, v56, v58
    v_mul_f32 v57, v57, v58
    v_cvt_pk_bf16_f32 v56, v56, v57
    v_min_u32 v56, -2, v56
    s_cbranch_scc0 .slowp_31
    buffer_store_dword v56, v116, s[4:7], s14 offen
.backp_32:
    v_mov_b32 v58, -1
    v_mov_b32 v59, -1
    ds_write_b64 v118, v[58:59] offset:0
    ds_write_b64 v118, v[58:59] offset:1792
    ds_write_b64 v118, v[58:59] offset:3584
    ds_write_b64 v118, v[58:59] offset:5376
    s_movk_i32 s45, 2000
    v_mov_b32 v38, 0
    v_mov_b32 v39, 0
    v_mov_b32 v40, 0
    v_mov_b32 v41, 0
    v_mov_b32 v42, 0
    v_mov_b32 v43, 0
    v_mov_b32 v44, 0
    v_mov_b32 v45, 0
    v_mov_b32 v46, 0
    v_mov_b32 v47, 0
    v_mov_b32 v48, 0
    v_mov_b32 v49, 0
    v_mov_b32 v50, 0
    v_mov_b32 v51, 0
    v_mov_b32 v52, 0
    v_mov_b32 v53, 0
    v_mov_b32 v54, 0
    v_mov_b32 v55, 0
    s_add_u32 s14, s14, 16384
    s_add_u32 s11, s11, 1
    s_sleep 2
    s_cmp_lt_u32 s11, 63
    s_cbranch_scc1 .sc_loop_26
    s_waitcnt vmcnt(0)
    s_endpgm
.stf_21:
    buffer_load_dword v1, off, s[4:7], s100 sc1
    s_sub_u32 s19, s19, 1
    s_cbranch_scc1 .abort
    s_waitcnt vmcnt(0)
    s_branch .stl_20
.stf_23:
    buffer_load_dword v1, off, s[4:7], s100 sc1
    s_sub_u32 s19, s19, 1
    s_cbranch_scc1 .abort
    s_waitcnt vmcnt(0)
    s_branch .stl_22
.slowp_31:
    buffer_store_dword v56, v116, s[4:7], s14 offen sc1
    s_branch .backp_32
.sc_rf_29:
    s_sub_u32 s45, s45, 1
    s_cbranch_scc0 .sc_rt_28
    s_cmp_eq_u32 s18, 0
    s_branch .sc_rb_30
.role_out:
    s_sub_u32 s30, s9, 16
    s_lshr_b32 s25, s30, 1
    s_lshl_b32 s25, s25, 11
    v_lshlrev_b32 v9, 4, v0
    s_lshl_b32 s22, s8, 1
    s_add_u32 s23, s22, 0
    s_cmp_ge_u32 s23, 7
    s_cselect_b32 s24, 7, 0
    s_sub_u32 s23, s23, s24
    s_lshl_b32 s32, s23, 11
    s_add_u32 s23, s22, 1
    s_cmp_ge_u32 s23, 7
    s_cselect_b32 s24, 7, 0
    s_sub_u32 s23, s23, s24
    s_lshl_b32 s33, s23, 11
    s_add_u32 s23, s22, 2
    s_cmp_ge_u32 s23, 7
    s_cselect_b32 s24, 7, 0
    s_sub_u32 s23, s23, s24
    s_lshl_b32 s34, s23, 11
    s_add_u32 s23, s22, 3
    s_cmp_ge_u32 s23, 7
    s_cselect_b32 s24, 7, 0
    s_sub_u32 s23, s23, s24
    s_lshl_b32 s35, s23, 11
    s_add_u32 s23, s22, 4
    s_cmp_ge_u32 s23, 7
    s_cselect_b32 s24, 7, 0
    s_sub_u32 s23, s23, s24
    s_lshl_b32 s36, s23, 11
    s_add_u32 s23, s22, 5
    s_cmp_ge_u32 s23, 7
    s_cselect_b32 s24, 7, 0
    s_sub_u32 s23, s23, s24
    s_lshl_b32 s37, s23, 11
    s_add_u32 s23, s22, 6
    s_cmp_ge_u32 s23, 7
    s_cselect_b32 s24, 7, 0
    s_sub_u32 s23, s23, s24
    s_lshl_b32 s38, s23, 11
    s_lshl_b32 s22, s8, 11
    v_add_u32 v161, s22, v9
    s_lshr_b32 s23, s34, 1
    s_add_u32 s23, s23, 4096
    v_add_u32 v172, s23, v9
    s_lshr_b32 s23, s36, 1
    s_add_u32 s23, s23, 4096
    v_add_u32 v173, s23, v9
    s_lshr_b32 s23, s38, 1
    s_add_u32 s23, s23, 4096
    v_add_u32 v174, s23, v9
    s_add_u32 s23, s32, s25
    s_sub_u32 s24, s23, 14336
    s_min_u32 s32, s23, s24
    s_add_u32 s23, s33, s25
    s_sub_u32 s24, s23, 14336
    s_min_u32 s33, s23, s24
    s_add_u32 s23, s34, s25
    s_sub_u32 s24, s23, 14336
    s_min_u32 s34, s23, s24
    s_add_u32 s23, s35, s25
    s_sub_u32 s24, s23, 14336
    s_min_u32 s35, s23, s24
    s_add_u32 s23, s36, s25
    s_sub_u32 s24, s23, 14336
    s_min_u32 s36, s23, s24
    s_add_u32 s23, s37, s25
    s_sub_u32 s24, s23, 14336
    s_min_u32 s37, s23, s24
    s_add_u32 s23, s38, s25
    s_sub_u32 s24, s23, 14336
    s_min_u32 s38, s23, s24
    s_lshr_b32 s23, s32, 1
    s_sub_u32 s23, s23, s22
    s_add_u32 s12, s23, 0x3ffc000
    s_lshr_b32 s23, s33, 1
    s_sub_u32 s23, s23, s22
    s_add_u32 s13, s23, 0x3ffc000
    s_mul_i32 s22, s8, 1605632
    s_mul_i32 s23, s30, 28672
    s_add_u32 s22, s22, s23
    s_add_u32 s22, s22, 0x700000
    s_mul_i32 s24, s8, 28672
    s_add_u32 s24, s24, 12288
    s_lshl_b32 s25, s30, 1
    s_add_u32 s32, s22, s32
    s_add_u32 s33, s22, s33
    s_add_u32 s34, s22, s34
    s_add_u32 s35, s22, s35
    s_add_u32 s36, s22, s36
    s_add_u32 s37, s22, s37
    s_add_u32 s38, s22, s38
    s_and_b32 s100, s25, 28
    s_add_u32 s100, s100, s8
    s_lshl_b32 s100, s100, 7
    s_add_u32 s100, s100, 0x4802000
.wd_33:
    buffer_load_dword v1, off, s[4:7], s100 sc1
    s_sub_u32 s19, s19, 1
    s_cbranch_scc1 .abort
    s_waitcnt vmcnt(0)
    v_readfirstlane_b32 s101, v1
    s_bfe_u32 s101, s101, 0x80000
    s_cmp_ge_u32 s101, 16
    s_cbranch_scc1 .wdg_34
    s_sleep 2
    s_branch .wd_33
.wdg_34:
    s_add_u32 s23, s32, 0
    buffer_load_dwordx4 a[0:3], v9, s[4:7], s23 offen
    buffer_load_dwordx4 a[4:7], v9, s[4:7], s23 offen offset:1024
    s_add_u32 s23, s32, 14336
    buffer_load_dwordx4 a[56:59], v9, s[4:7], s23 offen
    buffer_load_dwordx4 a[60:63], v9, s[4:7], s23 offen offset:1024
    s_add_u32 s23, s32, 401408
    buffer_load_dwordx4 a[112:115], v9, s[4:7], s23 offen
    buffer_load_dwordx4 a[116:119], v9, s[4:7], s23 offen offset:1024
    s_add_u32 s23, s32, 415744
    buffer_load_dwordx4 a[168:171], v9, s[4:7], s23 offen
    buffer_load_dwordx4 a[172:175], v9, s[4:7], s23 offen offset:1024
    s_add_u32 s23, s32, 802816
    buffer_load_dwordx4 a[224:227], v9, s[4:7], s23 offen
    buffer_load_dwordx4 a[228:231], v9, s[4:7], s23 offen offset:1024
    s_add_u32 s23, s32, 817152
    buffer_load_dwordx4 v[200:203], v9, s[4:7], s23 offen
    buffer_load_dwordx4 v[204:207], v9, s[4:7], s23 offen offset:1024
    s_add_u32 m0, s24, 0
    s_add_u32 s23, s32, 1204224
    buffer_load_dwordx4 v9, s[4:7], s23 offen  lds
    buffer_load_dwordx4 v9, s[4:7], s23 offen offset:1024  lds
    s_add_u32 m0, s24, 14336
    s_add_u32 s23, s32, 1218560
    buffer_load_dwordx4 v9, s[4:7], s23 offen  lds
    buffer_load_dwordx4 v9, s[4:7], s23 offen offset:1024  lds
    s_add_u32 s23, s33, 0
    buffer_load_dwordx4 a[8:11], v9, s[4:7], s23 offen
    buffer_load_dwordx4 a[12:15], v9, s[4:7], s23 offen offset:1024
    s_add_u32 s23, s33, 14336
    buffer_load_dwordx4 a[64:67], v9, s[4:7], s23 offen
    buffer_load_dwordx4 a[68:71], v9, s[4:7], s23 offen offset:1024
    s_add_u32 s23, s33, 401408
    buffer_load_dwordx4 a[120:123], v9, s[4:7], s23 offen
    buffer_load_dwordx4 a[124:127], v9, s[4:7], s23 offen offset:1024
    s_add_u32 s23, s33, 415744
    buffer_load_dwordx4 a[176:179], v9, s[4:7], s23 offen
    buffer_load_dwordx4 a[180:183], v9, s[4:7], s23 offen offset:1024
    s_waitcnt vmcnt(4)
    buffer_load_dword v1, off, s[4:7], s100 sc1
    s_add_u32 s23, s33, 802816
    buffer_load_dwordx4 a[232:235], v9, s[4:7], s23 offen
    buffer_load_dwordx4 a[236:239], v9, s[4:7], s23 offen offset:1024
    s_add_u32 s23, s33, 817152
    buffer_load_dwordx4 v[208:211], v9, s[4:7], s23 offen
    buffer_load_dwordx4 v[212:215], v9, s[4:7], s23 offen offset:1024
    s_add_u32 m0, s24, 2048
    s_add_u32 s23, s33, 1204224
    buffer_load_dwordx4 v9, s[4:7], s23 offen  lds
    buffer_load_dwordx4 v9, s[4:7], s23 offen offset:1024  lds
    s_add_u32 m0, s24, 16384
    s_add_u32 s23, s33, 1218560
    buffer_load_dwordx4 v9, s[4:7], s23 offen  lds
    buffer_load_dwordx4 v9, s[4:7], s23 offen offset:1024  lds
    s_waitcnt vmcnt(8)
.stl_35:
    v_readfirstlane_b32 s101, v1
    s_bfe_u32 s101, s101, 0x80008
    s_cmp_lt_u32 s101, 16
    s_cbranch_scc1 .stf_36
    s_add_u32 s23, s34, 0
    buffer_load_dwordx4 a[16:19], v9, s[4:7], s23 offen
    buffer_load_dwordx4 a[20:23], v9, s[4:7], s23 offen offset:1024
    s_add_u32 s23, s34, 14336
    buffer_load_dwordx4 a[72:75], v9, s[4:7], s23 offen
    buffer_load_dwordx4 a[76:79], v9, s[4:7], s23 offen offset:1024
    s_add_u32 s23, s34, 401408
    buffer_load_dwordx4 a[128:131], v9, s[4:7], s23 offen
    buffer_load_dwordx4 a[132:135], v9, s[4:7], s23 offen offset:1024
    s_add_u32 s23, s34, 415744
    buffer_load_dwordx4 a[184:187], v9, s[4:7], s23 offen
    buffer_load_dwordx4 a[188:191], v9, s[4:7], s23 offen offset:1024
    s_add_u32 s23, s34, 802816
    buffer_load_dwordx4 a[240:243], v9, s[4:7], s23 offen
    buffer_load_dwordx4 a[244:247], v9, s[4:7], s23 offen offset:1024
    s_add_u32 s23, s34, 817152
    buffer_load_dwordx4 v[216:219], v9, s[4:7], s23 offen
    buffer_load_dwordx4 v[220:223], v9, s[4:7], s23 offen offset:1024
    s_add_u32 m0, s24, 4096
    s_add_u32 s23, s34, 1204224
    buffer_load_dwordx4 v9, s[4:7], s23 offen  lds
    buffer_load_dwordx4 v9, s[4:7], s23 offen offset:1024  lds
    s_add_u32 m0, s24, 18432
    s_add_u32 s23, s34, 1218560
    buffer_load_dwordx4 v9, s[4:7], s23 offen  lds
    buffer_load_dwordx4 v9, s[4:7], s23 offen offset:1024  lds
    s_add_u32 s23, s35, 0
    buffer_load_dwordx4 a[24:27], v9, s[4:7], s23 offen
    buffer_load_dwordx4 a[28:31], v9, s[4:7], s23 offen offset:1024
    s_add_u32 s23, s35, 14336
    buffer_load_dwordx4 a[80:83], v9, s[4:7], s23 offen
    buffer_load_dwordx4 a[84:87], v9, s[4:7], s23 offen offset:1024
    s_add_u32 s23, s35, 401408
    buffer_load_dwordx4 a[136:139], v9, s[4:7], s23 offen
    buffer_load_dwordx4 a[140:143], v9, s[4:7], s23 offen offset:1024
    s_add_u32 s23, s35, 415744
    buffer_load_dwordx4 a[192:195], v9, s[4:7], s23 offen
    buffer_load_dwordx4 a[196:199], v9, s[4:7], s23 offen offset:1024
    s_waitcnt vmcnt(4)
    buffer_load_dword v1, off, s[4:7], s100 sc1
    s_add_u32 s23, s35, 802816
    buffer_load_dwordx4 a[248:251], v9, s[4:7], s23 offen
    buffer_load_dwordx4 a[252:255], v9, s[4:7], s23 offen offset:1024
    s_add_u32 s23, s35, 817152
    buffer_load_dwordx4 v[224:227], v9, s[4:7], s23 offen
    buffer_load_dwordx4 v[228:231], v9, s[4:7], s23 offen offset:1024
    s_add_u32 m0, s24, 6144
    s_add_u32 s23, s35, 1204224
    buffer_load_dwordx4 v9, s[4:7], s23 offen  lds
    buffer_load_dwordx4 v9, s[4:7], s23 offen offset:1024  lds
    s_add_u32 m0, s24, 20480
    s_add_u32 s23, s35, 1218560
    buffer_load_dwordx4 v9, s[4:7], s23 offen  lds
    buffer_load_dwordx4 v9, s[4:7], s23 offen offset:1024  lds
    s_waitcnt vmcnt(8)
.stl_37:
    v_readfirstlane_b32 s101, v1
    s_bfe_u32 s101, s101, 0x80010
    s_cmp_lt_u32 s101, 16
    s_cbranch_scc1 .stf_38
    s_add_u32 s23, s36, 0
    buffer_load_dwordx4 a[32:35], v9, s[4:7], s23 offen
    buffer_load_dwordx4 a[36:39], v9, s[4:7], s23 offen offset:1024
    s_add_u32 s23, s36, 14336
    buffer_load_dwordx4 a[88:91], v9, s[4:7], s23 offen
    buffer_load_dwordx4 a[92:95], v9, s[4:7], s23 offen offset:1024
    s_add_u32 s23, s36, 401408
    buffer_load_dwordx4 a[144:147], v9, s[4:7], s23 offen
    buffer_load_dwordx4 a[148:151], v9, s[4:7], s23 offen offset:1024
    s_add_u32 s23, s36, 415744
    buffer_load_dwordx4 a[200:203], v9, s[4:7], s23 offen
    buffer_load_dwordx4 a[204:207], v9, s[4:7], s23 offen offset:1024
    s_add_u32 s23, s36, 802816
    buffer_load_dwordx4 v[176:179], v9, s[4:7], s23 offen
    buffer_load_dwordx4 v[180:183], v9, s[4:7], s23 offen offset:1024
    s_add_u32 s23, s36, 817152
    buffer_load_dwordx4 v[232:235], v9, s[4:7], s23 offen
    buffer_load_dwordx4 v[236:239], v9, s[4:7], s23 offen offset:1024
    s_add_u32 m0, s24, 8192
    s_add_u32 s23, s36, 1204224
    buffer_load_dwordx4 v9, s[4:7], s23 offen  lds
    buffer_load_dwordx4 v9, s[4:7], s23 offen offset:1024  lds
    s_add_u32 m0, s24, 22528
    s_add_u32 s23, s36, 1218560
    buffer_load_dwordx4 v9, s[4:7], s23 offen  lds
    buffer_load_dwordx4 v9, s[4:7], s23 offen offset:1024  lds
    s_add_u32 s23, s37, 0
    buffer_load_dwordx4 a[40:43], v9, s[4:7], s23 offen
    buffer_load_dwordx4 a[44:47], v9, s[4:7], s23 offen offset:1024
    s_add_u32 s23, s37, 14336
    buffer_load_dwordx4 a[96:99], v9, s[4:7], s23 offen
    buffer_load_dwordx4 a[100:103], v9, s[4:7], s23 offen offset:1024
    s_add_u32 s23, s37, 401408
    buffer_load_dwordx4 a[152:155], v9, s[4:7], s23 offen
    buffer_load_dwordx4 a[156:159], v9, s[4:7], s23 offen offset:1024
    s_add_u32 s23, s37, 415744
    buffer_load_dwordx4 a[208:211], v9, s[4:7], s23 offen
    buffer_load_dwordx4 a[212:215], v9, s[4:7], s23 offen offset:1024
    s_add_u32 s23, s37, 802816
    buffer_load_dwordx4 v[184:187], v9, s[4:7], s23 offen
    buffer_load_dwordx4 v[188:191], v9, s[4:7], s23 offen offset:1024
    s_add_u32 s23, s37, 817152
    buffer_load_dwordx4 v[240:243], v9, s[4:7], s23 offen
    buffer_load_dwordx4 v[244:247], v9, s[4:7], s23 offen offset:1024
    s_add_u32 m0, s24, 10240
    s_add_u32 s23, s37, 1204224
    buffer_load_dwordx4 v9, s[4:7], s23 offen  lds
    buffer_load_dwordx4 v9, s[4:7], s23 offen offset:1024  lds
    s_add_u32 m0, s24, 24576
    s_add_u32 s23, s37, 1218560
    buffer_load_dwordx4 v9, s[4:7], s23 offen  lds
    buffer_load_dwordx4 v9, s[4:7], s23 offen offset:1024  lds
    s_add_u32 s23, s38, 0
    buffer_load_dwordx4 a[48:51], v9, s[4:7], s23 offen
    buffer_load_dwordx4 a[52:55], v9, s[4:7], s23 offen offset:1024
    s_add_u32 s23, s38, 14336
    buffer_load_dwordx4 a[104:107], v9, s[4:7], s23 offen
    buffer_load_dwordx4 a[108:111], v9, s[4:7], s23 offen offset:1024
    s_add_u32 s23, s38, 401408
    buffer_load_dwordx4 a[160:163], v9, s[4:7], s23 offen
    buffer_load_dwordx4 a[164:167], v9, s[4:7], s23 offen offset:1024
    s_add_u32 s23, s38, 415744
    buffer_load_dwordx4 a[216:219], v9, s[4:7], s23 offen
    buffer_load_dwordx4 a[220:223], v9, s[4:7], s23 offen offset:1024
    s_add_u32 s23, s38, 802816
    buffer_load_dwordx4 v[192:195], v9, s[4:7], s23 offen
    buffer_load_dwordx4 v[196:199], v9, s[4:7], s23 offen offset:1024
    s_add_u32 s23, s38, 817152
    buffer_load_dwordx4 v[248:251], v9, s[4:7], s23 offen
    buffer_load_dwordx4 v[252:255], v9, s[4:7], s23 offen offset:1024
    s_add_u32 m0, s24, 12288
    s_add_u32 s23, s38, 1204224
    buffer_load_dwordx4 v9, s[4:7], s23 offen  lds
    buffer_load_dwordx4 v9, s[4:7], s23 offen offset:1024  lds
    s_add_u32 m0, s24, 26624
    s_add_u32 s23, s38, 1218560
    buffer_load_dwordx4 v9, s[4:7], s23 offen  lds
    buffer_load_dwordx4 v9, s[4:7], s23 offen offset:1024  lds
    v_and_b32 v1, 2, v0
    v_mov_b32 v2, 0x4444
    v_mov_b32 v3, 0xeeee
    v_cmp_eq_u32 vcc, 0, v1
    s_nop 1
    v_cndmask_b32 v160, v3, v2, vcc
    s_lshl_b32 s24, s8, 9
    s_add_u32 s24, s24, 8192
    v_lshl_add_u32 v163, v0, 3, s24
    s_lshl_b32 s24, s8, 10
    s_add_u32 s24, s24, 0
    v_add_u32 v164, s24, v9
    s_mul_i32 s24, s8, 28672
    s_add_u32 s24, s24, 12288
    v_add_u32 v168, s24, v9
    s_lshr_b32 s25, s30, 1
    s_lshl_b32 s25, s25, 10
    s_and_b32 s26, s30, 1
    s_lshl_b32 s26, s26, 5
    s_add_u32 s25, s25, s26
    v_xor_b32 v72, 1024, v164
    v_xor_b32 v73, 2048, v164
    v_xor_b32 v74, 3072, v164
    v_mov_b32 v166, s25
    v_bfe_u32 v1, v0, 2, 2
    v_lshl_add_u32 v166, v1, 8, v166
    v_bfe_u32 v1, v0, 4, 2
    v_lshl_add_u32 v166, v1, 6, v166
    v_bfe_u32 v1, v0, 0, 2
    v_lshl_add_u32 v166, v1, 2, v166
    s_lshl_b32 s24, s8, 4
    s_lshl_b32 s25, s30, 7
    s_add_u32 s24, s24, s25
    s_add_u32 s24, s24, 10240
    v_and_b32 v1, 3, v0
    v_lshl_add_u32 v171, v1, 2, s24
    s_lshl_b32 s24, s30, 4
    s_lshl_b32 s25, s8, 2
    s_add_u32 s24, s24, s25
    s_add_u32 s24, s24, 12288
    s_cmp_lt_u32 s30, 2
    s_cselect_b32 s48, -1, 0xffff
    s_mov_b32 s49, 0
    v_and_b32 v1, 15, v0
    v_lshl_add_u32 v175, v1, 8, s24
    v_bfe_u32 v1, v0, 4, 1
    v_mul_u32_u24 v1, 224, v1
    v_add_u32 v175, v175, v1
    s_mov_b32 s11, 0
    s_mov_b32 s14, 0x4100000
    s_mul_i32 s15, s8, 6144
    s_lshl_b32 s24, s30, 15
    s_add_u32 s15, s15, s24
    s_add_u32 s15, s15, 0x1000000
    s_add_u32 s16, s15, 4096
    s_lshr_b32 s24, s30, 1
    s_lshl_b32 s24, s24, 2
    s_add_u32 s24, s24, s8
    s_lshl_b32 s24, s24, 7
    s_and_b32 s25, s30, 1
    s_lshl_b32 s25, s25, 3
    s_add_u32 s24, s24, s25
    s_add_u32 s17, s24, 0x4801000
.wd_39:
    buffer_load_dword v1, off, s[92:95], 0 offset:132 sc1
    s_sub_u32 s19, s19, 1
    s_cbranch_scc1 .abort
    s_waitcnt vmcnt(0)
    v_readfirstlane_b32 s101, v1
    s_and_b32 s100, s101, 0x2020
    s_cmp_eq_u32 s100, 0x2020
    s_cbranch_scc1 .wdg_40
    s_sleep 2
    s_branch .wd_39
.wdg_40:
    s_bfe_u32 s18, s101, 0x80010
    s_mov_b32 s50, s18
    s_mov_b32 s20, 0x4000000
    v_mov_b32 v4, -1
    v_mov_b32 v5, -1
    v_mov_b32 v6, -1
    v_mov_b32 v7, -1
    ds_write_b128 v164, v[4:7]
    v_mov_b32 v28, 0
    v_mov_b32 v29, 0
    v_mov_b32 v30, 0
    v_mov_b32 v31, 0
    v_mov_b32 v32, 0
    v_mov_b32 v33, 0
    v_mov_b32 v34, 0
    v_mov_b32 v35, 0
    v_mov_b32 v36, 0
    v_mov_b32 v37, 0
    v_mov_b32 v38, 0
    v_mov_b32 v39, 0
    v_mov_b32 v40, 0
    v_mov_b32 v41, 0
    v_mov_b32 v42, 0
    v_mov_b32 v43, 0
    v_mov_b32 v44, 0
    v_mov_b32 v45, 0
    v_mov_b32 v46, 0
    v_mov_b32 v47, 0
    v_mov_b32 v48, 0
    v_mov_b32 v49, 0
    v_mov_b32 v50, 0
    v_mov_b32 v51, 0
    v_mov_b32 v52, 0
    v_mov_b32 v53, 0
    v_mov_b32 v54, 0
    v_mov_b32 v55, 0
    v_mov_b32 v56, 0
    v_mov_b32 v57, 0
    v_mov_b32 v58, 0
    v_mov_b32 v59, 0
    ds_read_b128 v[128:131], v168 offset:0
    ds_read_b128 v[132:135], v168 offset:1024
    ds_read_b128 v[136:139], v168 offset:14336
    ds_read_b128 v[140:143], v168 offset:15360
    ds_read_b128 v[144:147], v168 offset:2048
    ds_read_b128 v[148:151], v168 offset:3072
    ds_read_b128 v[152:155], v168 offset:16384
    ds_read_b128 v[156:159], v168 offset:17408
    s_waitcnt lgkmcnt(0)
.oc_uw_42:
    buffer_load_dwordx2 v[118:119], off, s[4:7], s17 sc1
    s_sub_u32 s19, s19, 1
    s_cbranch_scc1 .abort
    s_waitcnt vmcnt(0)
    v_min_u32 v118, v118, v119
    s_nop 0
    v_readfirstlane_b32 s51, v118
    s_cmp_gt_u32 s51, s11
    s_cbranch_scc0 .oc_uw_42
.oc_loop_41:
    v_mov_b64 v[120:121], 0
    v_mov_b64 v[122:123], 0
    v_mov_b64 v[124:125], 0
    v_mov_b64 v[126:127], 0
    s_nop 15
    s_nop 15
    s_nop 15
    s_nop 11
    buffer_load_dwordx4 v[0:3], v161, s[4:7], s12 offen sc1
    buffer_load_dwordx4 v[4:7], v161, s[4:7], s13 offen sc1
    v_mov_b64 v[28:29], 0
    v_mov_b64 v[30:31], 0
    v_mov_b64 v[32:33], 0
    v_mov_b64 v[34:35], 0
    buffer_load_dwordx4 v[76:79], v161, s[4:7], s15 offen sc1
    v_mov_b64 v[36:37], 0
    v_mov_b64 v[38:39], 0
    v_mov_b64 v[40:41], 0
    v_mov_b64 v[42:43], 0
    buffer_load_dwordx4 v[84:87], v161, s[4:7], s15 offen offset:1024 sc1
    v_mov_b64 v[44:45], 0
    v_mov_b64 v[46:47], 0
    v_mov_b64 v[48:49], 0
    v_mov_b64 v[50:51], 0
    buffer_load_dwordx4 v[80:83], v161, s[4:7], s15 offen offset:2048 sc1
    v_mov_b64 v[52:53], 0
    v_mov_b64 v[54:55], 0
    v_mov_b64 v[56:57], 0
    v_mov_b64 v[58:59], 0
    buffer_load_dwordx4 v[88:91], v161, s[4:7], s15 offen offset:3072 sc1
    s_waitcnt vmcnt(4)
    v_max_u32 v167, v0, v4
    v_cmp_eq_u32 vcc, -1, v167
    s_cbranch_vccnz .oc_mfail_43
.oc_mback_44:
    v_smfmac_f32_16x16x64_bf16 v[52:55], v[0:3], v[128:135], v160
    ds_write_b128 v161, v[0:3] offset:4096
    v_smfmac_f32_16x16x64_bf16 v[56:59], v[0:3], v[136:143], v160
    ds_write_b128 v161, v[4:7] offset:5120
    v_smfmac_f32_16x16x64_bf16 v[28:31], v[0:3], a[0:7], v160
    v_smfmac_f32_16x16x64_bf16 v[32:35], v[0:3], a[56:63], v160
    buffer_load_dwordx4 v[92:95], v161, s[4:7], s16 offen sc1
    v_smfmac_f32_16x16x64_bf16 v[36:39], v[0:3], a[112:119], v160
    v_smfmac_f32_16x16x64_bf16 v[40:43], v[0:3], a[168:175], v160
    s_waitcnt lgkmcnt(0)
    s_barrier
    ds_read_b128 v[8:11], v172 offset:0
    v_smfmac_f32_16x16x64_bf16 v[44:47], v[0:3], a[224:231], v160
    ds_read_b128 v[12:15], v172 offset:1024
    ds_read_b128 v[16:19], v173 offset:0
    v_smfmac_f32_16x16x64_bf16 v[48:51], v[0:3], v[200:207], v160
    ds_read_b128 v[20:23], v173 offset:1024
    ds_read_b128 v[24:27], v174 offset:0
    buffer_load_dwordx4 v[100:103], v161, s[4:7], s16 offen offset:1024 sc1
    v_smfmac_f32_16x16x64_bf16 v[52:55], v[4:7], v[144:151], v160
    ds_read_b128 v[128:131], v168 offset:4096
    ds_read_b128 v[132:135], v168 offset:5120
    v_smfmac_f32_16x16x64_bf16 v[56:59], v[4:7], v[152:159], v160
    ds_read_b128 v[136:139], v168 offset:6144
    ds_read_b128 v[140:143], v168 offset:7168
    v_smfmac_f32_16x16x64_bf16 v[28:31], v[4:7], a[8:15], v160
    ds_read_b128 v[144:147], v168 offset:8192
    ds_read_b128 v[148:151], v168 offset:9216
    v_smfmac_f32_16x16x64_bf16 v[32:35], v[4:7], a[64:71], v160
    ds_read_b128 v[152:155], v168 offset:10240
    ds_read_b128 v[156:159], v168 offset:11264
    buffer_load_dwordx4 v[96:99], v161, s[4:7], s16 offen offset:2048 sc1
    v_smfmac_f32_16x16x64_bf16 v[36:39], v[4:7], a[120:127], v160
    v_smfmac_f32_16x16x64_bf16 v[40:43], v[4:7], a[176:183], v160
    v_smfmac_f32_16x16x64_bf16 v[44:47], v[4:7], a[232:239], v160
    v_smfmac_f32_16x16x64_bf16 v[48:51], v[4:7], v[208:215], v160
    buffer_load_dwordx4 v[104:107], v161, s[4:7], s16 offen offset:3072 sc1
    buffer_load_dwordx2 v[118:119], off, s[4:7], s17 sc1
    s_waitcnt lgkmcnt(6)
    v_smfmac_f32_16x16x64_bf16 v[52:55], v[8:11], v[128:135], v160
    v_smfmac_f32_16x16x64_bf16 v[28:31], v[8:11], a[16:23], v160
    ds_read_b128 v[128:131], v168 offset:12288
    ds_read_b128 v[132:135], v168 offset:13312
    v_smfmac_f32_16x16x64_bf16 v[28:31], v[12:15], a[24:31], v160
    s_waitcnt lgkmcnt(6)
    v_smfmac_f32_16x16x64_bf16 v[52:55], v[12:15], v[136:143], v160
    v_smfmac_f32_16x16x64_bf16 v[28:31], v[16:19], a[32:39], v160
    ds_read_b128 v[136:139], v168 offset:18432
    ds_read_b128 v[140:143], v168 offset:19456
    v_smfmac_f32_16x16x64_bf16 v[28:31], v[20:23], a[40:47], v160
    s_waitcnt lgkmcnt(6)
    v_smfmac_f32_16x16x64_bf16 v[52:55], v[16:19], v[144:151], v160
    v_smfmac_f32_16x16x64_bf16 v[28:31], v[24:27], a[48:55], v160
    ds_read_b128 v[144:147], v168 offset:20480
    ds_read_b128 v[148:151], v168 offset:21504
    v_smfmac_f32_16x16x64_bf16 v[32:35], v[8:11], a[72:79], v160
    s_waitcnt lgkmcnt(6)
    v_smfmac_f32_16x16x64_bf16 v[52:55], v[20:23], v[152:159], v160
    v_add_f32 v28, v28, v30
    v_smfmac_f32_16x16x64_bf16 v[32:35], v[12:15], a[80:87], v160
    ds_read_b128 v[152:155], v168 offset:22528
    ds_read_b128 v[156:159], v168 offset:23552
    v_add_f32 v29, v29, v31
    v_smfmac_f32_16x16x64_bf16 v[32:35], v[16:19], a[88:95], v160
    v_cvt_pk_bf16_f32 v60, v28, v29
    s_waitcnt lgkmcnt(6)
    v_smfmac_f32_16x16x64_bf16 v[52:55], v[24:27], v[128:135], v160
    v_smfmac_f32_16x16x64_bf16 v[32:35], v[20:23], a[96:103], v160
    ds_read_b128 v[128:131], v168 offset:24576
    ds_read_b128 v[132:135], v168 offset:25600
    v_smfmac_f32_16x16x64_bf16 v[32:35], v[24:27], a[104:111], v160
    v_add_f32 v52, v52, v54
    v_smfmac_f32_16x16x64_bf16 v[36:39], v[8:11], a[128:135], v160
    v_add_f32 v53, v53, v55
    v_smfmac_f32_16x16x64_bf16 v[36:39], v[12:15], a[136:143], v160
    v_cvt_pk_bf16_f32 v63, v52, v53
    v_smfmac_f32_16x16x64_bf16 v[36:39], v[16:19], a[144:151], v160
    v_add_f32 v32, v32, v34
    v_smfmac_f32_16x16x64_bf16 v[36:39], v[20:23], a[152:159], v160
    v_add_f32 v33, v33, v35
    v_smfmac_f32_16x16x64_bf16 v[36:39], v[24:27], a[160:167], v160
    v_cvt_pk_bf16_f32 v64, v32, v33
    s_waitcnt lgkmcnt(6)
    v_smfmac_f32_16x16x64_bf16 v[56:59], v[8:11], v[136:143], v160
    v_smfmac_f32_16x16x64_bf16 v[40:43], v[8:11], a[184:191], v160
    ds_read_b128 v[136:139], v168 offset:26624
    ds_read_b128 v[140:143], v168 offset:27648
    v_add_f32 v36, v36, v38
    v_smfmac_f32_16x16x64_bf16 v[40:43], v[12:15], a[192:199], v160
    v_add_f32 v37, v37, v39
    s_waitcnt lgkmcnt(6)
    v_smfmac_f32_16x16x64_bf16 v[56:59], v[12:15], v[144:151], v160
    v_cvt_pk_bf16_f32 v61, v36, v37
    v_smfmac_f32_16x16x64_bf16 v[40:43], v[16:19], a[200:207], v160
    ds_read_b128 v[144:147], v168 offset:2048
    ds_read_b128 v[148:151], v168 offset:3072
    v_smfmac_f32_16x16x64_bf16 v[40:43], v[20:23], a[208:215], v160
    s_waitcnt lgkmcnt(6)
    v_smfmac_f32_16x16x64_bf16 v[56:59], v[16:19], v[152:159], v160
    v_smfmac_f32_16x16x64_bf16 v[40:43], v[24:27], a[216:223], v160
    ds_read_b128 v[152:155], v168 offset:16384
    ds_read_b128 v[156:159], v168 offset:17408
    v_smfmac_f32_16x16x64_bf16 v[44:47], v[8:11], a[240:247], v160
    s_waitcnt lgkmcnt(6)
    v_smfmac_f32_16x16x64_bf16 v[56:59], v[20:23], v[128:135], v160
    v_add_f32 v40, v40, v42
    v_smfmac_f32_16x16x64_bf16 v[44:47], v[12:15], a[248:255], v160
    ds_read_b128 v[128:131], v168 offset:0
    ds_read_b128 v[132:135], v168 offset:1024
    v_add_f32 v41, v41, v43
    v_smfmac_f32_16x16x64_bf16 v[44:47], v[16:19], v[176:183], v160
    v_cvt_pk_bf16_f32 v65, v40, v41
    s_waitcnt lgkmcnt(6)
    v_smfmac_f32_16x16x64_bf16 v[56:59], v[24:27], v[136:143], v160
    v_smfmac_f32_16x16x64_bf16 v[44:47], v[20:23], v[184:191], v160
    ds_read_b128 v[136:139], v168 offset:14336
    ds_read_b128 v[140:143], v168 offset:15360
    v_smfmac_f32_16x16x64_bf16 v[44:47], v[24:27], v[192:199], v160
    v_add_f32 v56, v56, v58
    v_smfmac_f32_16x16x64_bf16 v[48:51], v[8:11], v[216:223], v160
    v_add_f32 v57, v57, v59
    v_smfmac_f32_16x16x64_bf16 v[48:51], v[12:15], v[224:231], v160
    v_cvt_pk_bf16_f32 v67, v56, v57
    v_smfmac_f32_16x16x64_bf16 v[48:51], v[16:19], v[232:239], v160
    v_add_f32 v44, v44, v46
    v_smfmac_f32_16x16x64_bf16 v[48:51], v[20:23], v[240:247], v160
    v_add_f32 v45, v45, v47
    v_smfmac_f32_16x16x64_bf16 v[48:51], v[24:27], v[248:255], v160
    v_cvt_pk_bf16_f32 v62, v44, v45
    s_nop 4
    v_add_f32 v48, v48, v50
    v_add_f32 v49, v49, v51
    v_cvt_pk_bf16_f32 v66, v48, v49
    s_add_u32 s12, s12, 16384
    s_add_u32 s13, s13, 16384
    s_add_u32 s15, s15, 458752
    s_add_u32 s16, s16, 458752
    s_waitcnt vmcnt(0) lgkmcnt(0)
    v_min_u32 v118, v118, v119
    s_nop 0
    v_readfirstlane_b32 s51, v118
    buffer_load_dwordx4 v[108:111], v161, s[4:7], s14 offen sc1
    buffer_load_dwordx4 v[112:115], v161, s[4:7], s14 offen offset:1024 sc1
    buffer_load_dwordx2 v[116:117], v163, s[4:7], s14 offen sc1
    s_nop 15
    s_nop 7
    buffer_load_dwordx4 v[108:111], v161, s[4:7], s14 offen sc1
    buffer_load_dwordx4 v[112:115], v161, s[4:7], s14 offen offset:1024 sc1
    buffer_load_dwordx2 v[116:117], v163, s[4:7], s14 offen sc1
    s_nop 15
    s_nop 7
.sp_45:
    buffer_load_dwordx4 v[108:111], v161, s[4:7], s14 offen sc1
    buffer_load_dwordx4 v[112:115], v161, s[4:7], s14 offen offset:1024 sc1
    buffer_load_dwordx2 v[116:117], v163, s[4:7], s14 offen sc1
    s_sub_u32 s19, s19, 1
    s_cbranch_scc1 .abort
    v_mov_b64 v[120:121], 0
    v_mov_b64 v[122:123], 0
    s_waitcnt vmcnt(6)
    v_max3_u32 v167, v108, v112, v116
    v_max_u32 v167, v167, v117
    v_cmp_eq_u32 vcc, -1, v167
    v_smfmac_f32_16x16x32_bf16 v[120:123], v[116:117], v[60:63], v160
    s_cbranch_vccnz .sp_45
    v_smfmac_f32_16x16x32_bf16 v[124:127], v[116:117], v[64:67], v160
    v_smfmac_f32_16x16x64_bf16 v[120:123], v[108:111], v[76:83], v160
    v_smfmac_f32_16x16x64_bf16 v[120:123], v[112:115], v[92:99], v160
    v_smfmac_f32_16x16x64_bf16 v[124:127], v[108:111], v[84:91], v160
    v_smfmac_f32_16x16x64_bf16 v[124:127], v[112:115], v[100:107], v160
    s_cmp_eq_u32 s18, 0
    v_add_f32 v68, v120, v122
    v_add_f32 v70, v121, v123
    s_nop 3
    v_add_f32 v69, v124, v126
    v_add_f32 v71, v125, v127
    ds_write_b128 v164, v[68:71]
    ds_read_b128 v[0:3], v72
    ds_read_b128 v[4:7], v73
    ds_read_b128 v[8:11], v74
    s_nop 1
    v_mov_b32 v28, 0
    s_nop 1
    v_mov_b32 v29, 0
    s_nop 1
    v_mov_b32 v30, 0
    s_waitcnt lgkmcnt(2)
    v_pk_add_f32 v[68:69], v[68:69], v[0:1]
    v_pk_add_f32 v[70:71], v[70:71], v[2:3]
    s_waitcnt lgkmcnt(0)
    v_max3_u32 v167, v0, v4, v8
    v_cmp_eq_u32 vcc, -1, v167
    v_pk_add_f32 v[4:5], v[4:5], v[8:9]
    v_pk_add_f32 v[6:7], v[6:7], v[10:11]
    v_pk_add_f32 v[68:69], v[68:69], v[4:5]
    v_pk_add_f32 v[70:71], v[70:71], v[6:7]
    v_cvt_pk_bf16_f32 v169, v68, v69
    v_cvt_pk_bf16_f32 v170, v70, v71
    v_min_u32 v169, -2, v169
    v_min_u32 v170, -2, v170
    s_cbranch_vccnz .backm_47
    s_cbranch_scc0 .slowm_46
    buffer_store_dword v169, v166, s[4:7], s20 offen
    buffer_store_dword v170, v166, s[4:7], s20 offen offset:16
.resetm_48:
    v_mov_b32 v0, -1
    v_mov_b32 v1, -1
    v_mov_b32 v2, -1
    v_mov_b32 v3, -1
    ds_write_b128 v164, v[0:3]
    ds_write_b128 v72, v[0:3]
    ds_write_b128 v73, v[0:3]
    ds_write_b128 v74, v[0:3]
.backm_47:
    s_add_u32 s20, s20, 16384
    s_add_u32 s14, s14, 16384
    s_add_u32 s11, s11, 1
    s_cmp_eq_u32 s11, 62
    s_cselect_b32 s22, 8192, 0
    s_add_u32 s20, s20, s22
    s_or_b32 s18, s18, s22
    s_barrier
    s_min_u32 s51, s51, 63
    s_cmp_gt_u32 s51, s11
    s_cbranch_scc1 .oc_loop_41
    s_cmp_lt_u32 s11, 63
    s_cbranch_scc1 .oc_uw_42
    s_waitcnt vmcnt(0)
    s_endpgm
.stf_36:
    buffer_load_dword v1, off, s[4:7], s100 sc1
    s_sub_u32 s19, s19, 1
    s_cbranch_scc1 .abort
    s_waitcnt vmcnt(0)
    s_branch .stl_35
.stf_38:
    buffer_load_dword v1, off, s[4:7], s100 sc1
    s_sub_u32 s19, s19, 1
    s_cbranch_scc1 .abort
    s_waitcnt vmcnt(0)
    s_branch .stl_37
.oc_mfail_43:
    s_sub_u32 s19, s19, 1
    s_cbranch_scc1 .abort
.pm_49:
    buffer_load_dwordx4 v[0:3], v161, s[4:7], s12 offen sc1
    buffer_load_dwordx4 v[4:7], v161, s[4:7], s13 offen sc1
    s_waitcnt vmcnt(0)
    v_max3_u32 v167, v0, v4, v4
    v_cmp_eq_u32 vcc, -1, v167
    s_cbranch_vccz .pmg_50
    s_sub_u32 s19, s19, 1
    s_cbranch_scc1 .abort
    s_sleep 1
    s_branch .pm_49
.pmg_50:
    s_branch .oc_mback_44
.slowm_46:
    buffer_store_dword v169, v166, s[4:7], s20 offen sc1
    buffer_store_dword v170, v166, s[4:7], s20 offen offset:16 sc1
    s_branch .resetm_48
.role_sh:
    s_load_dwordx2 s[40:41], s[0:1], 80
    s_sub_u32 s30, s9, 64
    s_lshr_b32 s56, s30, 5
    s_and_b32 s30, s30, 31
    s_lshr_b32 s31, s30, 2
    s_and_b32 s29, s30, 3
    s_lshl_b32 s29, s29, 6
    v_lshlrev_b32 v9, 4, v0
    v_add_u32 v13, 4096, v9
    s_mul_i32 s22, s8, 1605632
    s_mul_i32 s23, s31, 57344
    s_add_u32 s22, s22, s23
    s_add_u32 s22, s22, s29
    s_add_u32 s22, s22, 0x700000
    v_bfe_u32 v1, v0, 0, 2
    v_mul_u32_u24 v10, 14336, v1
    v_bfe_u32 v1, v0, 4, 2
    v_lshl_add_u32 v10, v1, 8, v10
    v_bfe_u32 v1, v0, 2, 2
    v_lshl_add_u32 v10, v1, 4, v10
    s_and_b32 s100, s30, 28
    s_add_u32 s100, s100, s8
    s_lshl_b32 s100, s100, 7
    s_add_u32 s100, s100, 0x4802000
.wd_51:
    buffer_load_dword v1, off, s[4:7], s100 sc1
    s_sub_u32 s19, s19, 1
    s_cbranch_scc1 .abort
    s_waitcnt vmcnt(0)
    v_readfirstlane_b32 s101, v1
    s_bfe_u32 s101, s101, 0x80010
    s_cmp_ge_u32 s101, 16
    s_cbranch_scc1 .wdg_52
    s_sleep 2
    s_branch .wd_51
.wdg_52:
    s_and_b32 s100, s30, 15
    s_lshl_b32 s100, s100, 7
    s_add_u32 s100, s100, 0x4801000
.wd_53:
    buffer_load_dword v1, off, s[4:7], s100 sc1
    s_sub_u32 s19, s19, 1
    s_cbranch_scc1 .abort
    s_waitcnt vmcnt(0)
    v_readfirstlane_b32 s101, v1
    s_bfe_u32 s101, s101, 0x80000
    s_cmp_ge_u32 s101, 1
    s_cbranch_scc1 .wdg_54
    s_sleep 16
    s_branch .wd_53
.wdg_54:
    s_add_u32 s23, s22, 0
    buffer_load_dwordx4 a[0:3], v10, s[4:7], s23 offen
    buffer_load_dwordx4 a[4:7], v10, s[4:7], s23 offen offset:1024
    buffer_load_dwordx4 a[8:11], v10, s[4:7], s23 offen offset:2048
    buffer_load_dwordx4 a[12:15], v10, s[4:7], s23 offen offset:3072
    s_add_u32 s23, s22, 4096
    buffer_load_dwordx4 a[16:19], v10, s[4:7], s23 offen
    buffer_load_dwordx4 a[20:23], v10, s[4:7], s23 offen offset:1024
    buffer_load_dwordx4 a[24:27], v10, s[4:7], s23 offen offset:2048
    buffer_load_dwordx4 a[28:31], v10, s[4:7], s23 offen offset:3072
    s_add_u32 s23, s22, 8192
    buffer_load_dwordx4 a[32:35], v10, s[4:7], s23 offen
    buffer_load_dwordx4 a[36:39], v10, s[4:7], s23 offen offset:1024
    buffer_load_dwordx4 a[40:43], v10, s[4:7], s23 offen offset:2048
    buffer_load_dwordx4 a[44:47], v10, s[4:7], s23 offen offset:3072
    s_add_u32 s23, s22, 12288
    buffer_load_dwordx4 a[48:51], v10, s[4:7], s23 offen
    buffer_load_dwordx4 a[52:55], v10, s[4:7], s23 offen offset:1024
    s_add_u32 s23, s22, 401408
    buffer_load_dwordx4 a[56:59], v10, s[4:7], s23 offen
    buffer_load_dwordx4 a[60:63], v10, s[4:7], s23 offen offset:1024
    buffer_load_dwordx4 a[64:67], v10, s[4:7], s23 offen offset:2048
    buffer_load_dwordx4 a[68:71], v10, s[4:7], s23 offen offset:3072
    s_add_u32 s23, s22, 405504
    buffer_load_dwordx4 a[72:75], v10, s[4:7], s23 offen
    buffer_load_dwordx4 a[76:79], v10, s[4:7], s23 offen offset:1024
    buffer_load_dwordx4 a[80:83], v10, s[4:7], s23 offen offset:2048
    buffer_load_dwordx4 a[84:87], v10, s[4:7], s23 offen offset:3072
    s_add_u32 s23, s22, 409600
    buffer_load_dwordx4 a[88:91], v10, s[4:7], s23 offen
    buffer_load_dwordx4 a[92:95], v10, s[4:7], s23 offen offset:1024
    buffer_load_dwordx4 a[96:99], v10, s[4:7], s23 offen offset:2048
    buffer_load_dwordx4 a[100:103], v10, s[4:7], s23 offen offset:3072
    s_add_u32 s23, s22, 413696
    buffer_load_dwordx4 a[104:107], v10, s[4:7], s23 offen
    buffer_load_dwordx4 a[108:111], v10, s[4:7], s23 offen offset:1024
    s_add_u32 s23, s22, 802816
    buffer_load_dwordx4 a[112:115], v10, s[4:7], s23 offen
    buffer_load_dwordx4 a[116:119], v10, s[4:7], s23 offen offset:1024
    buffer_load_dwordx4 a[120:123], v10, s[4:7], s23 offen offset:2048
    buffer_load_dwordx4 a[124:127], v10, s[4:7], s23 offen offset:3072
    s_add_u32 s23, s22, 806912
    buffer_load_dwordx4 a[128:131], v10, s[4:7], s23 offen
    buffer_load_dwordx4 a[132:135], v10, s[4:7], s23 offen offset:1024
    buffer_load_dwordx4 a[136:139], v10, s[4:7], s23 offen offset:2048
    buffer_load_dwordx4 a[140:143], v10, s[4:7], s23 offen offset:3072
    s_add_u32 s23, s22, 811008
    buffer_load_dwordx4 a[144:147], v10, s[4:7], s23 offen
    buffer_load_dwordx4 a[148:151], v10, s[4:7], s23 offen offset:1024
    buffer_load_dwordx4 a[152:155], v10, s[4:7], s23 offen offset:2048
    buffer_load_dwordx4 a[156:159], v10, s[4:7], s23 offen offset:3072
    s_add_u32 s23, s22, 815104
    buffer_load_dwordx4 a[160:163], v10, s[4:7], s23 offen
    buffer_load_dwordx4 a[164:167], v10, s[4:7], s23 offen offset:1024
    s_add_u32 s23, s22, 1204224
    buffer_load_dwordx4 a[168:171], v10, s[4:7], s23 offen
    buffer_load_dwordx4 a[172:175], v10, s[4:7], s23 offen offset:1024
    buffer_load_dwordx4 a[176:179], v10, s[4:7], s23 offen offset:2048
    buffer_load_dwordx4 a[180:183], v10, s[4:7], s23 offen offset:3072
    s_add_u32 s23, s22, 1208320
    buffer_load_dwordx4 a[184:187], v10, s[4:7], s23 offen
    buffer_load_dwordx4 a[188:191], v10, s[4:7], s23 offen offset:1024
    buffer_load_dwordx4 a[192:195], v10, s[4:7], s23 offen offset:2048
    buffer_load_dwordx4 a[196:199], v10, s[4:7], s23 offen offset:3072
    s_add_u32 s23, s22, 1212416
    buffer_load_dwordx4 a[200:203], v10, s[4:7], s23 offen
    buffer_load_dwordx4 a[204:207], v10, s[4:7], s23 offen offset:1024
    buffer_load_dwordx4 a[208:211], v10, s[4:7], s23 offen offset:2048
    buffer_load_dwordx4 a[212:215], v10, s[4:7], s23 offen offset:3072
    s_add_u32 s23, s22, 1216512
    buffer_load_dwordx4 a[216:219], v10, s[4:7], s23 offen
    buffer_load_dwordx4 a[220:223], v10, s[4:7], s23 offen offset:1024
    v_bfe_u32 v1, v0, 1, 1
    v_lshlrev_b32 v11, 15, v1
    v_bfe_u32 v1, v0, 0, 1
    v_lshl_add_u32 v11, v1, 10, v11
    v_bfe_u32 v1, v0, 4, 2
    v_lshl_add_u32 v11, v1, 8, v11
    v_bfe_u32 v1, v0, 2, 2
    v_lshl_add_u32 v11, v1, 4, v11
    v_add_u32 v12, 4096, v11
    v_and_b32 v1, 2, v0
    v_mov_b32 v2, 0x4444
    v_mov_b32 v3, 0xeeee
    v_cmp_eq_u32 vcc, 0, v1
    s_nop 1
    v_cndmask_b32 v229, v3, v2, vcc
    s_waitcnt lgkmcnt(0)
    s_mov_b32 s12, s40
    s_and_b32 s13, s41, 0xffff
    s_mov_b32 s14, 0x380000
    s_mov_b32 s15, 0x00020000
    s_lshl_b32 s44, s31, 16
    s_lshl_b32 s23, s8, 13
    s_add_u32 s44, s44, s23
    s_add_u32 s44, s44, s29
    s_add_u32 s44, s44, 0x1000000
    s_mov_b32 s45, 0x3ffe000
    s_lshl_b32 s46, s8, 12
    s_add_u32 s46, s46, 0x4200000
    s_add_u32 s47, s46, 20480
    s_lshl_b32 s48, s8, 10
    s_add_u32 s48, s48, 0x4204000
    s_add_u32 s49, s48, 20480
    s_mul_i32 s50, s8, 28672
    s_lshl_b32 s23, s30, 5
    s_add_u32 s50, s50, s23
    s_lshl_b32 s23, s8, 11
    v_add_u32 v14, s23, v9
    s_lshl_b32 s23, s8, 10
    v_add_u32 v8, s23, v9
    s_mov_b32 s11, s56
    s_lshl_b32 s57, s31, 2
    s_add_u32 s57, s57, s8
    s_lshl_b32 s57, s57, 7
    s_add_u32 s57, s57, 0x4801000
    s_mov_b32 s58, 0
    s_mul_i32 s23, s56, 458752
    s_add_u32 s44, s44, s23
    s_mul_i32 s23, s56, 16384
    s_add_u32 s45, s45, s23
    s_mul_i32 s23, s56, 40960
    s_add_u32 s46, s46, s23
    s_mul_i32 s23, s56, 40960
    s_add_u32 s47, s47, s23
    s_mul_i32 s23, s56, 40960
    s_add_u32 s48, s48, s23
    s_mul_i32 s23, s56, 40960
    s_add_u32 s49, s49, s23
    s_mul_i32 s23, s56, 57344
    s_add_u32 s50, s50, s23
    v_bfe_u32 v1, v0, 0, 4
    v_mul_u32_u24 v15, 1792, v1
    v_bfe_u32 v1, v0, 4, 2
    v_lshl_add_u32 v15, v1, 3, v15
.wd_55:
    buffer_load_dword v1, off, s[92:95], 0 offset:132 sc1
    s_sub_u32 s19, s19, 1
    s_cbranch_scc1 .abort
    s_waitcnt vmcnt(0)
    v_readfirstlane_b32 s101, v1
    s_and_b32 s100, s101, 0x10000020
    s_cmp_eq_u32 s100, 0x10000020
    s_cbranch_scc1 .wdg_56
    s_sleep 2
    s_branch .wd_55
.wdg_56:
    s_add_u32 s59, s11, 0
    s_min_u32 s59, s59, 63
    s_cmp_gt_u32 s58, s59
    s_cbranch_scc1 .shug_58
    v_mov_b32 v1, 0
.shu_57:
    buffer_load_dwordx4 v[4:7], v1, s[4:7], s57 offen sc1
    s_sub_u32 s19, s19, 1
    s_cbranch_scc1 .abort
    s_waitcnt vmcnt(0)
    v_min_u32 v4, v4, v5
    v_min3_u32 v4, v4, v6, v7
    s_nop 0
    v_readfirstlane_b32 s58, v4
    s_cmp_gt_u32 s58, s59
    s_cbranch_scc1 .shug_58
    s_sleep 8
    s_branch .shu_57
.shug_58:
    buffer_load_dwordx4 v[84:87], v11, s[4:7], s44 offen sc1
    buffer_load_dwordx4 v[88:91], v11, s[4:7], s44 offen offset:2048 sc1
    buffer_load_dwordx4 v[92:95], v12, s[4:7], s44 offen sc1
    buffer_load_dwordx4 v[96:99], v12, s[4:7], s44 offen offset:2048 sc1
    buffer_load_dwordx4 v[16:19], v9, s[4:7], s45 offen sc1
    buffer_load_dwordx4 v[20:23], v9, s[4:7], s45 offen offset:1024 sc1
    buffer_load_dwordx4 v[24:27], v9, s[4:7], s45 offen offset:2048 sc1
    buffer_load_dwordx4 v[28:31], v9, s[4:7], s45 offen offset:3072 sc1
    buffer_load_dwordx4 v[32:35], v13, s[4:7], s45 offen sc1
    buffer_load_dwordx4 v[36:39], v13, s[4:7], s45 offen offset:1024 sc1
    buffer_load_dwordx4 v[40:43], v13, s[4:7], s45 offen offset:2048 sc1
    buffer_load_dwordx4 v[44:47], v9, s[4:7], s46 offen sc1
    buffer_load_dwordx4 v[48:51], v9, s[4:7], s46 offen offset:1024 sc1
    buffer_load_dwordx4 v[52:55], v9, s[4:7], s46 offen offset:2048 sc1
    buffer_load_dwordx4 v[56:59], v9, s[4:7], s46 offen offset:3072 sc1
    buffer_load_dwordx4 v[60:63], v9, s[4:7], s48 offen sc1
    buffer_load_dwordx4 v[64:67], v9, s[4:7], s47 offen sc1
    buffer_load_dwordx4 v[68:71], v9, s[4:7], s47 offen offset:1024 sc1
    buffer_load_dwordx4 v[72:75], v9, s[4:7], s47 offen offset:2048 sc1
    buffer_load_dwordx4 v[76:79], v9, s[4:7], s47 offen offset:3072 sc1
    buffer_load_dwordx4 v[80:83], v9, s[4:7], s49 offen sc1
.sh_loop_59:
    v_mov_b32 v184, 0
    v_mov_b32 v185, 0
    v_mov_b32 v186, 0
    v_mov_b32 v187, 0
    v_mov_b32 v188, 0
    v_mov_b32 v189, 0
    v_mov_b32 v190, 0
    v_mov_b32 v191, 0
    v_mov_b32 v192, 0
    v_mov_b32 v193, 0
    v_mov_b32 v194, 0
    v_mov_b32 v195, 0
    v_mov_b32 v196, 0
    v_mov_b32 v197, 0
    v_mov_b32 v198, 0
    v_mov_b32 v199, 0
    s_waitcnt vmcnt(10)
    v_max3_u32 v228, v16, v17, v18
    v_max3_u32 v228, v228, v19, v20
    v_max3_u32 v228, v228, v21, v22
    v_max3_u32 v228, v228, v23, v24
    v_max3_u32 v228, v228, v25, v26
    v_max3_u32 v228, v228, v27, v28
    v_max3_u32 v228, v228, v29, v30
    v_max3_u32 v228, v228, v31, v32
    v_max3_u32 v228, v228, v33, v34
    v_max3_u32 v228, v228, v35, v36
    v_max3_u32 v228, v228, v37, v38
    v_max3_u32 v228, v228, v39, v40
    v_max3_u32 v228, v228, v41, v42
    v_max_u32 v228, v228, v43
    v_cmp_eq_u32 vcc, -1, v228
    s_cbranch_vccz .sh_mok_60
    v_mov_b32 v1, 0
.pl_61:
    buffer_load_dword v2, v1, s[4:7], s45 offen sc1
    s_waitcnt vmcnt(0)
    v_readfirstlane_b32 s23, v2
    s_cmp_lg_u32 s23, -1
    s_cbranch_scc1 .plg_62
    s_sub_u32 s19, s19, 1
    s_cbranch_scc1 .abort
    s_sleep 2
    s_branch .pl_61
.plg_62:
.pm_63:
    buffer_load_dwordx4 v[16:19], v9, s[4:7], s45 offen sc1
    buffer_load_dwordx4 v[20:23], v9, s[4:7], s45 offen offset:1024 sc1
    buffer_load_dwordx4 v[24:27], v9, s[4:7], s45 offen offset:2048 sc1
    buffer_load_dwordx4 v[28:31], v9, s[4:7], s45 offen offset:3072 sc1
    buffer_load_dwordx4 v[32:35], v13, s[4:7], s45 offen sc1
    buffer_load_dwordx4 v[36:39], v13, s[4:7], s45 offen offset:1024 sc1
    buffer_load_dwordx4 v[40:43], v13, s[4:7], s45 offen offset:2048 sc1
    s_waitcnt vmcnt(0)
    v_max3_u32 v228, v16, v17, v18
    v_max3_u32 v228, v228, v19, v20
    v_max3_u32 v228, v228, v21, v22
    v_max3_u32 v228, v228, v23, v24
    v_max3_u32 v228, v228, v25, v26
    v_max3_u32 v228, v228, v27, v28
    v_max3_u32 v228, v228, v29, v30
    v_max3_u32 v228, v228, v31, v32
    v_max3_u32 v228, v228, v33, v34
    v_max3_u32 v228, v228, v35, v36
    v_max3_u32 v228, v228, v37, v38
    v_max3_u32 v228, v228, v39, v40
    v_max3_u32 v228, v228, v41, v42
    v_max_u32 v228, v228, v43
    v_cmp_eq_u32 vcc, -1, v228
    s_cbranch_vccz .pmg_64
    s_sub_u32 s19, s19, 1
    s_cbranch_scc1 .abort
    s_sleep 1
    s_branch .pm_63
.pmg_64:
.sh_mok_60:
    v_smfmac_f32_16x16x64_bf16 v[184:187], v[16:19], a[0:7], v229
    v_smfmac_f32_16x16x64_bf16 v[188:191], v[16:19], a[56:63], v229
    v_smfmac_f32_16x16x64_bf16 v[192:195], v[16:19], a[112:119], v229
    v_smfmac_f32_16x16x64_bf16 v[196:199], v[16:19], a[168:175], v229
    v_smfmac_f32_16x16x64_bf16 v[184:187], v[20:23], a[8:15], v229
    v_smfmac_f32_16x16x64_bf16 v[188:191], v[20:23], a[64:71], v229
    v_smfmac_f32_16x16x64_bf16 v[192:195], v[20:23], a[120:127], v229
    v_smfmac_f32_16x16x64_bf16 v[196:199], v[20:23], a[176:183], v229
    v_smfmac_f32_16x16x64_bf16 v[184:187], v[24:27], a[16:23], v229
    v_smfmac_f32_16x16x64_bf16 v[188:191], v[24:27], a[72:79], v229
    v_smfmac_f32_16x16x64_bf16 v[192:195], v[24:27], a[128:135], v229
    v_smfmac_f32_16x16x64_bf16 v[196:199], v[24:27], a[184:191], v229
    v_smfmac_f32_16x16x64_bf16 v[184:187], v[28:31], a[24:31], v229
    v_smfmac_f32_16x16x64_bf16 v[188:191], v[28:31], a[80:87], v229
    v_smfmac_f32_16x16x64_bf16 v[192:195], v[28:31], a[136:143], v229
    v_smfmac_f32_16x16x64_bf16 v[196:199], v[28:31], a[192:199], v229
    v_smfmac_f32_16x16x64_bf16 v[184:187], v[32:35], a[32:39], v229
    v_smfmac_f32_16x16x64_bf16 v[188:191], v[32:35], a[88:95], v229
    v_smfmac_f32_16x16x64_bf16 v[192:195], v[32:35], a[144:151], v229
    v_smfmac_f32_16x16x64_bf16 v[196:199], v[32:35], a[200:207], v229
    v_smfmac_f32_16x16x64_bf16 v[184:187], v[36:39], a[40:47], v229
    v_smfmac_f32_16x16x64_bf16 v[188:191], v[36:39], a[96:103], v229
    v_smfmac_f32_16x16x64_bf16 v[192:195], v[36:39], a[152:159], v229
    v_smfmac_f32_16x16x64_bf16 v[196:199], v[36:39], a[208:215], v229
    v_smfmac_f32_16x16x64_bf16 v[184:187], v[40:43], a[48:55], v229
    v_smfmac_f32_16x16x64_bf16 v[188:191], v[40:43], a[104:111], v229
    v_smfmac_f32_16x16x64_bf16 v[192:195], v[40:43], a[160:167], v229
    v_smfmac_f32_16x16x64_bf16 v[196:199], v[40:43], a[216:223], v229
    s_mov_b32 s52, s46
    s_add_u32 s46, s46, 81920
    s_mov_b32 s53, s47
    s_add_u32 s47, s47, 81920
    s_mov_b32 s54, s48
    s_add_u32 s48, s48, 81920
    s_mov_b32 s55, s49
    s_add_u32 s49, s49, 81920
    s_add_u32 s44, s44, 917504
    s_add_u32 s45, s45, 32768
    s_add_u32 s59, s11, 2
    s_min_u32 s59, s59, 63
    s_cmp_gt_u32 s58, s59
    s_cbranch_scc1 .shug_67
    v_mov_b32 v1, 0
.shu_66:
    buffer_load_dwordx4 v[4:7], v1, s[4:7], s57 offen sc1
    s_sub_u32 s19, s19, 1
    s_cbranch_scc1 .abort
    s_waitcnt vmcnt(0)
    v_min_u32 v4, v4, v5
    v_min3_u32 v4, v4, v6, v7
    s_nop 0
    v_readfirstlane_b32 s58, v4
    s_cmp_gt_u32 s58, s59
    s_cbranch_scc1 .shug_67
    s_sleep 8
    s_branch .shu_66
.shug_67:
    buffer_load_dwordx4 v[168:171], v11, s[4:7], s44 offen sc1
    buffer_load_dwordx4 v[172:175], v11, s[4:7], s44 offen offset:2048 sc1
    buffer_load_dwordx4 v[176:179], v12, s[4:7], s44 offen sc1
    buffer_load_dwordx4 v[180:183], v12, s[4:7], s44 offen offset:2048 sc1
    buffer_load_dwordx4 v[100:103], v9, s[4:7], s45 offen sc1
    buffer_load_dwordx4 v[104:107], v9, s[4:7], s45 offen offset:1024 sc1
    buffer_load_dwordx4 v[108:111], v9, s[4:7], s45 offen offset:2048 sc1
    buffer_load_dwordx4 v[112:115], v9, s[4:7], s45 offen offset:3072 sc1
    buffer_load_dwordx4 v[116:119], v13, s[4:7], s45 offen sc1
    buffer_load_dwordx4 v[120:123], v13, s[4:7], s45 offen offset:1024 sc1
    buffer_load_dwordx4 v[124:127], v13, s[4:7], s45 offen offset:2048 sc1
    buffer_load_dwordx4 v[128:131], v9, s[4:7], s46 offen sc1
    buffer_load_dwordx4 v[132:135], v9, s[4:7], s46 offen offset:1024 sc1
    buffer_load_dwordx4 v[136:139], v9, s[4:7], s46 offen offset:2048 sc1
    buffer_load_dwordx4 v[140:143], v9, s[4:7], s46 offen offset:3072 sc1
    buffer_load_dwordx4 v[144:147], v9, s[4:7], s48 offen sc1
    buffer_load_dwordx4 v[148:151], v9, s[4:7], s47 offen sc1
    buffer_load_dwordx4 v[152:155], v9, s[4:7], s47 offen offset:1024 sc1
    buffer_load_dwordx4 v[156:159], v9, s[4:7], s47 offen offset:2048 sc1
    buffer_load_dwordx4 v[160:163], v9, s[4:7], s47 offen offset:3072 sc1
    buffer_load_dwordx4 v[164:167], v9, s[4:7], s49 offen sc1
.sh_nopf_65:
    v_add_f32 v184, v184, v186
    v_add_f32 v185, v185, v187
    v_cvt_pk_bf16_f32 v200, v184, v185
    v_add_f32 v188, v188, v190
    v_add_f32 v189, v189, v191
    v_cvt_pk_bf16_f32 v201, v188, v189
    v_add_f32 v192, v192, v194
    v_add_f32 v193, v193, v195
    v_cvt_pk_bf16_f32 v202, v192, v193
    v_add_f32 v196, v196, v198
    v_add_f32 v197, v197, v199
    v_cvt_pk_bf16_f32 v203, v196, v197
    s_waitcnt vmcnt(21)
    v_max3_u32 v228, v44, v45, v46
    v_max3_u32 v228, v228, v47, v48
    v_max3_u32 v228, v228, v49, v50
    v_max3_u32 v228, v228, v51, v52
    v_max3_u32 v228, v228, v53, v54
    v_max3_u32 v228, v228, v55, v56
    v_max3_u32 v228, v228, v57, v58
    v_max3_u32 v228, v228, v59, v60
    v_max3_u32 v228, v228, v61, v62
    v_max3_u32 v228, v228, v63, v64
    v_max3_u32 v228, v228, v65, v66
    v_max3_u32 v228, v228, v67, v68
    v_max3_u32 v228, v228, v69, v70
    v_max3_u32 v228, v228, v71, v72
    v_max3_u32 v228, v228, v73, v74
    v_max3_u32 v228, v228, v75, v76
    v_max3_u32 v228, v228, v77, v78
    v_max3_u32 v228, v228, v79, v80
    v_max3_u32 v228, v228, v81, v82
    v_max_u32 v228, v228, v83
    v_cmp_eq_u32 vcc, -1, v228
    s_cbranch_vccz .sh_pok_68
.pm_69:
    buffer_load_dwordx4 v[44:47], v9, s[4:7], s52 offen sc1
    buffer_load_dwordx4 v[48:51], v9, s[4:7], s52 offen offset:1024 sc1
    buffer_load_dwordx4 v[52:55], v9, s[4:7], s52 offen offset:2048 sc1
    buffer_load_dwordx4 v[56:59], v9, s[4:7], s52 offen offset:3072 sc1
    buffer_load_dwordx4 v[60:63], v9, s[4:7], s54 offen sc1
    buffer_load_dwordx4 v[64:67], v9, s[4:7], s53 offen sc1
    buffer_load_dwordx4 v[68:71], v9, s[4:7], s53 offen offset:1024 sc1
    buffer_load_dwordx4 v[72:75], v9, s[4:7], s53 offen offset:2048 sc1
    buffer_load_dwordx4 v[76:79], v9, s[4:7], s53 offen offset:3072 sc1
    buffer_load_dwordx4 v[80:83], v9, s[4:7], s55 offen sc1
    s_waitcnt vmcnt(0)
    v_max3_u32 v228, v44, v45, v46
    v_max3_u32 v228, v228, v47, v48
    v_max3_u32 v228, v228, v49, v50
    v_max3_u32 v228, v228, v51, v52
    v_max3_u32 v228, v228, v53, v54
    v_max3_u32 v228, v228, v55, v56
    v_max3_u32 v228, v228, v57, v58
    v_max3_u32 v228, v228, v59, v60
    v_max3_u32 v228, v228, v61, v62
    v_max3_u32 v228, v228, v63, v64
    v_max3_u32 v228, v228, v65, v66
    v_max3_u32 v228, v228, v67, v68
    v_max3_u32 v228, v228, v69, v70
    v_max3_u32 v228, v228, v71, v72
    v_max3_u32 v228, v228, v73, v74
    v_max3_u32 v228, v228, v75, v76
    v_max3_u32 v228, v228, v77, v78
    v_max3_u32 v228, v228, v79, v80
    v_max3_u32 v228, v228, v81, v82
    v_max_u32 v228, v228, v83
    v_cmp_eq_u32 vcc, -1, v228
    s_cbranch_vccz .pmg_70
    s_sub_u32 s19, s19, 1
    s_cbranch_scc1 .abort
    s_sleep 4
    s_branch .pm_69
.pmg_70:
.sh_pok_68:
    v_mfma_f32_16x16x32_bf16 v[204:207], v[84:87], v[44:47], 0
    v_mfma_f32_16x16x32_bf16 v[208:211], v[84:87], v[64:67], 0
    v_mfma_f32_16x16x32_bf16 v[204:207], v[88:91], v[48:51], v[204:207]
    v_mfma_f32_16x16x32_bf16 v[208:211], v[88:91], v[68:71], v[208:211]
    v_mfma_f32_16x16x32_bf16 v[204:207], v[92:95], v[52:55], v[204:207]
    v_mfma_f32_16x16x32_bf16 v[208:211], v[92:95], v[72:75], v[208:211]
    v_mfma_f32_16x16x32_bf16 v[204:207], v[96:99], v[56:59], v[204:207]
    v_mfma_f32_16x16x32_bf16 v[208:211], v[96:99], v[76:79], v[208:211]
    v_mfma_f32_16x16x32_bf16 v[204:207], v[200:203], v[60:63], v[204:207]
    v_mfma_f32_16x16x32_bf16 v[208:211], v[200:203], v[80:83], v[208:211]
    s_nop 7
    ds_write_b128 v14, v[204:207]
    ds_write_b128 v14, v[208:211] offset:1024
    s_waitcnt lgkmcnt(0)
    s_barrier
    s_cmp_ge_u32 s8, 2
    s_cbranch_scc1 .sh_skip_71
    ds_read_b128 v[212:215], v8
    ds_read_b128 v[216:219], v8 offset:2048
    ds_read_b128 v[220:223], v8 offset:4096
    ds_read_b128 v[224:227], v8 offset:6144
    s_waitcnt lgkmcnt(0)
    v_pk_add_f32 v[212:213], v[212:213], v[216:217]
    v_pk_add_f32 v[214:215], v[214:215], v[218:219]
    v_pk_add_f32 v[220:221], v[220:221], v[224:225]
    v_pk_add_f32 v[222:223], v[222:223], v[226:227]
    v_pk_add_f32 v[212:213], v[212:213], v[220:221]
    v_pk_add_f32 v[214:215], v[214:215], v[222:223]
    v_cvt_pk_bf16_f32 v212, v212, v213
    v_cvt_pk_bf16_f32 v213, v214, v215
    buffer_store_dwordx2 v[212:213], v15, s[12:15], s50 offen
.sh_skip_71:
    s_add_u32 s50, s50, 114688
    s_add_u32 s11, s11, 2
    v_mov_b32 v184, 0
    v_mov_b32 v185, 0
    v_mov_b32 v186, 0
    v_mov_b32 v187, 0
    v_mov_b32 v188, 0
    v_mov_b32 v189, 0
    v_mov_b32 v190, 0
    v_mov_b32 v191, 0
    v_mov_b32 v192, 0
    v_mov_b32 v193, 0
    v_mov_b32 v194, 0
    v_mov_b32 v195, 0
    v_mov_b32 v196, 0
    v_mov_b32 v197, 0
    v_mov_b32 v198, 0
    v_mov_b32 v199, 0
    s_waitcnt vmcnt(10)
    v_max3_u32 v228, v100, v101, v102
    v_max3_u32 v228, v228, v103, v104
    v_max3_u32 v228, v228, v105, v106
    v_max3_u32 v228, v228, v107, v108
    v_max3_u32 v228, v228, v109, v110
    v_max3_u32 v228, v228, v111, v112
    v_max3_u32 v228, v228, v113, v114
    v_max3_u32 v228, v228, v115, v116
    v_max3_u32 v228, v228, v117, v118
    v_max3_u32 v228, v228, v119, v120
    v_max3_u32 v228, v228, v121, v122
    v_max3_u32 v228, v228, v123, v124
    v_max3_u32 v228, v228, v125, v126
    v_max_u32 v228, v228, v127
    v_cmp_eq_u32 vcc, -1, v228
    s_cbranch_vccz .sh_mok_72
    v_mov_b32 v1, 0
.pl_73:
    buffer_load_dword v2, v1, s[4:7], s45 offen sc1
    s_waitcnt vmcnt(0)
    v_readfirstlane_b32 s23, v2
    s_cmp_lg_u32 s23, -1
    s_cbranch_scc1 .plg_74
    s_sub_u32 s19, s19, 1
    s_cbranch_scc1 .abort
    s_sleep 2
    s_branch .pl_73
.plg_74:
.pm_75:
    buffer_load_dwordx4 v[100:103], v9, s[4:7], s45 offen sc1
    buffer_load_dwordx4 v[104:107], v9, s[4:7], s45 offen offset:1024 sc1
    buffer_load_dwordx4 v[108:111], v9, s[4:7], s45 offen offset:2048 sc1
    buffer_load_dwordx4 v[112:115], v9, s[4:7], s45 offen offset:3072 sc1
    buffer_load_dwordx4 v[116:119], v13, s[4:7], s45 offen sc1
    buffer_load_dwordx4 v[120:123], v13, s[4:7], s45 offen offset:1024 sc1
    buffer_load_dwordx4 v[124:127], v13, s[4:7], s45 offen offset:2048 sc1
    s_waitcnt vmcnt(0)
    v_max3_u32 v228, v100, v101, v102
    v_max3_u32 v228, v228, v103, v104
    v_max3_u32 v228, v228, v105, v106
    v_max3_u32 v228, v228, v107, v108
    v_max3_u32 v228, v228, v109, v110
    v_max3_u32 v228, v228, v111, v112
    v_max3_u32 v228, v228, v113, v114
    v_max3_u32 v228, v228, v115, v116
    v_max3_u32 v228, v228, v117, v118
    v_max3_u32 v228, v228, v119, v120
    v_max3_u32 v228, v228, v121, v122
    v_max3_u32 v228, v228, v123, v124
    v_max3_u32 v228, v228, v125, v126
    v_max_u32 v228, v228, v127
    v_cmp_eq_u32 vcc, -1, v228
    s_cbranch_vccz .pmg_76
    s_sub_u32 s19, s19, 1
    s_cbranch_scc1 .abort
    s_sleep 1
    s_branch .pm_75
.pmg_76:
.sh_mok_72:
    v_smfmac_f32_16x16x64_bf16 v[184:187], v[100:103], a[0:7], v229
    v_smfmac_f32_16x16x64_bf16 v[188:191], v[100:103], a[56:63], v229
    v_smfmac_f32_16x16x64_bf16 v[192:195], v[100:103], a[112:119], v229
    v_smfmac_f32_16x16x64_bf16 v[196:199], v[100:103], a[168:175], v229
    v_smfmac_f32_16x16x64_bf16 v[184:187], v[104:107], a[8:15], v229
    v_smfmac_f32_16x16x64_bf16 v[188:191], v[104:107], a[64:71], v229
    v_smfmac_f32_16x16x64_bf16 v[192:195], v[104:107], a[120:127], v229
    v_smfmac_f32_16x16x64_bf16 v[196:199], v[104:107], a[176:183], v229
    v_smfmac_f32_16x16x64_bf16 v[184:187], v[108:111], a[16:23], v229
    v_smfmac_f32_16x16x64_bf16 v[188:191], v[108:111], a[72:79], v229
    v_smfmac_f32_16x16x64_bf16 v[192:195], v[108:111], a[128:135], v229
    v_smfmac_f32_16x16x64_bf16 v[196:199], v[108:111], a[184:191], v229
    v_smfmac_f32_16x16x64_bf16 v[184:187], v[112:115], a[24:31], v229
    v_smfmac_f32_16x16x64_bf16 v[188:191], v[112:115], a[80:87], v229
    v_smfmac_f32_16x16x64_bf16 v[192:195], v[112:115], a[136:143], v229
    v_smfmac_f32_16x16x64_bf16 v[196:199], v[112:115], a[192:199], v229
    v_smfmac_f32_16x16x64_bf16 v[184:187], v[116:119], a[32:39], v229
    v_smfmac_f32_16x16x64_bf16 v[188:191], v[116:119], a[88:95], v229
    v_smfmac_f32_16x16x64_bf16 v[192:195], v[116:119], a[144:151], v229
    v_smfmac_f32_16x16x64_bf16 v[196:199], v[116:119], a[200:207], v229
    v_smfmac_f32_16x16x64_bf16 v[184:187], v[120:123], a[40:47], v229
    v_smfmac_f32_16x16x64_bf16 v[188:191], v[120:123], a[96:103], v229
    v_smfmac_f32_16x16x64_bf16 v[192:195], v[120:123], a[152:159], v229
    v_smfmac_f32_16x16x64_bf16 v[196:199], v[120:123], a[208:215], v229
    v_smfmac_f32_16x16x64_bf16 v[184:187], v[124:127], a[48:55], v229
    v_smfmac_f32_16x16x64_bf16 v[188:191], v[124:127], a[104:111], v229
    v_smfmac_f32_16x16x64_bf16 v[192:195], v[124:127], a[160:167], v229
    v_smfmac_f32_16x16x64_bf16 v[196:199], v[124:127], a[216:223], v229
    s_mov_b32 s52, s46
    s_add_u32 s46, s46, 81920
    s_mov_b32 s53, s47
    s_add_u32 s47, s47, 81920
    s_mov_b32 s54, s48
    s_add_u32 s48, s48, 81920
    s_mov_b32 s55, s49
    s_add_u32 s49, s49, 81920
    s_add_u32 s44, s44, 917504
    s_add_u32 s45, s45, 32768
    s_cmp_lt_u32 s11, 62
    s_cbranch_scc1 .sh_pf_78
    s_waitcnt vmcnt(0)
    s_branch .sh_nopf_77
.sh_pf_78:
    s_add_u32 s59, s11, 2
    s_min_u32 s59, s59, 63
    s_cmp_gt_u32 s58, s59
    s_cbranch_scc1 .shug_80
    v_mov_b32 v1, 0
.shu_79:
    buffer_load_dwordx4 v[4:7], v1, s[4:7], s57 offen sc1
    s_sub_u32 s19, s19, 1
    s_cbranch_scc1 .abort
    s_waitcnt vmcnt(0)
    v_min_u32 v4, v4, v5
    v_min3_u32 v4, v4, v6, v7
    s_nop 0
    v_readfirstlane_b32 s58, v4
    s_cmp_gt_u32 s58, s59
    s_cbranch_scc1 .shug_80
    s_sleep 8
    s_branch .shu_79
.shug_80:
    buffer_load_dwordx4 v[84:87], v11, s[4:7], s44 offen sc1
    buffer_load_dwordx4 v[88:91], v11, s[4:7], s44 offen offset:2048 sc1
    buffer_load_dwordx4 v[92:95], v12, s[4:7], s44 offen sc1
    buffer_load_dwordx4 v[96:99], v12, s[4:7], s44 offen offset:2048 sc1
    buffer_load_dwordx4 v[16:19], v9, s[4:7], s45 offen sc1
    buffer_load_dwordx4 v[20:23], v9, s[4:7], s45 offen offset:1024 sc1
    buffer_load_dwordx4 v[24:27], v9, s[4:7], s45 offen offset:2048 sc1
    buffer_load_dwordx4 v[28:31], v9, s[4:7], s45 offen offset:3072 sc1
    buffer_load_dwordx4 v[32:35], v13, s[4:7], s45 offen sc1
    buffer_load_dwordx4 v[36:39], v13, s[4:7], s45 offen offset:1024 sc1
    buffer_load_dwordx4 v[40:43], v13, s[4:7], s45 offen offset:2048 sc1
    buffer_load_dwordx4 v[44:47], v9, s[4:7], s46 offen sc1
    buffer_load_dwordx4 v[48:51], v9, s[4:7], s46 offen offset:1024 sc1
    buffer_load_dwordx4 v[52:55], v9, s[4:7], s46 offen offset:2048 sc1
    buffer_load_dwordx4 v[56:59], v9, s[4:7], s46 offen offset:3072 sc1
    buffer_load_dwordx4 v[60:63], v9, s[4:7], s48 offen sc1
    buffer_load_dwordx4 v[64:67], v9, s[4:7], s47 offen sc1
    buffer_load_dwordx4 v[68:71], v9, s[4:7], s47 offen offset:1024 sc1
    buffer_load_dwordx4 v[72:75], v9, s[4:7], s47 offen offset:2048 sc1
    buffer_load_dwordx4 v[76:79], v9, s[4:7], s47 offen offset:3072 sc1
    buffer_load_dwordx4 v[80:83], v9, s[4:7], s49 offen sc1
.sh_nopf_77:
    v_add_f32 v184, v184, v186
    v_add_f32 v185, v185, v187
    v_cvt_pk_bf16_f32 v200, v184, v185
    v_add_f32 v188, v188, v190
    v_add_f32 v189, v189, v191
    v_cvt_pk_bf16_f32 v201, v188, v189
    v_add_f32 v192, v192, v194
    v_add_f32 v193, v193, v195
    v_cvt_pk_bf16_f32 v202, v192, v193
    v_add_f32 v196, v196, v198
    v_add_f32 v197, v197, v199
    v_cvt_pk_bf16_f32 v203, v196, v197
    s_waitcnt vmcnt(21)
    v_max3_u32 v228, v128, v129, v130
    v_max3_u32 v228, v228, v131, v132
    v_max3_u32 v228, v228, v133, v134
    v_max3_u32 v228, v228, v135, v136
    v_max3_u32 v228, v228, v137, v138
    v_max3_u32 v228, v228, v139, v140
    v_max3_u32 v228, v228, v141, v142
    v_max3_u32 v228, v228, v143, v144
    v_max3_u32 v228, v228, v145, v146
    v_max3_u32 v228, v228, v147, v148
    v_max3_u32 v228, v228, v149, v150
    v_max3_u32 v228, v228, v151, v152
    v_max3_u32 v228, v228, v153, v154
    v_max3_u32 v228, v228, v155, v156
    v_max3_u32 v228, v228, v157, v158
    v_max3_u32 v228, v228, v159, v160
    v_max3_u32 v228, v228, v161, v162
    v_max3_u32 v228, v228, v163, v164
    v_max3_u32 v228, v228, v165, v166
    v_max_u32 v228, v228, v167
    v_cmp_eq_u32 vcc, -1, v228
    s_cbranch_vccz .sh_pok_81
.pm_82:
    buffer_load_dwordx4 v[128:131], v9, s[4:7], s52 offen sc1
    buffer_load_dwordx4 v[132:135], v9, s[4:7], s52 offen offset:1024 sc1
    buffer_load_dwordx4 v[136:139], v9, s[4:7], s52 offen offset:2048 sc1
    buffer_load_dwordx4 v[140:143], v9, s[4:7], s52 offen offset:3072 sc1
    buffer_load_dwordx4 v[144:147], v9, s[4:7], s54 offen sc1
    buffer_load_dwordx4 v[148:151], v9, s[4:7], s53 offen sc1
    buffer_load_dwordx4 v[152:155], v9, s[4:7], s53 offen offset:1024 sc1
    buffer_load_dwordx4 v[156:159], v9, s[4:7], s53 offen offset:2048 sc1
    buffer_load_dwordx4 v[160:163], v9, s[4:7], s53 offen offset:3072 sc1
    buffer_load_dwordx4 v[164:167], v9, s[4:7], s55 offen sc1
    s_waitcnt vmcnt(0)
    v_max3_u32 v228, v128, v129, v130
    v_max3_u32 v228, v228, v131, v132
    v_max3_u32 v228, v228, v133, v134
    v_max3_u32 v228, v228, v135, v136
    v_max3_u32 v228, v228, v137, v138
    v_max3_u32 v228, v228, v139, v140
    v_max3_u32 v228, v228, v141, v142
    v_max3_u32 v228, v228, v143, v144
    v_max3_u32 v228, v228, v145, v146
    v_max3_u32 v228, v228, v147, v148
    v_max3_u32 v228, v228, v149, v150
    v_max3_u32 v228, v228, v151, v152
    v_max3_u32 v228, v228, v153, v154
    v_max3_u32 v228, v228, v155, v156
    v_max3_u32 v228, v228, v157, v158
    v_max3_u32 v228, v228, v159, v160
    v_max3_u32 v228, v228, v161, v162
    v_max3_u32 v228, v228, v163, v164
    v_max3_u32 v228, v228, v165, v166
    v_max_u32 v228, v228, v167
    v_cmp_eq_u32 vcc, -1, v228
    s_cbranch_vccz .pmg_83
    s_sub_u32 s19, s19, 1
    s_cbranch_scc1 .abort
    s_sleep 4
    s_branch .pm_82
.pmg_83:
.sh_pok_81:
    v_mfma_f32_16x16x32_bf16 v[204:207], v[168:171], v[128:131], 0
    v_mfma_f32_16x16x32_bf16 v[208:211], v[168:171], v[148:151], 0
    v_mfma_f32_16x16x32_bf16 v[204:207], v[172:175], v[132:135], v[204:207]
    v_mfma_f32_16x16x32_bf16 v[208:211], v[172:175], v[152:155], v[208:211]
    v_mfma_f32_16x16x32_bf16 v[204:207], v[176:179], v[136:139], v[204:207]
    v_mfma_f32_16x16x32_bf16 v[208:211], v[176:179], v[156:159], v[208:211]
    v_mfma_f32_16x16x32_bf16 v[204:207], v[180:183], v[140:143], v[204:207]
    v_mfma_f32_16x16x32_bf16 v[208:211], v[180:183], v[160:163], v[208:211]
    v_mfma_f32_16x16x32_bf16 v[204:207], v[200:203], v[144:147], v[204:207]
    v_mfma_f32_16x16x32_bf16 v[208:211], v[200:203], v[164:167], v[208:211]
    s_nop 7
    ds_write_b128 v14, v[204:207] offset:8192
    ds_write_b128 v14, v[208:211] offset:9216
    s_waitcnt lgkmcnt(0)
    s_barrier
    s_cmp_ge_u32 s8, 2
    s_cbranch_scc1 .sh_skip_84
    ds_read_b128 v[212:215], v8 offset:8192
    ds_read_b128 v[216:219], v8 offset:10240
    ds_read_b128 v[220:223], v8 offset:12288
    ds_read_b128 v[224:227], v8 offset:14336
    s_waitcnt lgkmcnt(0)
    v_pk_add_f32 v[212:213], v[212:213], v[216:217]
    v_pk_add_f32 v[214:215], v[214:215], v[218:219]
    v_pk_add_f32 v[220:221], v[220:221], v[224:225]
    v_pk_add_f32 v[222:223], v[222:223], v[226:227]
    v_pk_add_f32 v[212:213], v[212:213], v[220:221]
    v_pk_add_f32 v[214:215], v[214:215], v[222:223]
    v_cvt_pk_bf16_f32 v212, v212, v213
    v_cvt_pk_bf16_f32 v213, v214, v215
    buffer_store_dwordx2 v[212:213], v15, s[12:15], s50 offen
.sh_skip_84:
    s_add_u32 s50, s50, 114688
    s_add_u32 s11, s11, 2
    s_cmp_lt_u32 s11, 64
    s_cbranch_scc1 .sh_loop_59
    s_waitcnt vmcnt(0)
    s_endpgm
.role_uw:
    s_load_dwordx2 s[40:41], s[0:1], 0
    s_sub_u32 s30, s9, 32
    v_lshlrev_b32 v9, 4, v0
    s_mul_i32 s22, s8, 1605632
    s_mul_i32 s23, s30, 14336
    s_add_u32 s22, s22, s23
    s_add_u32 s22, s22, 0x700000
    s_waitcnt lgkmcnt(0)
    s_mov_b32 s12, s40
    s_and_b32 s13, s41, 0xffff
    s_mov_b32 s14, 0x1c0000
    s_mov_b32 s15, 0x00020000
    v_bfe_u32 v1, v0, 0, 4
    v_mul_u32_u24 v13, 896, v1
    v_bfe_u32 v1, v0, 4, 2
    v_lshl_add_u32 v13, v1, 4, v13
    s_add_u32 s23, s8, 0
    s_min_u32 s23, s23, 13
    s_lshl_b32 s44, s23, 6
    s_lshl_b32 s48, s23, 11
    s_add_u32 s23, s8, 4
    s_min_u32 s23, s23, 13
    s_lshl_b32 s45, s23, 6
    s_lshl_b32 s49, s23, 11
    s_add_u32 s23, s8, 8
    s_min_u32 s23, s23, 13
    s_lshl_b32 s46, s23, 6
    s_lshl_b32 s50, s23, 11
    s_add_u32 s23, s8, 12
    s_min_u32 s23, s23, 13
    s_lshl_b32 s47, s23, 6
    s_lshl_b32 s51, s23, 11
    s_mov_b32 s52, 0
    s_mov_b32 s53, 0
    s_mov_b32 s54, 0
    v_add_u32 v14, 14336, v13
    s_lshr_b32 s24, s30, 2
    s_lshl_b32 s23, s8, 1
    s_add_u32 s24, s24, s23
    s_sub_u32 s23, s24, 7
    s_min_u32 s24, s24, s23
    s_lshl_b32 s23, s24, 12
    v_add_u32 v100, s23, v9
    s_lshr_b32 s23, s23, 1
    s_add_u32 s32, s22, s23
    s_add_u32 s24, s24, 1
    s_sub_u32 s23, s24, 7
    s_min_u32 s24, s24, s23
    s_lshl_b32 s23, s24, 12
    v_add_u32 v101, s23, v9
    s_lshr_b32 s23, s23, 1
    s_add_u32 s33, s22, s23
    s_add_u32 s24, s24, 1
    s_sub_u32 s23, s24, 7
    s_min_u32 s24, s24, s23
    s_lshl_b32 s23, s24, 12
    v_add_u32 v102, s23, v9
    s_lshr_b32 s23, s23, 1
    s_add_u32 s34, s22, s23
    s_add_u32 s24, s24, 1
    s_sub_u32 s23, s24, 7
    s_min_u32 s24, s24, s23
    s_lshl_b32 s23, s24, 12
    v_add_u32 v103, s23, v9
    s_lshr_b32 s23, s23, 1
    s_add_u32 s35, s22, s23
    s_add_u32 s24, s24, 1
    s_sub_u32 s23, s24, 7
    s_min_u32 s24, s24, s23
    s_lshl_b32 s23, s24, 12
    v_add_u32 v104, s23, v9
    s_lshr_b32 s23, s23, 1
    s_add_u32 s36, s22, s23
    s_add_u32 s24, s24, 1
    s_sub_u32 s23, s24, 7
    s_min_u32 s24, s24, s23
    s_lshl_b32 s23, s24, 12
    v_add_u32 v105, s23, v9
    s_lshr_b32 s23, s23, 1
    s_add_u32 s37, s22, s23
    s_add_u32 s24, s24, 1
    s_sub_u32 s23, s24, 7
    s_min_u32 s24, s24, s23
    s_lshl_b32 s23, s24, 12
    v_add_u32 v106, s23, v9
    s_lshr_b32 s23, s23, 1
    s_add_u32 s38, s22, s23
    s_add_u32 s24, s24, 1
    s_and_b32 s100, s30, 28
    s_add_u32 s100, s100, s8
    s_lshl_b32 s100, s100, 7
    s_add_u32 s100, s100, 0x4802000
.wd_85:
    buffer_load_dword v1, off, s[4:7], s100 sc1
    s_sub_u32 s19, s19, 1
    s_cbranch_scc1 .abort
    s_waitcnt vmcnt(0)
    v_readfirstlane_b32 s101, v1
    s_bfe_u32 s101, s101, 0x80000
    s_cmp_ge_u32 s101, 16
    s_cbranch_scc1 .wdg_86
    s_sleep 2
    s_branch .wd_85
.wdg_86:
    s_add_u32 s23, s32, 0
    buffer_load_dwordx4 a[0:3], v9, s[4:7], s23 offen
    buffer_load_dwordx4 a[4:7], v9, s[4:7], s23 offen offset:1024
    s_add_u32 s23, s32, 401408
    buffer_load_dwordx4 a[56:59], v9, s[4:7], s23 offen
    buffer_load_dwordx4 a[60:63], v9, s[4:7], s23 offen offset:1024
    s_add_u32 s23, s32, 802816
    buffer_load_dwordx4 a[112:115], v9, s[4:7], s23 offen
    buffer_load_dwordx4 a[116:119], v9, s[4:7], s23 offen offset:1024
    s_add_u32 s23, s32, 1204224
    buffer_load_dwordx4 a[168:171], v9, s[4:7], s23 offen
    buffer_load_dwordx4 a[172:175], v9, s[4:7], s23 offen offset:1024
    s_waitcnt vmcnt(30)
    buffer_load_dword v1, off, s[4:7], s100 sc1
    s_add_u32 s24, s53, s48
    s_add_u32 m0, s24, 0
    s_add_u32 s25, s52, s44
    buffer_load_dwordx4 v13, s[12:15], s25 offen lds
    s_add_u32 s24, s53, s48
    s_add_u32 m0, s24, 1024
    s_add_u32 s25, s52, s44
    buffer_load_dwordx4 v14, s[12:15], s25 offen lds
    s_add_u32 s24, s53, s49
    s_add_u32 m0, s24, 0
    s_add_u32 s25, s52, s45
    buffer_load_dwordx4 v13, s[12:15], s25 offen lds
    s_add_u32 s24, s53, s49
    s_add_u32 m0, s24, 1024
    s_add_u32 s25, s52, s45
    buffer_load_dwordx4 v14, s[12:15], s25 offen lds
    s_add_u32 s24, s53, s50
    s_add_u32 m0, s24, 0
    s_add_u32 s25, s52, s46
    buffer_load_dwordx4 v13, s[12:15], s25 offen lds
    s_add_u32 s24, s53, s50
    s_add_u32 m0, s24, 1024
    s_add_u32 s25, s52, s46
    buffer_load_dwordx4 v14, s[12:15], s25 offen lds
    s_add_u32 s24, s53, s51
    s_add_u32 m0, s24, 0
    s_add_u32 s25, s52, s47
    buffer_load_dwordx4 v13, s[12:15], s25 offen lds
    s_add_u32 s24, s53, s51
    s_add_u32 m0, s24, 1024
    s_add_u32 s25, s52, s47
    buffer_load_dwordx4 v14, s[12:15], s25 offen lds
    s_add_u32 s52, s52, 28672
    s_min_u32 s52, s52, 1806336
    s_add_u32 s53, s53, 28672
    s_cmp_ge_u32 s53, 86016
    s_cselect_b32 s53, 0, s53
    s_add_u32 s23, s33, 0
    buffer_load_dwordx4 a[8:11], v9, s[4:7], s23 offen
    buffer_load_dwordx4 a[12:15], v9, s[4:7], s23 offen offset:1024
    s_add_u32 s23, s33, 401408
    buffer_load_dwordx4 a[64:67], v9, s[4:7], s23 offen
    buffer_load_dwordx4 a[68:71], v9, s[4:7], s23 offen offset:1024
    s_add_u32 s23, s33, 802816
    buffer_load_dwordx4 a[120:123], v9, s[4:7], s23 offen
    buffer_load_dwordx4 a[124:127], v9, s[4:7], s23 offen offset:1024
    s_add_u32 s23, s33, 1204224
    buffer_load_dwordx4 a[176:179], v9, s[4:7], s23 offen
    buffer_load_dwordx4 a[180:183], v9, s[4:7], s23 offen offset:1024
    s_waitcnt vmcnt(16)
.stl_87:
    v_readfirstlane_b32 s101, v1
    s_bfe_u32 s101, s101, 0x80008
    s_cmp_lt_u32 s101, 16
    s_cbranch_scc1 .stf_88
    s_waitcnt vmcnt(30)
    buffer_load_dword v1, off, s[4:7], s100 sc1
    s_add_u32 s23, s34, 0
    buffer_load_dwordx4 a[16:19], v9, s[4:7], s23 offen
    buffer_load_dwordx4 a[20:23], v9, s[4:7], s23 offen offset:1024
    s_add_u32 s23, s34, 401408
    buffer_load_dwordx4 a[72:75], v9, s[4:7], s23 offen
    buffer_load_dwordx4 a[76:79], v9, s[4:7], s23 offen offset:1024
    s_add_u32 s23, s34, 802816
    buffer_load_dwordx4 a[128:131], v9, s[4:7], s23 offen
    buffer_load_dwordx4 a[132:135], v9, s[4:7], s23 offen offset:1024
    s_add_u32 s23, s34, 1204224
    buffer_load_dwordx4 a[184:187], v9, s[4:7], s23 offen
    buffer_load_dwordx4 a[188:191], v9, s[4:7], s23 offen offset:1024
    s_add_u32 s23, s35, 0
    buffer_load_dwordx4 a[24:27], v9, s[4:7], s23 offen
    buffer_load_dwordx4 a[28:31], v9, s[4:7], s23 offen offset:1024
    s_add_u32 s23, s35, 401408
    buffer_load_dwordx4 a[80:83], v9, s[4:7], s23 offen
    buffer_load_dwordx4 a[84:87], v9, s[4:7], s23 offen offset:1024
    s_add_u32 s23, s35, 802816
    buffer_load_dwordx4 a[136:139], v9, s[4:7], s23 offen
    buffer_load_dwordx4 a[140:143], v9, s[4:7], s23 offen offset:1024
    s_add_u32 s23, s35, 1204224
    buffer_load_dwordx4 a[192:195], v9, s[4:7], s23 offen
    buffer_load_dwordx4 a[196:199], v9, s[4:7], s23 offen offset:1024
    s_waitcnt vmcnt(16)
.stl_89:
    v_readfirstlane_b32 s101, v1
    s_bfe_u32 s101, s101, 0x80010
    s_cmp_lt_u32 s101, 16
    s_cbranch_scc1 .stf_90
    s_add_u32 s23, s36, 0
    buffer_load_dwordx4 a[32:35], v9, s[4:7], s23 offen
    buffer_load_dwordx4 a[36:39], v9, s[4:7], s23 offen offset:1024
    s_add_u32 s23, s36, 401408
    buffer_load_dwordx4 a[88:91], v9, s[4:7], s23 offen
    buffer_load_dwordx4 a[92:95], v9, s[4:7], s23 offen offset:1024
    s_add_u32 s23, s36, 802816
    buffer_load_dwordx4 a[144:147], v9, s[4:7], s23 offen
    buffer_load_dwordx4 a[148:151], v9, s[4:7], s23 offen offset:1024
    s_add_u32 s23, s36, 1204224
    buffer_load_dwordx4 a[200:203], v9, s[4:7], s23 offen
    buffer_load_dwordx4 a[204:207], v9, s[4:7], s23 offen offset:1024
    s_add_u32 s23, s37, 0
    buffer_load_dwordx4 a[40:43], v9, s[4:7], s23 offen
    buffer_load_dwordx4 a[44:47], v9, s[4:7], s23 offen offset:1024
    s_add_u32 s23, s37, 401408
    buffer_load_dwordx4 a[96:99], v9, s[4:7], s23 offen
    buffer_load_dwordx4 a[100:103], v9, s[4:7], s23 offen offset:1024
    s_add_u32 s23, s37, 802816
    buffer_load_dwordx4 a[152:155], v9, s[4:7], s23 offen
    buffer_load_dwordx4 a[156:159], v9, s[4:7], s23 offen offset:1024
    s_add_u32 s23, s37, 1204224
    buffer_load_dwordx4 a[208:211], v9, s[4:7], s23 offen
    buffer_load_dwordx4 a[212:215], v9, s[4:7], s23 offen offset:1024
    s_add_u32 s23, s38, 0
    buffer_load_dwordx4 a[48:51], v9, s[4:7], s23 offen
    buffer_load_dwordx4 a[52:55], v9, s[4:7], s23 offen offset:1024
    s_add_u32 s23, s38, 401408
    buffer_load_dwordx4 a[104:107], v9, s[4:7], s23 offen
    buffer_load_dwordx4 a[108:111], v9, s[4:7], s23 offen offset:1024
    s_add_u32 s23, s38, 802816
    buffer_load_dwordx4 a[160:163], v9, s[4:7], s23 offen
    buffer_load_dwordx4 a[164:167], v9, s[4:7], s23 offen offset:1024
    s_add_u32 s23, s38, 1204224
    buffer_load_dwordx4 a[216:219], v9, s[4:7], s23 offen
    buffer_load_dwordx4 a[220:223], v9, s[4:7], s23 offen offset:1024
    s_add_u32 s24, s53, s48
    s_add_u32 m0, s24, 0
    s_add_u32 s25, s52, s44
    buffer_load_dwordx4 v13, s[12:15], s25 offen lds
    s_add_u32 s24, s53, s48
    s_add_u32 m0, s24, 1024
    s_add_u32 s25, s52, s44
    buffer_load_dwordx4 v14, s[12:15], s25 offen lds
    s_add_u32 s24, s53, s49
    s_add_u32 m0, s24, 0
    s_add_u32 s25, s52, s45
    buffer_load_dwordx4 v13, s[12:15], s25 offen lds
    s_add_u32 s24, s53, s49
    s_add_u32 m0, s24, 1024
    s_add_u32 s25, s52, s45
    buffer_load_dwordx4 v14, s[12:15], s25 offen lds
    s_add_u32 s24, s53, s50
    s_add_u32 m0, s24, 0
    s_add_u32 s25, s52, s46
    buffer_load_dwordx4 v13, s[12:15], s25 offen lds
    s_add_u32 s24, s53, s50
    s_add_u32 m0, s24, 1024
    s_add_u32 s25, s52, s46
    buffer_load_dwordx4 v14, s[12:15], s25 offen lds
    s_add_u32 s24, s53, s51
    s_add_u32 m0, s24, 0
    s_add_u32 s25, s52, s47
    buffer_load_dwordx4 v13, s[12:15], s25 offen lds
    s_add_u32 s24, s53, s51
    s_add_u32 m0, s24, 1024
    s_add_u32 s25, s52, s47
    buffer_load_dwordx4 v14, s[12:15], s25 offen lds
    s_add_u32 s52, s52, 28672
    s_min_u32 s52, s52, 1806336
    s_add_u32 s53, s53, 28672
    s_cmp_ge_u32 s53, 86016
    s_cselect_b32 s53, 0, s53
    s_lshr_b32 s22, s30, 1
    s_lshl_b32 s22, s22, 15
    s_and_b32 s23, s30, 1
    s_lshl_b32 s23, s23, 10
    s_add_u32 s22, s22, s23
    s_lshl_b32 s23, s8, 13
    s_add_u32 s22, s22, s23
    s_add_u32 s55, s22, 0x1000000
    s_add_u32 s56, s55, 4096
    s_lshr_b32 s22, s30, 2
    s_lshl_b32 s22, s22, 2
    s_add_u32 s22, s22, s8
    s_lshl_b32 s22, s22, 7
    s_and_b32 s23, s30, 3
    s_lshl_b32 s23, s23, 2
    s_add_u32 s22, s22, s23
    s_add_u32 s57, s22, 0x4801000
    s_mov_b32 s11, 0
    v_mov_b32 v10, 0
    s_waitcnt vmcnt(8)
.uw_loop_91:
    v_add_u32 v108, s54, v100
    v_add_u32 v109, s54, v101
    v_add_u32 v110, s54, v102
    v_add_u32 v111, s54, v103
    v_add_u32 v112, s54, v104
    v_add_u32 v113, s54, v105
    v_add_u32 v114, s54, v106
    s_barrier
    ds_read_b128 v[16:19], v108
    ds_read_b128 v[20:23], v108 offset:1024
    ds_read_b128 v[24:27], v108 offset:2048
    ds_read_b128 v[28:31], v108 offset:3072
    ds_read_b128 v[32:35], v109
    ds_read_b128 v[36:39], v109 offset:1024
    v_mov_b32 v12, s11
    s_waitcnt lgkmcnt(4)
    v_mfma_f32_16x16x32_bf16 v[48:51], v[16:19], a[0:3], 0
    ds_read_b128 v[40:43], v109 offset:2048
    v_mfma_f32_16x16x32_bf16 v[52:55], v[20:23], a[0:3], 0
    ds_read_b128 v[44:47], v109 offset:3072
    v_mfma_f32_16x16x32_bf16 v[56:59], v[16:19], a[56:59], 0
    v_mfma_f32_16x16x32_bf16 v[60:63], v[20:23], a[56:59], 0
    s_add_u32 s24, s53, s48
    s_add_u32 m0, s24, 0
    s_add_u32 s25, s52, s44
    buffer_load_dwordx4 v13, s[12:15], s25 offen lds
    v_mfma_f32_16x16x32_bf16 v[64:67], v[16:19], a[112:115], 0
    v_mfma_f32_16x16x32_bf16 v[68:71], v[20:23], a[112:115], 0
    v_mfma_f32_16x16x32_bf16 v[72:75], v[16:19], a[168:171], 0
    v_mfma_f32_16x16x32_bf16 v[76:79], v[20:23], a[168:171], 0
    s_waitcnt lgkmcnt(4)
    v_mfma_f32_16x16x32_bf16 v[48:51], v[24:27], a[4:7], v[48:51]
    ds_read_b128 v[16:19], v110
    v_mfma_f32_16x16x32_bf16 v[52:55], v[28:31], a[4:7], v[52:55]
    ds_read_b128 v[20:23], v110 offset:1024
    v_mfma_f32_16x16x32_bf16 v[56:59], v[24:27], a[60:63], v[56:59]
    v_mfma_f32_16x16x32_bf16 v[60:63], v[28:31], a[60:63], v[60:63]
    s_add_u32 s24, s53, s48
    s_add_u32 m0, s24, 1024
    s_add_u32 s25, s52, s44
    buffer_load_dwordx4 v14, s[12:15], s25 offen lds
    v_mfma_f32_16x16x32_bf16 v[64:67], v[24:27], a[116:119], v[64:67]
    v_mfma_f32_16x16x32_bf16 v[68:71], v[28:31], a[116:119], v[68:71]
    v_mfma_f32_16x16x32_bf16 v[72:75], v[24:27], a[172:175], v[72:75]
    v_mfma_f32_16x16x32_bf16 v[76:79], v[28:31], a[172:175], v[76:79]
    s_waitcnt lgkmcnt(4)
    v_mfma_f32_16x16x32_bf16 v[48:51], v[32:35], a[8:11], v[48:51]
    ds_read_b128 v[24:27], v110 offset:2048
    v_mfma_f32_16x16x32_bf16 v[52:55], v[36:39], a[8:11], v[52:55]
    ds_read_b128 v[28:31], v110 offset:3072
    v_mfma_f32_16x16x32_bf16 v[56:59], v[32:35], a[64:67], v[56:59]
    v_mfma_f32_16x16x32_bf16 v[60:63], v[36:39], a[64:67], v[60:63]
    s_add_u32 s24, s53, s49
    s_add_u32 m0, s24, 0
    s_add_u32 s25, s52, s45
    buffer_load_dwordx4 v13, s[12:15], s25 offen lds
    v_mfma_f32_16x16x32_bf16 v[64:67], v[32:35], a[120:123], v[64:67]
    v_mfma_f32_16x16x32_bf16 v[68:71], v[36:39], a[120:123], v[68:71]
    v_mfma_f32_16x16x32_bf16 v[72:75], v[32:35], a[176:179], v[72:75]
    v_mfma_f32_16x16x32_bf16 v[76:79], v[36:39], a[176:179], v[76:79]
    s_waitcnt lgkmcnt(4)
    v_mfma_f32_16x16x32_bf16 v[48:51], v[40:43], a[12:15], v[48:51]
    ds_read_b128 v[32:35], v111
    v_mfma_f32_16x16x32_bf16 v[52:55], v[44:47], a[12:15], v[52:55]
    ds_read_b128 v[36:39], v111 offset:1024
    v_mfma_f32_16x16x32_bf16 v[56:59], v[40:43], a[68:71], v[56:59]
    v_mfma_f32_16x16x32_bf16 v[60:63], v[44:47], a[68:71], v[60:63]
    s_add_u32 s24, s53, s49
    s_add_u32 m0, s24, 1024
    s_add_u32 s25, s52, s45
    buffer_load_dwordx4 v14, s[12:15], s25 offen lds
    v_mfma_f32_16x16x32_bf16 v[64:67], v[40:43], a[124:127], v[64:67]
    v_mfma_f32_16x16x32_bf16 v[68:71], v[44:47], a[124:127], v[68:71]
    v_mfma_f32_16x16x32_bf16 v[72:75], v[40:43], a[180:183], v[72:75]
    v_mfma_f32_16x16x32_bf16 v[76:79], v[44:47], a[180:183], v[76:79]
    s_waitcnt lgkmcnt(4)
    v_mfma_f32_16x16x32_bf16 v[48:51], v[16:19], a[16:19], v[48:51]
    ds_read_b128 v[40:43], v111 offset:2048
    v_mfma_f32_16x16x32_bf16 v[52:55], v[20:23], a[16:19], v[52:55]
    ds_read_b128 v[44:47], v111 offset:3072
    v_mfma_f32_16x16x32_bf16 v[56:59], v[16:19], a[72:75], v[56:59]
    v_mfma_f32_16x16x32_bf16 v[60:63], v[20:23], a[72:75], v[60:63]
    s_add_u32 s24, s53, s50
    s_add_u32 m0, s24, 0
    s_add_u32 s25, s52, s46
    buffer_load_dwordx4 v13, s[12:15], s25 offen lds
    v_mfma_f32_16x16x32_bf16 v[64:67], v[16:19], a[128:131], v[64:67]
    v_mfma_f32_16x16x32_bf16 v[68:71], v[20:23], a[128:131], v[68:71]
    v_mfma_f32_16x16x32_bf16 v[72:75], v[16:19], a[184:187], v[72:75]
    v_mfma_f32_16x16x32_bf16 v[76:79], v[20:23], a[184:187], v[76:79]
    s_waitcnt lgkmcnt(4)
    v_mfma_f32_16x16x32_bf16 v[48:51], v[24:27], a[20:23], v[48:51]
    ds_read_b128 v[16:19], v112
    v_mfma_f32_16x16x32_bf16 v[52:55], v[28:31], a[20:23], v[52:55]
    ds_read_b128 v[20:23], v112 offset:1024
    v_mfma_f32_16x16x32_bf16 v[56:59], v[24:27], a[76:79], v[56:59]
    v_mfma_f32_16x16x32_bf16 v[60:63], v[28:31], a[76:79], v[60:63]
    s_add_u32 s24, s53, s50
    s_add_u32 m0, s24, 1024
    s_add_u32 s25, s52, s46
    buffer_load_dwordx4 v14, s[12:15], s25 offen lds
    v_mfma_f32_16x16x32_bf16 v[64:67], v[24:27], a[132:135], v[64:67]
    v_mfma_f32_16x16x32_bf16 v[68:71], v[28:31], a[132:135], v[68:71]
    v_mfma_f32_16x16x32_bf16 v[72:75], v[24:27], a[188:191], v[72:75]
    v_mfma_f32_16x16x32_bf16 v[76:79], v[28:31], a[188:191], v[76:79]
    s_waitcnt lgkmcnt(4)
    v_mfma_f32_16x16x32_bf16 v[48:51], v[32:35], a[24:27], v[48:51]
    ds_read_b128 v[24:27], v112 offset:2048
    v_mfma_f32_16x16x32_bf16 v[52:55], v[36:39], a[24:27], v[52:55]
    ds_read_b128 v[28:31], v112 offset:3072
    v_mfma_f32_16x16x32_bf16 v[56:59], v[32:35], a[80:83], v[56:59]
    v_mfma_f32_16x16x32_bf16 v[60:63], v[36:39], a[80:83], v[60:63]
    s_add_u32 s24, s53, s51
    s_add_u32 m0, s24, 0
    s_add_u32 s25, s52, s47
    buffer_load_dwordx4 v13, s[12:15], s25 offen lds
    v_mfma_f32_16x16x32_bf16 v[64:67], v[32:35], a[136:139], v[64:67]
    v_mfma_f32_16x16x32_bf16 v[68:71], v[36:39], a[136:139], v[68:71]
    v_mfma_f32_16x16x32_bf16 v[72:75], v[32:35], a[192:195], v[72:75]
    v_mfma_f32_16x16x32_bf16 v[76:79], v[36:39], a[192:195], v[76:79]
    s_waitcnt lgkmcnt(4)
    v_mfma_f32_16x16x32_bf16 v[48:51], v[40:43], a[28:31], v[48:51]
    ds_read_b128 v[32:35], v113
    v_mfma_f32_16x16x32_bf16 v[52:55], v[44:47], a[28:31], v[52:55]
    ds_read_b128 v[36:39], v113 offset:1024
    v_mfma_f32_16x16x32_bf16 v[56:59], v[40:43], a[84:87], v[56:59]
    v_mfma_f32_16x16x32_bf16 v[60:63], v[44:47], a[84:87], v[60:63]
    s_add_u32 s24, s53, s51
    s_add_u32 m0, s24, 1024
    s_add_u32 s25, s52, s47
    buffer_load_dwordx4 v14, s[12:15], s25 offen lds
    v_mfma_f32_16x16x32_bf16 v[64:67], v[40:43], a[140:143], v[64:67]
    v_mfma_f32_16x16x32_bf16 v[68:71], v[44:47], a[140:143], v[68:71]
    v_mfma_f32_16x16x32_bf16 v[72:75], v[40:43], a[196:199], v[72:75]
    v_mfma_f32_16x16x32_bf16 v[76:79], v[44:47], a[196:199], v[76:79]
    s_waitcnt lgkmcnt(4)
    v_mfma_f32_16x16x32_bf16 v[48:51], v[16:19], a[32:35], v[48:51]
    ds_read_b128 v[40:43], v113 offset:2048
    v_mfma_f32_16x16x32_bf16 v[52:55], v[20:23], a[32:35], v[52:55]
    ds_read_b128 v[44:47], v113 offset:3072
    v_mfma_f32_16x16x32_bf16 v[56:59], v[16:19], a[88:91], v[56:59]
    v_mfma_f32_16x16x32_bf16 v[60:63], v[20:23], a[88:91], v[60:63]
    s_add_u32 s52, s52, 28672
    s_min_u32 s52, s52, 1806336
    s_add_u32 s53, s53, 28672
    s_cmp_ge_u32 s53, 86016
    s_cselect_b32 s53, 0, s53
    v_mfma_f32_16x16x32_bf16 v[64:67], v[16:19], a[144:147], v[64:67]
    v_mfma_f32_16x16x32_bf16 v[68:71], v[20:23], a[144:147], v[68:71]
    v_mfma_f32_16x16x32_bf16 v[72:75], v[16:19], a[200:203], v[72:75]
    v_mfma_f32_16x16x32_bf16 v[76:79], v[20:23], a[200:203], v[76:79]
    s_waitcnt lgkmcnt(4)
    v_mfma_f32_16x16x32_bf16 v[48:51], v[24:27], a[36:39], v[48:51]
    ds_read_b128 v[16:19], v114
    v_mfma_f32_16x16x32_bf16 v[52:55], v[28:31], a[36:39], v[52:55]
    ds_read_b128 v[20:23], v114 offset:1024
    v_mfma_f32_16x16x32_bf16 v[56:59], v[24:27], a[92:95], v[56:59]
    v_mfma_f32_16x16x32_bf16 v[60:63], v[28:31], a[92:95], v[60:63]
    s_waitcnt vmcnt(8)
    s_mov_b64 exec, 1
    buffer_store_dword v12, v10, s[4:7], s57 offen sc1
    s_mov_b64 exec, -1
    v_mfma_f32_16x16x32_bf16 v[64:67], v[24:27], a[148:151], v[64:67]
    v_mfma_f32_16x16x32_bf16 v[68:71], v[28:31], a[148:151], v[68:71]
    v_mfma_f32_16x16x32_bf16 v[72:75], v[24:27], a[204:207], v[72:75]
    v_mfma_f32_16x16x32_bf16 v[76:79], v[28:31], a[204:207], v[76:79]
    s_waitcnt lgkmcnt(4)
    v_mfma_f32_16x16x32_bf16 v[48:51], v[32:35], a[40:43], v[48:51]
    ds_read_b128 v[24:27], v114 offset:2048
    v_mfma_f32_16x16x32_bf16 v[52:55], v[36:39], a[40:43], v[52:55]
    ds_read_b128 v[28:31], v114 offset:3072
    v_mfma_f32_16x16x32_bf16 v[56:59], v[32:35], a[96:99], v[56:59]
    v_mfma_f32_16x16x32_bf16 v[60:63], v[36:39], a[96:99], v[60:63]
    v_mfma_f32_16x16x32_bf16 v[64:67], v[32:35], a[152:155], v[64:67]
    v_mfma_f32_16x16x32_bf16 v[68:71], v[36:39], a[152:155], v[68:71]
    v_mfma_f32_16x16x32_bf16 v[72:75], v[32:35], a[208:211], v[72:75]
    v_mfma_f32_16x16x32_bf16 v[76:79], v[36:39], a[208:211], v[76:79]
    s_waitcnt lgkmcnt(4)
    v_mfma_f32_16x16x32_bf16 v[48:51], v[40:43], a[44:47], v[48:51]
    v_mfma_f32_16x16x32_bf16 v[52:55], v[44:47], a[44:47], v[52:55]
    v_mfma_f32_16x16x32_bf16 v[56:59], v[40:43], a[100:103], v[56:59]
    v_mfma_f32_16x16x32_bf16 v[60:63], v[44:47], a[100:103], v[60:63]
    v_mfma_f32_16x16x32_bf16 v[64:67], v[40:43], a[156:159], v[64:67]
    v_mfma_f32_16x16x32_bf16 v[68:71], v[44:47], a[156:159], v[68:71]
    v_mfma_f32_16x16x32_bf16 v[72:75], v[40:43], a[212:215], v[72:75]
    v_mfma_f32_16x16x32_bf16 v[76:79], v[44:47], a[212:215], v[76:79]
    s_waitcnt lgkmcnt(2)
    v_mfma_f32_16x16x32_bf16 v[48:51], v[16:19], a[48:51], v[48:51]
    v_mfma_f32_16x16x32_bf16 v[52:55], v[20:23], a[48:51], v[52:55]
    v_mfma_f32_16x16x32_bf16 v[56:59], v[16:19], a[104:107], v[56:59]
    v_mfma_f32_16x16x32_bf16 v[60:63], v[20:23], a[104:107], v[60:63]
    v_mfma_f32_16x16x32_bf16 v[64:67], v[16:19], a[160:163], v[64:67]
    v_mfma_f32_16x16x32_bf16 v[68:71], v[20:23], a[160:163], v[68:71]
    v_mfma_f32_16x16x32_bf16 v[72:75], v[16:19], a[216:219], v[72:75]
    v_mfma_f32_16x16x32_bf16 v[76:79], v[20:23], a[216:219], v[76:79]
    s_waitcnt lgkmcnt(0)
    v_mfma_f32_16x16x32_bf16 v[48:51], v[24:27], a[52:55], v[48:51]
    v_mfma_f32_16x16x32_bf16 v[52:55], v[28:31], a[52:55], v[52:55]
    v_mfma_f32_16x16x32_bf16 v[56:59], v[24:27], a[108:111], v[56:59]
    v_mfma_f32_16x16x32_bf16 v[60:63], v[28:31], a[108:111], v[60:63]
    v_mfma_f32_16x16x32_bf16 v[64:67], v[24:27], a[164:167], v[64:67]
    v_mfma_f32_16x16x32_bf16 v[68:71], v[28:31], a[164:167], v[68:71]
    v_mfma_f32_16x16x32_bf16 v[72:75], v[24:27], a[220:223], v[72:75]
    v_mfma_f32_16x16x32_bf16 v[76:79], v[28:31], a[220:223], v[76:79]
    s_add_u32 s54, s54, 28672
    s_cmp_ge_u32 s54, 86016
    s_cselect_b32 s54, 0, s54
    v_cvt_pk_bf16_f32 v80, v48, v49
    v_cvt_pk_bf16_f32 v81, v50, v51
    v_cvt_pk_bf16_f32 v82, v52, v53
    v_cvt_pk_bf16_f32 v83, v54, v55
    buffer_store_dwordx4 v[80:83], v9, s[4:7], s55 offen sc1
    v_cvt_pk_bf16_f32 v84, v56, v57
    v_cvt_pk_bf16_f32 v85, v58, v59
    v_cvt_pk_bf16_f32 v86, v60, v61
    v_cvt_pk_bf16_f32 v87, v62, v63
    buffer_store_dwordx4 v[84:87], v9, s[4:7], s55 offen offset:2048 sc1
    v_cvt_pk_bf16_f32 v88, v64, v65
    v_cvt_pk_bf16_f32 v89, v66, v67
    v_cvt_pk_bf16_f32 v90, v68, v69
    v_cvt_pk_bf16_f32 v91, v70, v71
    buffer_store_dwordx4 v[88:91], v9, s[4:7], s56 offen sc1
    s_nop 3
    v_cvt_pk_bf16_f32 v92, v72, v73
    v_cvt_pk_bf16_f32 v93, v74, v75
    v_cvt_pk_bf16_f32 v94, v76, v77
    v_cvt_pk_bf16_f32 v95, v78, v79
    buffer_store_dwordx4 v[92:95], v9, s[4:7], s56 offen offset:2048 sc1
    s_add_u32 s55, s55, 458752
    s_add_u32 s56, s56, 458752
    s_add_u32 s11, s11, 1
    s_sub_u32 s22, s11, 2
    s_cmp_lt_u32 s22, 62
    s_cbranch_scc1 .uw_loop_91
    s_waitcnt vmcnt(0)
    v_mov_b32 v12, s11
    s_mov_b64 exec, 1
    buffer_store_dword v12, v10, s[4:7], s57 offen sc1
    s_mov_b64 exec, -1
    s_cmp_lt_u32 s11, 64
    s_cbranch_scc1 .uw_loop_91
    s_endpgm
.stf_88:
    buffer_load_dword v1, off, s[4:7], s100 sc1
    s_sub_u32 s19, s19, 1
    s_cbranch_scc1 .abort
    s_waitcnt vmcnt(0)
    s_branch .stl_87
.stf_90:
    buffer_load_dword v1, off, s[4:7], s100 sc1
    s_sub_u32 s19, s19, 1
    s_cbranch_scc1 .abort
    s_waitcnt vmcnt(0)
    s_branch .stl_89
.role_tw:
    s_load_dwordx2 s[40:41], s[0:1], 0
    s_sub_u32 s22, s9, 128
    s_lshr_b32 s30, s22, 2
    s_and_b32 s11, s22, 3
    v_lshlrev_b32 v9, 4, v0
    s_waitcnt lgkmcnt(0)
    s_mov_b32 s12, s40
    s_and_b32 s13, s41, 0xffff
    s_mov_b32 s14, 0x1c0000
    s_mov_b32 s15, 0x00020000
    v_bfe_u32 v1, v0, 0, 4
    v_mul_u32_u24 v13, 896, v1
    v_bfe_u32 v1, v0, 4, 2
    v_lshl_add_u32 v13, v1, 4, v13
    v_add_u32 v14, 14336, v13
    s_add_u32 s23, s8, 0
    s_min_u32 s23, s23, 13
    s_lshl_b32 s44, s23, 6
    s_lshl_b32 s48, s23, 11
    s_add_u32 s23, s8, 4
    s_min_u32 s23, s23, 13
    s_lshl_b32 s45, s23, 6
    s_lshl_b32 s49, s23, 11
    s_add_u32 s23, s8, 8
    s_min_u32 s23, s23, 13
    s_lshl_b32 s46, s23, 6
    s_lshl_b32 s50, s23, 11
    s_add_u32 s23, s8, 12
    s_min_u32 s23, s23, 13
    s_lshl_b32 s47, s23, 6
    s_lshl_b32 s51, s23, 11
    s_mul_i32 s52, s11, 28672
    s_mov_b32 s53, 0
    s_add_u32 s24, s53, s48
    s_add_u32 m0, s24, 0
    s_add_u32 s25, s52, s44
    buffer_load_dwordx4 v13, s[12:15], s25 offen lds
    s_add_u32 s24, s53, s48
    s_add_u32 m0, s24, 1024
    s_add_u32 s25, s52, s44
    buffer_load_dwordx4 v14, s[12:15], s25 offen lds
    s_add_u32 s24, s53, s49
    s_add_u32 m0, s24, 0
    s_add_u32 s25, s52, s45
    buffer_load_dwordx4 v13, s[12:15], s25 offen lds
    s_add_u32 s24, s53, s49
    s_add_u32 m0, s24, 1024
    s_add_u32 s25, s52, s45
    buffer_load_dwordx4 v14, s[12:15], s25 offen lds
    s_add_u32 s24, s53, s50
    s_add_u32 m0, s24, 0
    s_add_u32 s25, s52, s46
    buffer_load_dwordx4 v13, s[12:15], s25 offen lds
    s_add_u32 s24, s53, s50
    s_add_u32 m0, s24, 1024
    s_add_u32 s25, s52, s46
    buffer_load_dwordx4 v14, s[12:15], s25 offen lds
    s_add_u32 s24, s53, s51
    s_add_u32 m0, s24, 0
    s_add_u32 s25, s52, s47
    buffer_load_dwordx4 v13, s[12:15], s25 offen lds
    s_add_u32 s24, s53, s51
    s_add_u32 m0, s24, 1024
    s_add_u32 s25, s52, s47
    buffer_load_dwordx4 v14, s[12:15], s25 offen lds
    s_add_u32 s52, s52, 114688
    s_min_u32 s52, s52, 1806336
    s_xor_b32 s53, s53, 28672
    s_lshl_b32 s100, s30, 7
    s_add_u32 s100, s100, 0x4800800
.wd_92:
    buffer_load_dword v1, off, s[4:7], s100 sc1
    s_sub_u32 s19, s19, 1
    s_cbranch_scc1 .abort
    s_waitcnt vmcnt(0)
    v_readfirstlane_b32 s101, v1
    s_bfe_u32 s101, s101, 0x80010
    s_cmp_ge_u32 s101, 28
    s_cbranch_scc1 .wdg_93
    s_sleep 2
    s_branch .wd_92
.wdg_93:
    s_and_b32 s100, s30, 15
    s_lshl_b32 s100, s100, 7
    s_add_u32 s100, s100, 0x4801000
.wd_94:
    buffer_load_dword v1, off, s[4:7], s100 sc1
    s_sub_u32 s19, s19, 1
    s_cbranch_scc1 .abort
    s_waitcnt vmcnt(0)
    v_readfirstlane_b32 s101, v1
    s_bfe_u32 s101, s101, 0x80000
    s_cmp_ge_u32 s101, 1
    s_cbranch_scc1 .wdg_95
    s_sleep 16
    s_branch .wd_94
.wdg_95:
    s_mul_i32 s22, s30, 401408
    s_mul_i32 s23, s8, 100352
    s_add_u32 s22, s22, s23
    s_add_u32 s22, s22, 0x0
    s_add_u32 s23, s22, 0
    buffer_load_dwordx4 a[0:3], v9, s[4:7], s23 offen
    buffer_load_dwordx4 a[4:7], v9, s[4:7], s23 offen offset:1024
    buffer_load_dwordx4 a[8:11], v9, s[4:7], s23 offen offset:2048
    buffer_load_dwordx4 a[12:15], v9, s[4:7], s23 offen offset:3072
    s_add_u32 s23, s22, 4096
    buffer_load_dwordx4 a[16:19], v9, s[4:7], s23 offen
    buffer_load_dwordx4 a[20:23], v9, s[4:7], s23 offen offset:1024
    buffer_load_dwordx4 a[24:27], v9, s[4:7], s23 offen offset:2048
    buffer_load_dwordx4 a[28:31], v9, s[4:7], s23 offen offset:3072
    s_add_u32 s23, s22, 8192
    buffer_load_dwordx4 a[32:35], v9, s[4:7], s23 offen
    buffer_load_dwordx4 a[36:39], v9, s[4:7], s23 offen offset:1024
    buffer_load_dwordx4 a[40:43], v9, s[4:7], s23 offen offset:2048
    buffer_load_dwordx4 a[44:47], v9, s[4:7], s23 offen offset:3072
    s_add_u32 s23, s22, 12288
    buffer_load_dwordx4 a[48:51], v9, s[4:7], s23 offen
    buffer_load_dwordx4 a[52:55], v9, s[4:7], s23 offen offset:1024
    buffer_load_dwordx4 a[56:59], v9, s[4:7], s23 offen offset:2048
    buffer_load_dwordx4 a[60:63], v9, s[4:7], s23 offen offset:3072
    s_add_u32 s23, s22, 16384
    buffer_load_dwordx4 a[64:67], v9, s[4:7], s23 offen
    buffer_load_dwordx4 a[68:71], v9, s[4:7], s23 offen offset:1024
    buffer_load_dwordx4 a[72:75], v9, s[4:7], s23 offen offset:2048
    buffer_load_dwordx4 a[76:79], v9, s[4:7], s23 offen offset:3072
    s_add_u32 s23, s22, 20480
    buffer_load_dwordx4 a[80:83], v9, s[4:7], s23 offen
    buffer_load_dwordx4 a[84:87], v9, s[4:7], s23 offen offset:1024
    buffer_load_dwordx4 a[88:91], v9, s[4:7], s23 offen offset:2048
    buffer_load_dwordx4 a[92:95], v9, s[4:7], s23 offen offset:3072
    s_add_u32 s23, s22, 24576
    buffer_load_dwordx4 a[96:99], v9, s[4:7], s23 offen
    buffer_load_dwordx4 a[100:103], v9, s[4:7], s23 offen offset:1024
    buffer_load_dwordx4 a[104:107], v9, s[4:7], s23 offen offset:2048
    buffer_load_dwordx4 a[108:111], v9, s[4:7], s23 offen offset:3072
    s_add_u32 s23, s22, 28672
    buffer_load_dwordx4 a[112:115], v9, s[4:7], s23 offen
    buffer_load_dwordx4 a[116:119], v9, s[4:7], s23 offen offset:1024
    buffer_load_dwordx4 a[120:123], v9, s[4:7], s23 offen offset:2048
    buffer_load_dwordx4 a[124:127], v9, s[4:7], s23 offen offset:3072
    s_add_u32 s23, s22, 32768
    buffer_load_dwordx4 a[128:131], v9, s[4:7], s23 offen
    buffer_load_dwordx4 a[132:135], v9, s[4:7], s23 offen offset:1024
    buffer_load_dwordx4 a[136:139], v9, s[4:7], s23 offen offset:2048
    buffer_load_dwordx4 a[140:143], v9, s[4:7], s23 offen offset:3072
    s_add_u32 s23, s22, 36864
    buffer_load_dwordx4 a[144:147], v9, s[4:7], s23 offen
    buffer_load_dwordx4 a[148:151], v9, s[4:7], s23 offen offset:1024
    buffer_load_dwordx4 a[152:155], v9, s[4:7], s23 offen offset:2048
    buffer_load_dwordx4 a[156:159], v9, s[4:7], s23 offen offset:3072
    s_add_u32 s23, s22, 40960
    buffer_load_dwordx4 a[160:163], v9, s[4:7], s23 offen
    buffer_load_dwordx4 a[164:167], v9, s[4:7], s23 offen offset:1024
    buffer_load_dwordx4 a[168:171], v9, s[4:7], s23 offen offset:2048
    buffer_load_dwordx4 a[172:175], v9, s[4:7], s23 offen offset:3072
    s_add_u32 s23, s22, 45056
    buffer_load_dwordx4 a[176:179], v9, s[4:7], s23 offen
    buffer_load_dwordx4 a[180:183], v9, s[4:7], s23 offen offset:1024
    buffer_load_dwordx4 a[184:187], v9, s[4:7], s23 offen offset:2048
    buffer_load_dwordx4 a[188:191], v9, s[4:7], s23 offen offset:3072
    s_waitcnt vmcnt(40)
    s_add_u32 s23, s22, 49152
    buffer_load_dwordx4 a[192:195], v9, s[4:7], s23 offen
    buffer_load_dwordx4 a[196:199], v9, s[4:7], s23 offen offset:1024
    buffer_load_dwordx4 a[200:203], v9, s[4:7], s23 offen offset:2048
    buffer_load_dwordx4 a[204:207], v9, s[4:7], s23 offen offset:3072
    s_add_u32 s23, s22, 53248
    buffer_load_dwordx4 a[208:211], v9, s[4:7], s23 offen
    buffer_load_dwordx4 a[212:215], v9, s[4:7], s23 offen offset:1024
    buffer_load_dwordx4 a[216:219], v9, s[4:7], s23 offen offset:2048
    buffer_load_dwordx4 a[220:223], v9, s[4:7], s23 offen offset:3072
    s_add_u32 s23, s22, 57344
    buffer_load_dwordx4 a[224:227], v9, s[4:7], s23 offen
    buffer_load_dwordx4 a[228:231], v9, s[4:7], s23 offen offset:1024
    buffer_load_dwordx4 a[232:235], v9, s[4:7], s23 offen offset:2048
    buffer_load_dwordx4 a[236:239], v9, s[4:7], s23 offen offset:3072
    s_add_u32 s23, s22, 61440
    buffer_load_dwordx4 a[240:243], v9, s[4:7], s23 offen
    buffer_load_dwordx4 a[244:247], v9, s[4:7], s23 offen offset:1024
    buffer_load_dwordx4 a[248:251], v9, s[4:7], s23 offen offset:2048
    buffer_load_dwordx4 a[252:255], v9, s[4:7], s23 offen offset:3072
    s_waitcnt vmcnt(40)
    s_add_u32 s23, s22, 65536
    buffer_load_dwordx4 v[120:123], v9, s[4:7], s23 offen
    buffer_load_dwordx4 v[124:127], v9, s[4:7], s23 offen offset:1024
    buffer_load_dwordx4 v[128:131], v9, s[4:7], s23 offen offset:2048
    buffer_load_dwordx4 v[132:135], v9, s[4:7], s23 offen offset:3072
    s_add_u32 s23, s22, 69632
    buffer_load_dwordx4 v[136:139], v9, s[4:7], s23 offen
    buffer_load_dwordx4 v[140:143], v9, s[4:7], s23 offen offset:1024
    buffer_load_dwordx4 v[144:147], v9, s[4:7], s23 offen offset:2048
    buffer_load_dwordx4 v[148:151], v9, s[4:7], s23 offen offset:3072
    s_add_u32 s23, s22, 73728
    buffer_load_dwordx4 v[152:155], v9, s[4:7], s23 offen
    buffer_load_dwordx4 v[156:159], v9, s[4:7], s23 offen offset:1024
    buffer_load_dwordx4 v[160:163], v9, s[4:7], s23 offen offset:2048
    buffer_load_dwordx4 v[164:167], v9, s[4:7], s23 offen offset:3072
    s_add_u32 s23, s22, 77824
    buffer_load_dwordx4 v[168:171], v9, s[4:7], s23 offen
    buffer_load_dwordx4 v[172:175], v9, s[4:7], s23 offen offset:1024
    buffer_load_dwordx4 v[176:179], v9, s[4:7], s23 offen offset:2048
    buffer_load_dwordx4 v[180:183], v9, s[4:7], s23 offen offset:3072
    s_waitcnt vmcnt(40)
    s_add_u32 s23, s22, 81920
    buffer_load_dwordx4 v[184:187], v9, s[4:7], s23 offen
    buffer_load_dwordx4 v[188:191], v9, s[4:7], s23 offen offset:1024
    buffer_load_dwordx4 v[192:195], v9, s[4:7], s23 offen offset:2048
    buffer_load_dwordx4 v[196:199], v9, s[4:7], s23 offen offset:3072
    s_add_u32 s23, s22, 86016
    buffer_load_dwordx4 v[200:203], v9, s[4:7], s23 offen
    buffer_load_dwordx4 v[204:207], v9, s[4:7], s23 offen offset:1024
    buffer_load_dwordx4 v[208:211], v9, s[4:7], s23 offen offset:2048
    buffer_load_dwordx4 v[212:215], v9, s[4:7], s23 offen offset:3072
    s_add_u32 s23, s22, 90112
    buffer_load_dwordx4 v[216:219], v9, s[4:7], s23 offen
    buffer_load_dwordx4 v[220:223], v9, s[4:7], s23 offen offset:1024
    buffer_load_dwordx4 v[224:227], v9, s[4:7], s23 offen offset:2048
    buffer_load_dwordx4 v[228:231], v9, s[4:7], s23 offen offset:3072
    s_add_u32 s23, s22, 94208
    buffer_load_dwordx4 v[232:235], v9, s[4:7], s23 offen
    buffer_load_dwordx4 v[236:239], v9, s[4:7], s23 offen offset:1024
    buffer_load_dwordx4 v[240:243], v9, s[4:7], s23 offen offset:2048
    buffer_load_dwordx4 v[244:247], v9, s[4:7], s23 offen offset:3072
    s_waitcnt vmcnt(40)
    s_add_u32 s23, s22, 98304
    buffer_load_dwordx4 v[248:251], v9, s[4:7], s23 offen
    buffer_load_dwordx4 v[252:255], v9, s[4:7], s23 offen offset:1024
    v_bfe_u32 v1, v0, 4, 2
    v_lshlrev_b32 v104, 8, v1
    v_bfe_u32 v1, v0, 2, 2
    v_lshl_add_u32 v104, v1, 6, v104
    v_bfe_u32 v1, v0, 0, 1
    v_lshl_add_u32 v104, v1, 4, v104
    v_bfe_u32 v1, v0, 5, 1
    v_lshlrev_b32 v105, 8, v1
    v_bfe_u32 v1, v0, 4, 1
    v_lshl_add_u32 v105, v1, 5, v105
    v_bfe_u32 v1, v0, 2, 2
    v_lshl_add_u32 v105, v1, 6, v105
    v_bfe_u32 v1, v0, 0, 1
    v_lshl_add_u32 v105, v1, 4, v105
    v_bfe_u32 v1, v0, 5, 1
    v_lshlrev_b32 v106, 11, v1
    v_bfe_u32 v1, v0, 4, 1
    v_lshl_add_u32 v106, v1, 9, v106
    v_bfe_u32 v1, v0, 0, 4
    v_lshl_add_u32 v106, v1, 4, v106
    v_bfe_u32 v1, v0, 5, 1
    v_lshlrev_b32 v119, 9, v1
    v_bfe_u32 v1, v0, 4, 1
    v_lshl_add_u32 v119, v1, 2, v119
    v_bfe_u32 v1, v0, 0, 4
    v_lshl_add_u32 v119, v1, 4, v119
    s_and_b32 s29, s8, 1
    s_lshl_b32 s22, s29, 4
    v_and_b32 v1, 15, v0
    v_add_u32 v1, s22, v1
    v_lshrrev_b32 v2, 4, v0
    v_lshlrev_b32 v2, 2, v2
    v_sub_u32 v3, v1, v2
    s_sub_u32 s54, s29, 1
    s_not_b32 s55, s54
    s_lshl_b32 s22, s8, 12
    s_add_u32 s22, s22, 57344
    v_add_u32 v107, s22, v9
    s_lshl_b32 s22, s29, 11
    s_add_u32 s22, s22, 57344
    v_add_u32 v108, s22, v9
    s_lshl_b32 s22, s8, 10
    s_add_u32 s22, s22, 73728
    v_lshl_add_u32 v109, v0, 3, s22
    s_lshl_b32 s22, s29, 9
    s_add_u32 s22, s22, 73728
    v_lshl_add_u32 v110, v0, 3, s22
    s_lshr_b32 s22, s8, 1
    s_mul_i32 s22, s22, 3584
    s_mul_i32 s23, s29, 1536
    s_add_u32 s56, s22, s23
    s_add_u32 s56, s56, 0x3ffe000
    s_add_u32 s57, s22, 0x3ffec00
    s_lshr_b32 s59, s8, 1
    s_mul_i32 s59, s59, 14336
    s_mul_i32 s58, s29, 6144
    s_add_u32 s58, s58, s59
    s_add_u32 s59, s59, 12288
    s_mul_i32 s22, s29, 20480
    s_add_u32 s22, s22, 0x4200000
    s_lshr_b32 s23, s30, 2
    s_lshl_b32 s23, s23, 10
    s_and_b32 s24, s30, 3
    s_lshl_b32 s24, s24, 2
    s_add_u32 s23, s23, s24
    s_add_u32 s23, s23, s22
    s_add_u32 s43, s23, 16384
    s_lshl_b32 s24, s30, 10
    s_add_u32 s42, s22, s24
    v_cmp_le_i32 s[60:61], 0, v3
    v_cmp_le_i32 s[62:63], 1, v3
    v_cmp_le_i32 s[64:65], 2, v3
    v_cmp_le_i32 s[66:67], 3, v3
    v_cmp_le_i32 s[68:69], 16, v3
    v_cmp_le_i32 s[70:71], 17, v3
    v_cmp_le_i32 s[72:73], 18, v3
    v_cmp_le_i32 s[74:75], 19, v3
.wd_96:
    buffer_load_dword v1, off, s[92:95], 0 offset:132 sc1
    s_sub_u32 s19, s19, 1
    s_cbranch_scc1 .abort
    s_waitcnt vmcnt(0)
    v_readfirstlane_b32 s101, v1
    s_and_b32 s100, s101, 0x10000020
    s_cmp_eq_u32 s100, 0x10000020
    s_cbranch_scc1 .wdg_97
    s_sleep 2
    s_branch .wd_96
.wdg_97:
.tw_loop_98:
    s_xor_b32 s22, s53, 28672
    v_add_u32 v11, s22, v9
    s_waitcnt vmcnt(0)
    s_barrier
    ds_read_b128 v[16:19], v11
    ds_read_b128 v[20:23], v11 offset:1024
    ds_read_b128 v[24:27], v11 offset:2048
    ds_read_b128 v[28:31], v11 offset:3072
    s_waitcnt lgkmcnt(2)
    v_mfma_f32_16x16x32_bf16 v[48:51], a[0:3], v[16:19], 0
    ds_read_b128 v[32:35], v11 offset:4096
    v_mfma_f32_16x16x32_bf16 v[52:55], a[56:59], v[16:19], 0
    ds_read_b128 v[36:39], v11 offset:5120
    v_mfma_f32_16x16x32_bf16 v[56:59], a[112:115], v[16:19], 0
    v_mfma_f32_16x16x32_bf16 v[60:63], a[168:171], v[16:19], 0
    s_add_u32 s24, s53, s48
    s_add_u32 m0, s24, 0
    s_add_u32 s25, s52, s44
    buffer_load_dwordx4 v13, s[12:15], s25 offen lds
    v_mfma_f32_16x16x32_bf16 v[64:67], a[224:227], v[16:19], 0
    v_mfma_f32_16x16x32_bf16 v[68:71], v[144:147], v[16:19], 0
    v_mfma_f32_16x16x32_bf16 v[72:75], v[200:203], v[16:19], 0
    v_mfma_f32_16x16x32_bf16 v[76:79], a[0:3], v[20:23], 0
    v_mfma_f32_16x16x32_bf16 v[80:83], a[56:59], v[20:23], 0
    v_mfma_f32_16x16x32_bf16 v[84:87], a[112:115], v[20:23], 0
    v_mfma_f32_16x16x32_bf16 v[88:91], a[168:171], v[20:23], 0
    v_mfma_f32_16x16x32_bf16 v[92:95], a[224:227], v[20:23], 0
    v_mfma_f32_16x16x32_bf16 v[96:99], v[144:147], v[20:23], 0
    v_mfma_f32_16x16x32_bf16 v[100:103], v[200:203], v[20:23], 0
    s_waitcnt lgkmcnt(2)
    v_mfma_f32_16x16x32_bf16 v[48:51], a[4:7], v[24:27], v[48:51]
    ds_read_b128 v[40:43], v11 offset:6144
    v_mfma_f32_16x16x32_bf16 v[52:55], a[60:63], v[24:27], v[52:55]
    ds_read_b128 v[44:47], v11 offset:7168
    v_mfma_f32_16x16x32_bf16 v[56:59], a[116:119], v[24:27], v[56:59]
    v_mfma_f32_16x16x32_bf16 v[60:63], a[172:175], v[24:27], v[60:63]
    s_add_u32 s24, s53, s48
    s_add_u32 m0, s24, 1024
    s_add_u32 s25, s52, s44
    buffer_load_dwordx4 v14, s[12:15], s25 offen lds
    v_mfma_f32_16x16x32_bf16 v[64:67], a[228:231], v[24:27], v[64:67]
    v_mfma_f32_16x16x32_bf16 v[68:71], v[148:151], v[24:27], v[68:71]
    v_mfma_f32_16x16x32_bf16 v[72:75], v[204:207], v[24:27], v[72:75]
    v_mfma_f32_16x16x32_bf16 v[76:79], a[4:7], v[28:31], v[76:79]
    v_mfma_f32_16x16x32_bf16 v[80:83], a[60:63], v[28:31], v[80:83]
    v_mfma_f32_16x16x32_bf16 v[84:87], a[116:119], v[28:31], v[84:87]
    v_mfma_f32_16x16x32_bf16 v[88:91], a[172:175], v[28:31], v[88:91]
    v_mfma_f32_16x16x32_bf16 v[92:95], a[228:231], v[28:31], v[92:95]
    v_mfma_f32_16x16x32_bf16 v[96:99], v[148:151], v[28:31], v[96:99]
    v_mfma_f32_16x16x32_bf16 v[100:103], v[204:207], v[28:31], v[100:103]
    s_waitcnt lgkmcnt(2)
    v_mfma_f32_16x16x32_bf16 v[48:51], a[8:11], v[32:35], v[48:51]
    ds_read_b128 v[16:19], v11 offset:8192
    v_mfma_f32_16x16x32_bf16 v[52:55], a[64:67], v[32:35], v[52:55]
    ds_read_b128 v[20:23], v11 offset:9216
    v_mfma_f32_16x16x32_bf16 v[56:59], a[120:123], v[32:35], v[56:59]
    v_mfma_f32_16x16x32_bf16 v[60:63], a[176:179], v[32:35], v[60:63]
    s_add_u32 s24, s53, s49
    s_add_u32 m0, s24, 0
    s_add_u32 s25, s52, s45
    buffer_load_dwordx4 v13, s[12:15], s25 offen lds
    v_mfma_f32_16x16x32_bf16 v[64:67], a[232:235], v[32:35], v[64:67]
    v_mfma_f32_16x16x32_bf16 v[68:71], v[152:155], v[32:35], v[68:71]
    v_mfma_f32_16x16x32_bf16 v[72:75], v[208:211], v[32:35], v[72:75]
    v_mfma_f32_16x16x32_bf16 v[76:79], a[8:11], v[36:39], v[76:79]
    v_mfma_f32_16x16x32_bf16 v[80:83], a[64:67], v[36:39], v[80:83]
    v_mfma_f32_16x16x32_bf16 v[84:87], a[120:123], v[36:39], v[84:87]
    v_mfma_f32_16x16x32_bf16 v[88:91], a[176:179], v[36:39], v[88:91]
    v_mfma_f32_16x16x32_bf16 v[92:95], a[232:235], v[36:39], v[92:95]
    v_mfma_f32_16x16x32_bf16 v[96:99], v[152:155], v[36:39], v[96:99]
    v_mfma_f32_16x16x32_bf16 v[100:103], v[208:211], v[36:39], v[100:103]
    s_waitcnt lgkmcnt(2)
    v_mfma_f32_16x16x32_bf16 v[48:51], a[12:15], v[40:43], v[48:51]
    ds_read_b128 v[24:27], v11 offset:10240
    v_mfma_f32_16x16x32_bf16 v[52:55], a[68:71], v[40:43], v[52:55]
    ds_read_b128 v[28:31], v11 offset:11264
    v_mfma_f32_16x16x32_bf16 v[56:59], a[124:127], v[40:43], v[56:59]
    v_mfma_f32_16x16x32_bf16 v[60:63], a[180:183], v[40:43], v[60:63]
    s_add_u32 s24, s53, s49
    s_add_u32 m0, s24, 1024
    s_add_u32 s25, s52, s45
    buffer_load_dwordx4 v14, s[12:15], s25 offen lds
    v_mfma_f32_16x16x32_bf16 v[64:67], a[236:239], v[40:43], v[64:67]
    v_mfma_f32_16x16x32_bf16 v[68:71], v[156:159], v[40:43], v[68:71]
    v_mfma_f32_16x16x32_bf16 v[72:75], v[212:215], v[40:43], v[72:75]
    v_mfma_f32_16x16x32_bf16 v[76:79], a[12:15], v[44:47], v[76:79]
    v_mfma_f32_16x16x32_bf16 v[80:83], a[68:71], v[44:47], v[80:83]
    v_mfma_f32_16x16x32_bf16 v[84:87], a[124:127], v[44:47], v[84:87]
    v_mfma_f32_16x16x32_bf16 v[88:91], a[180:183], v[44:47], v[88:91]
    v_mfma_f32_16x16x32_bf16 v[92:95], a[236:239], v[44:47], v[92:95]
    v_mfma_f32_16x16x32_bf16 v[96:99], v[156:159], v[44:47], v[96:99]
    v_mfma_f32_16x16x32_bf16 v[100:103], v[212:215], v[44:47], v[100:103]
    s_waitcnt lgkmcnt(2)
    v_mfma_f32_16x16x32_bf16 v[48:51], a[16:19], v[16:19], v[48:51]
    ds_read_b128 v[32:35], v11 offset:12288
    v_mfma_f32_16x16x32_bf16 v[52:55], a[72:75], v[16:19], v[52:55]
    ds_read_b128 v[36:39], v11 offset:13312
    v_mfma_f32_16x16x32_bf16 v[56:59], a[128:131], v[16:19], v[56:59]
    v_mfma_f32_16x16x32_bf16 v[60:63], a[184:187], v[16:19], v[60:63]
    s_add_u32 s24, s53, s50
    s_add_u32 m0, s24, 0
    s_add_u32 s25, s52, s46
    buffer_load_dwordx4 v13, s[12:15], s25 offen lds
    v_mfma_f32_16x16x32_bf16 v[64:67], a[240:243], v[16:19], v[64:67]
    v_mfma_f32_16x16x32_bf16 v[68:71], v[160:163], v[16:19], v[68:71]
    v_mfma_f32_16x16x32_bf16 v[72:75], v[216:219], v[16:19], v[72:75]
    v_mfma_f32_16x16x32_bf16 v[76:79], a[16:19], v[20:23], v[76:79]
    v_mfma_f32_16x16x32_bf16 v[80:83], a[72:75], v[20:23], v[80:83]
    v_mfma_f32_16x16x32_bf16 v[84:87], a[128:131], v[20:23], v[84:87]
    v_mfma_f32_16x16x32_bf16 v[88:91], a[184:187], v[20:23], v[88:91]
    v_mfma_f32_16x16x32_bf16 v[92:95], a[240:243], v[20:23], v[92:95]
    v_mfma_f32_16x16x32_bf16 v[96:99], v[160:163], v[20:23], v[96:99]
    v_mfma_f32_16x16x32_bf16 v[100:103], v[216:219], v[20:23], v[100:103]
    s_waitcnt lgkmcnt(2)
    v_mfma_f32_16x16x32_bf16 v[48:51], a[20:23], v[24:27], v[48:51]
    ds_read_b128 v[40:43], v11 offset:14336
    v_mfma_f32_16x16x32_bf16 v[52:55], a[76:79], v[24:27], v[52:55]
    ds_read_b128 v[44:47], v11 offset:15360
    v_mfma_f32_16x16x32_bf16 v[56:59], a[132:135], v[24:27], v[56:59]
    v_mfma_f32_16x16x32_bf16 v[60:63], a[188:191], v[24:27], v[60:63]
    s_add_u32 s24, s53, s50
    s_add_u32 m0, s24, 1024
    s_add_u32 s25, s52, s46
    buffer_load_dwordx4 v14, s[12:15], s25 offen lds
    v_mfma_f32_16x16x32_bf16 v[64:67], a[244:247], v[24:27], v[64:67]
    v_mfma_f32_16x16x32_bf16 v[68:71], v[164:167], v[24:27], v[68:71]
    v_mfma_f32_16x16x32_bf16 v[72:75], v[220:223], v[24:27], v[72:75]
    v_mfma_f32_16x16x32_bf16 v[76:79], a[20:23], v[28:31], v[76:79]
    v_mfma_f32_16x16x32_bf16 v[80:83], a[76:79], v[28:31], v[80:83]
    v_mfma_f32_16x16x32_bf16 v[84:87], a[132:135], v[28:31], v[84:87]
    v_mfma_f32_16x16x32_bf16 v[88:91], a[188:191], v[28:31], v[88:91]
    v_mfma_f32_16x16x32_bf16 v[92:95], a[244:247], v[28:31], v[92:95]
    v_mfma_f32_16x16x32_bf16 v[96:99], v[164:167], v[28:31], v[96:99]
    v_mfma_f32_16x16x32_bf16 v[100:103], v[220:223], v[28:31], v[100:103]
    s_waitcnt lgkmcnt(2)
    v_mfma_f32_16x16x32_bf16 v[48:51], a[24:27], v[32:35], v[48:51]
    ds_read_b128 v[16:19], v11 offset:16384
    v_mfma_f32_16x16x32_bf16 v[52:55], a[80:83], v[32:35], v[52:55]
    ds_read_b128 v[20:23], v11 offset:17408
    v_mfma_f32_16x16x32_bf16 v[56:59], a[136:139], v[32:35], v[56:59]
    v_mfma_f32_16x16x32_bf16 v[60:63], a[192:195], v[32:35], v[60:63]
    s_add_u32 s24, s53, s51
    s_add_u32 m0, s24, 0
    s_add_u32 s25, s52, s47
    buffer_load_dwordx4 v13, s[12:15], s25 offen lds
    v_mfma_f32_16x16x32_bf16 v[64:67], a[248:251], v[32:35], v[64:67]
    v_mfma_f32_16x16x32_bf16 v[68:71], v[168:171], v[32:35], v[68:71]
    v_mfma_f32_16x16x32_bf16 v[72:75], v[224:227], v[32:35], v[72:75]
    v_mfma_f32_16x16x32_bf16 v[76:79], a[24:27], v[36:39], v[76:79]
    v_mfma_f32_16x16x32_bf16 v[80:83], a[80:83], v[36:39], v[80:83]
    v_mfma_f32_16x16x32_bf16 v[84:87], a[136:139], v[36:39], v[84:87]
    v_mfma_f32_16x16x32_bf16 v[88:91], a[192:195], v[36:39], v[88:91]
    v_mfma_f32_16x16x32_bf16 v[92:95], a[248:251], v[36:39], v[92:95]
    v_mfma_f32_16x16x32_bf16 v[96:99], v[168:171], v[36:39], v[96:99]
    v_mfma_f32_16x16x32_bf16 v[100:103], v[224:227], v[36:39], v[100:103]
    s_waitcnt lgkmcnt(2)
    v_mfma_f32_16x16x32_bf16 v[48:51], a[28:31], v[40:43], v[48:51]
    ds_read_b128 v[24:27], v11 offset:18432
    v_mfma_f32_16x16x32_bf16 v[52:55], a[84:87], v[40:43], v[52:55]
    ds_read_b128 v[28:31], v11 offset:19456
    v_mfma_f32_16x16x32_bf16 v[56:59], a[140:143], v[40:43], v[56:59]
    v_mfma_f32_16x16x32_bf16 v[60:63], a[196:199], v[40:43], v[60:63]
    s_add_u32 s24, s53, s51
    s_add_u32 m0, s24, 1024
    s_add_u32 s25, s52, s47
    buffer_load_dwordx4 v14, s[12:15], s25 offen lds
    v_mfma_f32_16x16x32_bf16 v[64:67], a[252:255], v[40:43], v[64:67]
    v_mfma_f32_16x16x32_bf16 v[68:71], v[172:175], v[40:43], v[68:71]
    v_mfma_f32_16x16x32_bf16 v[72:75], v[228:231], v[40:43], v[72:75]
    v_mfma_f32_16x16x32_bf16 v[76:79], a[28:31], v[44:47], v[76:79]
    v_mfma_f32_16x16x32_bf16 v[80:83], a[84:87], v[44:47], v[80:83]
    v_mfma_f32_16x16x32_bf16 v[84:87], a[140:143], v[44:47], v[84:87]
    v_mfma_f32_16x16x32_bf16 v[88:91], a[196:199], v[44:47], v[88:91]
    v_mfma_f32_16x16x32_bf16 v[92:95], a[252:255], v[44:47], v[92:95]
    v_mfma_f32_16x16x32_bf16 v[96:99], v[172:175], v[44:47], v[96:99]
    v_mfma_f32_16x16x32_bf16 v[100:103], v[228:231], v[44:47], v[100:103]
    s_waitcnt lgkmcnt(2)
    v_mfma_f32_16x16x32_bf16 v[48:51], a[32:35], v[16:19], v[48:51]
    ds_read_b128 v[32:35], v11 offset:20480
    v_mfma_f32_16x16x32_bf16 v[52:55], a[88:91], v[16:19], v[52:55]
    ds_read_b128 v[36:39], v11 offset:21504
    v_mfma_f32_16x16x32_bf16 v[56:59], a[144:147], v[16:19], v[56:59]
    v_mfma_f32_16x16x32_bf16 v[60:63], a[200:203], v[16:19], v[60:63]
    s_add_u32 s52, s52, 114688
    s_min_u32 s52, s52, 1806336
    s_xor_b32 s53, s53, 28672
    v_mfma_f32_16x16x32_bf16 v[64:67], v[120:123], v[16:19], v[64:67]
    v_mfma_f32_16x16x32_bf16 v[68:71], v[176:179], v[16:19], v[68:71]
    v_mfma_f32_16x16x32_bf16 v[72:75], v[232:235], v[16:19], v[72:75]
    v_mfma_f32_16x16x32_bf16 v[76:79], a[32:35], v[20:23], v[76:79]
    v_mfma_f32_16x16x32_bf16 v[80:83], a[88:91], v[20:23], v[80:83]
    v_mfma_f32_16x16x32_bf16 v[84:87], a[144:147], v[20:23], v[84:87]
    v_mfma_f32_16x16x32_bf16 v[88:91], a[200:203], v[20:23], v[88:91]
    v_mfma_f32_16x16x32_bf16 v[92:95], v[120:123], v[20:23], v[92:95]
    v_mfma_f32_16x16x32_bf16 v[96:99], v[176:179], v[20:23], v[96:99]
    v_mfma_f32_16x16x32_bf16 v[100:103], v[232:235], v[20:23], v[100:103]
    s_waitcnt lgkmcnt(2)
    v_mfma_f32_16x16x32_bf16 v[48:51], a[36:39], v[24:27], v[48:51]
    ds_read_b128 v[40:43], v11 offset:22528
    v_mfma_f32_16x16x32_bf16 v[52:55], a[92:95], v[24:27], v[52:55]
    ds_read_b128 v[44:47], v11 offset:23552
    v_mfma_f32_16x16x32_bf16 v[56:59], a[148:151], v[24:27], v[56:59]
    v_mfma_f32_16x16x32_bf16 v[60:63], a[204:207], v[24:27], v[60:63]
    v_mfma_f32_16x16x32_bf16 v[64:67], v[124:127], v[24:27], v[64:67]
    v_mfma_f32_16x16x32_bf16 v[68:71], v[180:183], v[24:27], v[68:71]
    v_mfma_f32_16x16x32_bf16 v[72:75], v[236:239], v[24:27], v[72:75]
    v_mfma_f32_16x16x32_bf16 v[76:79], a[36:39], v[28:31], v[76:79]
    v_mfma_f32_16x16x32_bf16 v[80:83], a[92:95], v[28:31], v[80:83]
    v_mfma_f32_16x16x32_bf16 v[84:87], a[148:151], v[28:31], v[84:87]
    v_mfma_f32_16x16x32_bf16 v[88:91], a[204:207], v[28:31], v[88:91]
    v_mfma_f32_16x16x32_bf16 v[92:95], v[124:127], v[28:31], v[92:95]
    v_mfma_f32_16x16x32_bf16 v[96:99], v[180:183], v[28:31], v[96:99]
    v_mfma_f32_16x16x32_bf16 v[100:103], v[236:239], v[28:31], v[100:103]
    s_waitcnt lgkmcnt(2)
    v_mfma_f32_16x16x32_bf16 v[48:51], a[40:43], v[32:35], v[48:51]
    ds_read_b128 v[16:19], v11 offset:24576
    v_mfma_f32_16x16x32_bf16 v[52:55], a[96:99], v[32:35], v[52:55]
    ds_read_b128 v[20:23], v11 offset:25600
    v_mfma_f32_16x16x32_bf16 v[56:59], a[152:155], v[32:35], v[56:59]
    v_mfma_f32_16x16x32_bf16 v[60:63], a[208:211], v[32:35], v[60:63]
    v_mfma_f32_16x16x32_bf16 v[64:67], v[128:131], v[32:35], v[64:67]
    v_mfma_f32_16x16x32_bf16 v[68:71], v[184:187], v[32:35], v[68:71]
    v_mfma_f32_16x16x32_bf16 v[72:75], v[240:243], v[32:35], v[72:75]
    v_mfma_f32_16x16x32_bf16 v[76:79], a[40:43], v[36:39], v[76:79]
    v_mfma_f32_16x16x32_bf16 v[80:83], a[96:99], v[36:39], v[80:83]
    v_mfma_f32_16x16x32_bf16 v[84:87], a[152:155], v[36:39], v[84:87]
    v_mfma_f32_16x16x32_bf16 v[88:91], a[208:211], v[36:39], v[88:91]
    v_mfma_f32_16x16x32_bf16 v[92:95], v[128:131], v[36:39], v[92:95]
    v_mfma_f32_16x16x32_bf16 v[96:99], v[184:187], v[36:39], v[96:99]
    v_mfma_f32_16x16x32_bf16 v[100:103], v[240:243], v[36:39], v[100:103]
    s_waitcnt lgkmcnt(2)
    v_mfma_f32_16x16x32_bf16 v[48:51], a[44:47], v[40:43], v[48:51]
    ds_read_b128 v[24:27], v11 offset:26624
    v_mfma_f32_16x16x32_bf16 v[52:55], a[100:103], v[40:43], v[52:55]
    ds_read_b128 v[28:31], v11 offset:27648
    v_mfma_f32_16x16x32_bf16 v[56:59], a[156:159], v[40:43], v[56:59]
    v_mfma_f32_16x16x32_bf16 v[60:63], a[212:215], v[40:43], v[60:63]
    v_mfma_f32_16x16x32_bf16 v[64:67], v[132:135], v[40:43], v[64:67]
    v_mfma_f32_16x16x32_bf16 v[68:71], v[188:191], v[40:43], v[68:71]
    v_mfma_f32_16x16x32_bf16 v[72:75], v[244:247], v[40:43], v[72:75]
    v_mfma_f32_16x16x32_bf16 v[76:79], a[44:47], v[44:47], v[76:79]
    v_mfma_f32_16x16x32_bf16 v[80:83], a[100:103], v[44:47], v[80:83]
    v_mfma_f32_16x16x32_bf16 v[84:87], a[156:159], v[44:47], v[84:87]
    v_mfma_f32_16x16x32_bf16 v[88:91], a[212:215], v[44:47], v[88:91]
    v_mfma_f32_16x16x32_bf16 v[92:95], v[132:135], v[44:47], v[92:95]
    v_mfma_f32_16x16x32_bf16 v[96:99], v[188:191], v[44:47], v[96:99]
    v_mfma_f32_16x16x32_bf16 v[100:103], v[244:247], v[44:47], v[100:103]
    s_waitcnt lgkmcnt(2)
    v_mfma_f32_16x16x32_bf16 v[48:51], a[48:51], v[16:19], v[48:51]
    v_mfma_f32_16x16x32_bf16 v[52:55], a[104:107], v[16:19], v[52:55]
    v_mfma_f32_16x16x32_bf16 v[56:59], a[160:163], v[16:19], v[56:59]
    v_mfma_f32_16x16x32_bf16 v[60:63], a[216:219], v[16:19], v[60:63]
    v_mfma_f32_16x16x32_bf16 v[64:67], v[136:139], v[16:19], v[64:67]
    v_mfma_f32_16x16x32_bf16 v[68:71], v[192:195], v[16:19], v[68:71]
    v_mfma_f32_16x16x32_bf16 v[72:75], v[248:251], v[16:19], v[72:75]
    v_mfma_f32_16x16x32_bf16 v[76:79], a[48:51], v[20:23], v[76:79]
    v_mfma_f32_16x16x32_bf16 v[80:83], a[104:107], v[20:23], v[80:83]
    v_mfma_f32_16x16x32_bf16 v[84:87], a[160:163], v[20:23], v[84:87]
    v_mfma_f32_16x16x32_bf16 v[88:91], a[216:219], v[20:23], v[88:91]
    v_mfma_f32_16x16x32_bf16 v[92:95], v[136:139], v[20:23], v[92:95]
    v_mfma_f32_16x16x32_bf16 v[96:99], v[192:195], v[20:23], v[96:99]
    v_mfma_f32_16x16x32_bf16 v[100:103], v[248:251], v[20:23], v[100:103]
    s_waitcnt lgkmcnt(0)
    v_mfma_f32_16x16x32_bf16 v[48:51], a[52:55], v[24:27], v[48:51]
    v_mfma_f32_16x16x32_bf16 v[52:55], a[108:111], v[24:27], v[52:55]
    v_mfma_f32_16x16x32_bf16 v[56:59], a[164:167], v[24:27], v[56:59]
    v_mfma_f32_16x16x32_bf16 v[60:63], a[220:223], v[24:27], v[60:63]
    v_mfma_f32_16x16x32_bf16 v[64:67], v[140:143], v[24:27], v[64:67]
    v_mfma_f32_16x16x32_bf16 v[68:71], v[196:199], v[24:27], v[68:71]
    v_mfma_f32_16x16x32_bf16 v[72:75], v[252:255], v[24:27], v[72:75]
    v_mfma_f32_16x16x32_bf16 v[76:79], a[52:55], v[28:31], v[76:79]
    v_mfma_f32_16x16x32_bf16 v[80:83], a[108:111], v[28:31], v[80:83]
    v_mfma_f32_16x16x32_bf16 v[84:87], a[164:167], v[28:31], v[84:87]
    v_mfma_f32_16x16x32_bf16 v[88:91], a[220:223], v[28:31], v[88:91]
    v_mfma_f32_16x16x32_bf16 v[92:95], v[140:143], v[28:31], v[92:95]
    v_mfma_f32_16x16x32_bf16 v[96:99], v[196:199], v[28:31], v[96:99]
    v_mfma_f32_16x16x32_bf16 v[100:103], v[252:255], v[28:31], v[100:103]
    s_add_u32 s24, s53, s58
    s_add_u32 s25, s53, s59
    s_lshl_b32 s22, s11, 14
    s_add_u32 s26, s22, s56
    s_add_u32 s27, s22, s57
    v_cvt_pk_bf16_f32 v16, v48, v49
    v_cvt_pk_bf16_f32 v17, v52, v53
    v_cvt_pk_bf16_f32 v18, v50, v51
    v_cvt_pk_bf16_f32 v19, v54, v55
    v_cvt_pk_bf16_f32 v20, v56, v57
    v_cvt_pk_bf16_f32 v21, v60, v61
    v_cvt_pk_bf16_f32 v22, v58, v59
    v_cvt_pk_bf16_f32 v23, v62, v63
    v_cvt_pk_bf16_f32 v24, v64, v65
    v_cvt_pk_bf16_f32 v25, v68, v69
    v_cvt_pk_bf16_f32 v26, v66, v67
    v_cvt_pk_bf16_f32 v27, v70, v71
    v_cvt_pk_bf16_f32 v28, v72, v73
    v_cvt_pk_bf16_f32 v30, v74, v75
    v_and_b32 v29, s55, v28
    v_and_b32 v31, s55, v30
    v_and_b32 v28, s54, v28
    v_and_b32 v30, s54, v30
    v_cvt_pk_bf16_f32 v32, v76, v77
    v_cvt_pk_bf16_f32 v33, v80, v81
    v_cvt_pk_bf16_f32 v34, v78, v79
    v_cvt_pk_bf16_f32 v35, v82, v83
    v_cvt_pk_bf16_f32 v36, v84, v85
    v_cvt_pk_bf16_f32 v37, v88, v89
    v_cvt_pk_bf16_f32 v38, v86, v87
    v_cvt_pk_bf16_f32 v39, v90, v91
    v_cvt_pk_bf16_f32 v40, v92, v93
    v_cvt_pk_bf16_f32 v41, v96, v97
    v_cvt_pk_bf16_f32 v42, v94, v95
    v_cvt_pk_bf16_f32 v43, v98, v99
    v_cvt_pk_bf16_f32 v44, v100, v101
    v_cvt_pk_bf16_f32 v46, v102, v103
    v_and_b32 v45, s55, v44
    v_and_b32 v47, s55, v46
    v_and_b32 v44, s54, v44
    v_and_b32 v46, s54, v46
    v_add_u32 v114, s24, v106
    v_add_u32 v116, s25, v119
    s_add_u32 s22, s24, 4096
    v_add_u32 v112, s22, v119
    s_add_u32 s24, s24, 1024
    s_add_u32 s25, s25, 1024
    v_add_u32 v115, s24, v106
    v_add_u32 v117, s25, v119
    s_add_u32 s22, s24, 4096
    v_add_u32 v113, s22, v119
    s_add_u32 s24, s24, 1024
    s_add_u32 s25, s25, 1024
    ds_read2_b32 v[48:49], v114 offset0:0 offset1:2
    ds_read2_b32 v[50:51], v114 offset0:64 offset1:66
    ds_read2_b32 v[52:53], v115 offset0:0 offset1:2
    ds_read2_b32 v[54:55], v115 offset0:64 offset1:66
    ds_read2_b32 v[56:57], v114 offset0:1 offset1:3
    ds_read2_b32 v[58:59], v114 offset0:65 offset1:67
    ds_read2_b32 v[60:61], v115 offset0:1 offset1:3
    ds_read2_b32 v[62:63], v115 offset0:65 offset1:67
    ds_read2_b32 v[64:65], v112 offset0:0 offset1:2
    ds_read2_b32 v[66:67], v112 offset0:64 offset1:66
    ds_read2_b32 v[68:69], v113 offset0:0 offset1:2
    ds_read2_b32 v[70:71], v113 offset0:64 offset1:66
    ds_read2_b32 v[72:73], v116 offset0:0 offset1:2
    ds_read2_b32 v[74:75], v116 offset0:64 offset1:66
    ds_read2_b32 v[76:77], v117 offset0:0 offset1:2
    ds_read2_b32 v[78:79], v117 offset0:64 offset1:66
    s_waitcnt lgkmcnt(12)
    v_mfma_f32_16x16x32_bf16 v[80:83], v[48:51], v[16:19], 0
    v_mfma_f32_16x16x32_bf16 v[84:87], v[52:55], v[16:19], 0
    v_mfma_f32_16x16x32_bf16 v[88:91], v[48:51], v[32:35], 0
    v_mfma_f32_16x16x32_bf16 v[92:95], v[52:55], v[32:35], 0
    s_waitcnt lgkmcnt(8)
    v_mfma_f32_16x16x32_bf16 v[80:83], v[56:59], v[20:23], v[80:83]
    v_mfma_f32_16x16x32_bf16 v[84:87], v[60:63], v[20:23], v[84:87]
    v_mfma_f32_16x16x32_bf16 v[88:91], v[56:59], v[36:39], v[88:91]
    v_mfma_f32_16x16x32_bf16 v[92:95], v[60:63], v[36:39], v[92:95]
    s_waitcnt lgkmcnt(4)
    v_mfma_f32_16x16x32_bf16 v[80:83], v[64:67], v[24:27], v[80:83]
    v_mfma_f32_16x16x32_bf16 v[84:87], v[68:71], v[24:27], v[84:87]
    v_mfma_f32_16x16x32_bf16 v[88:91], v[64:67], v[40:43], v[88:91]
    v_mfma_f32_16x16x32_bf16 v[92:95], v[68:71], v[40:43], v[92:95]
    s_waitcnt lgkmcnt(0)
    v_mfma_f32_16x16x32_bf16 v[80:83], v[72:75], v[28:31], v[80:83]
    v_mfma_f32_16x16x32_bf16 v[84:87], v[76:79], v[28:31], v[84:87]
    v_mfma_f32_16x16x32_bf16 v[88:91], v[72:75], v[44:47], v[88:91]
    v_mfma_f32_16x16x32_bf16 v[92:95], v[76:79], v[44:47], v[92:95]
    s_nop 7
    ds_write_b128 v107, v[80:83]
    ds_write_b128 v107, v[84:87] offset:1024
    ds_write_b128 v107, v[88:91] offset:2048
    ds_write_b128 v107, v[92:95] offset:3072
    s_waitcnt lgkmcnt(0)
    s_barrier
    ds_read_b128 v[48:51], v108
    ds_read_b128 v[52:55], v108 offset:1024
    ds_read_b128 v[56:59], v108 offset:4096
    ds_read_b128 v[60:63], v108 offset:5120
    ds_read_b128 v[64:67], v108 offset:8192
    ds_read_b128 v[68:71], v108 offset:9216
    ds_read_b128 v[72:75], v108 offset:12288
    ds_read_b128 v[76:79], v108 offset:13312
    v_mov_b32 v113, 0xf149f2ca
    s_waitcnt lgkmcnt(0)
    v_pk_add_f32 v[48:49], v[48:49], v[56:57]
    v_pk_add_f32 v[64:65], v[64:65], v[72:73]
    v_pk_add_f32 v[80:81], v[48:49], v[64:65]
    v_pk_add_f32 v[50:51], v[50:51], v[58:59]
    v_pk_add_f32 v[66:67], v[66:67], v[74:75]
    v_pk_add_f32 v[82:83], v[50:51], v[66:67]
    v_pk_add_f32 v[52:53], v[52:53], v[60:61]
    v_pk_add_f32 v[68:69], v[68:69], v[76:77]
    v_pk_add_f32 v[84:85], v[52:53], v[68:69]
    v_pk_add_f32 v[54:55], v[54:55], v[62:63]
    v_pk_add_f32 v[70:71], v[70:71], v[78:79]
    v_pk_add_f32 v[86:87], v[54:55], v[70:71]
    v_cndmask_b32 v80, v113, v80, s[60:61]
    v_cndmask_b32 v81, v113, v81, s[62:63]
    v_cndmask_b32 v82, v113, v82, s[64:65]
    v_cndmask_b32 v83, v113, v83, s[66:67]
    v_cndmask_b32 v84, v113, v84, s[68:69]
    v_cndmask_b32 v85, v113, v85, s[70:71]
    v_cndmask_b32 v86, v113, v86, s[72:73]
    v_cndmask_b32 v87, v113, v87, s[74:75]
    v_max3_f32 v112, v80, v81, v82
    v_max3_f32 v112, v112, v83, v84
    v_max3_f32 v112, v112, v85, v86
    v_max_f32 v112, v112, v87
    s_mul_i32 s22, s11, 40960
    s_add_u32 s24, s22, s42
    s_add_u32 s25, s22, s43
.pm_99:
    buffer_load_dwordx4 v[48:51], v104, s[4:7], s26 offen sc1
    buffer_load_dwordx4 v[52:55], v104, s[4:7], s26 offen offset:32 sc1
    buffer_load_dwordx4 v[56:59], v105, s[4:7], s26 offen offset:1024 sc1
    buffer_load_dwordx4 v[60:63], v105, s[4:7], s27 offen sc1
    s_waitcnt vmcnt(0)
    v_max3_u32 v111, v48, v49, v50
    v_max3_u32 v111, v111, v51, v52
    v_max3_u32 v111, v111, v53, v54
    v_max3_u32 v111, v111, v55, v56
    v_max3_u32 v111, v111, v57, v58
    v_max3_u32 v111, v111, v59, v60
    v_max3_u32 v111, v111, v61, v62
    v_max_u32 v111, v111, v63
    v_cmp_eq_u32 vcc, -1, v111
    s_cbranch_vccz .pmg_100
    s_sub_u32 s19, s19, 1
    s_cbranch_scc1 .abort
    s_sleep 4
    s_branch .pm_99
.pmg_100:
    v_mfma_f32_16x16x32_bf16 v[96:99], v[48:51], v[16:19], 0
    v_mfma_f32_16x16x32_bf16 v[100:103], v[48:51], v[32:35], 0
    v_mfma_f32_16x16x32_bf16 v[96:99], v[52:55], v[20:23], v[96:99]
    v_mfma_f32_16x16x32_bf16 v[100:103], v[52:55], v[36:39], v[100:103]
    v_mfma_f32_16x16x32_bf16 v[96:99], v[56:59], v[24:27], v[96:99]
    v_mfma_f32_16x16x32_bf16 v[100:103], v[56:59], v[40:43], v[100:103]
    v_mfma_f32_16x16x32_bf16 v[96:99], v[60:63], v[28:31], v[96:99]
    v_mfma_f32_16x16x32_bf16 v[100:103], v[60:63], v[44:47], v[100:103]
    s_nop 6
    ds_write_b64 v109, v[96:97]
    s_nop 3
    ds_write_b64 v109, v[100:101] offset:512
    s_waitcnt lgkmcnt(0)
    s_barrier
    s_cmp_ge_u32 s8, 2
    s_cbranch_scc1 .tw_next_101
    ds_read_b64 v[96:97], v110
    ds_read_b64 v[98:99], v110 offset:1024
    ds_read_b64 v[100:101], v110 offset:2048
    ds_read_b64 v[102:103], v110 offset:3072
    s_waitcnt lgkmcnt(0)
    v_pk_add_f32 v[96:97], v[96:97], v[98:99]
    v_pk_add_f32 v[100:101], v[100:101], v[102:103]
    v_pk_add_f32 v[88:89], v[96:97], v[100:101]
    v_max3_f32 v112, v112, v88, v89
    v_mov_b32 v113, v112
    s_nop 1
    v_permlane16_swap_b32 v112, v113
    s_nop 0
    v_max_f32 v112, v112, v113
    v_mov_b32 v113, v112
    s_nop 1
    v_permlane32_swap_b32 v112, v113
    s_nop 0
    v_max_f32 v112, v112, v113
    v_sub_f32 v80, v80, v112
    v_sub_f32 v81, v81, v112
    v_sub_f32 v82, v82, v112
    v_sub_f32 v83, v83, v112
    v_sub_f32 v84, v84, v112
    v_sub_f32 v85, v85, v112
    v_sub_f32 v86, v86, v112
    v_sub_f32 v87, v87, v112
    v_sub_f32 v88, v88, v112
    v_sub_f32 v89, v89, v112
    v_exp_f32 v80, v80
    v_exp_f32 v81, v81
    v_exp_f32 v82, v82
    v_exp_f32 v83, v83
    v_exp_f32 v84, v84
    v_exp_f32 v85, v85
    v_exp_f32 v86, v86
    v_exp_f32 v87, v87
    v_exp_f32 v88, v88
    v_exp_f32 v89, v89
    s_nop 0
    v_add_f32 v112, v80, v81
    v_add_f32 v112, v112, v82
    v_add_f32 v112, v112, v83
    v_add_f32 v112, v112, v84
    v_add_f32 v112, v112, v85
    v_add_f32 v112, v112, v86
    v_add_f32 v112, v112, v87
    v_add_f32 v112, v112, v88
    v_add_f32 v112, v112, v89
    v_mov_b32 v113, v112
    s_nop 1
    v_permlane16_swap_b32 v112, v113
    s_nop 0
    v_add_f32 v112, v112, v113
    v_mov_b32 v113, v112
    s_nop 1
    v_permlane32_swap_b32 v112, v113
    s_nop 0
    v_add_f32 v112, v112, v113
    v_rcp_f32 v112, v112
    s_nop 0
    v_mul_f32 v80, v80, v112
    v_mul_f32 v81, v81, v112
    v_mul_f32 v82, v82, v112
    v_mul_f32 v83, v83, v112
    v_mul_f32 v84, v84, v112
    v_mul_f32 v85, v85, v112
    v_mul_f32 v86, v86, v112
    v_mul_f32 v87, v87, v112
    v_mul_f32 v88, v88, v112
    v_mul_f32 v89, v89, v112
    v_cvt_pk_bf16_f32 v114, v80, v81
    v_min_u32 v114, -2, v114
    v_cvt_pk_bf16_f32 v115, v82, v83
    v_min_u32 v115, -2, v115
    v_cvt_pk_bf16_f32 v116, v84, v85
    v_min_u32 v116, -2, v116
    v_cvt_pk_bf16_f32 v117, v86, v87
    v_min_u32 v117, -2, v117
    v_cvt_pk_bf16_f32 v118, v88, v89
    v_min_u32 v118, -2, v118
    buffer_store_dwordx4 v[114:117], v9, s[4:7], s24 offen sc1
    buffer_store_dword v118, v9, s[4:7], s25 offen sc1
.tw_next_101:
    s_add_u32 s11, s11, 4
    s_cmp_lt_u32 s11, 64
    s_cbranch_scc1 .tw_loop_98
    s_waitcnt vmcnt(0)
    s_endpgm
.role_bw:
    s_load_dwordx8 s[48:55], s[0:1], 56
    s_sub_u32 s30, s9, 192
    s_lshr_b32 s22, s30, 1
    s_sub_u32 s23, s30, 32
    s_cmp_lt_u32 s30, 32
    s_cselect_b32 s30, s22, s23
    v_lshlrev_b32 v9, 4, v0
    s_mov_b32 s60, 0x05040100
    s_mov_b32 s61, 0x07060302
    s_mov_b32 s62, 0x3fb8aa3b
    s_mov_b32 s63, 0x358637bd
    s_waitcnt lgkmcnt(0)
    s_mov_b32 s12, s48
    s_and_b32 s13, s49, 0xffff
    s_mov_b32 s14, 0x1c0000
    s_mov_b32 s15, 0x00020000
    s_mov_b32 s32, s50
    s_and_b32 s33, s51, 0xffff
    s_mov_b32 s34, 0x126000
    s_mov_b32 s35, 0x00020000
    s_mov_b32 s36, s52
    s_and_b32 s37, s53, 0xffff
    s_mov_b32 s38, 0x62000
    s_mov_b32 s39, 0x00020000
    s_mov_b32 s40, s54
    s_and_b32 s41, s55, 0xffff
    s_mov_b32 s42, 0x380000
    s_mov_b32 s43, 0x00020000
    v_bfe_u32 v1, v0, 0, 4
    v_mul_u32_u24 v13, 896, v1
    v_bfe_u32 v1, v0, 4, 2
    v_lshl_add_u32 v13, v1, 4, v13
    s_mul_i32 s24, s30, 114688
    s_mul_i32 s25, s8, 28672
    s_add_u32 s24, s24, s25
    s_add_u32 s25, s24, 14336
    s_lshl_b32 s23, s8, 11
    s_add_u32 m0, s23, 0
    s_nop 0
    buffer_load_dwordx4 v13, s[12:15], s24 offen lds
    s_add_u32 m0, s23, 1024
    s_nop 0
    buffer_load_dwordx4 v13, s[12:15], s25 offen lds
    s_add_u32 m0, s23, 8128
    s_nop 0
    buffer_load_dwordx4 v13, s[12:15], s24 offen offset:64 lds
    s_add_u32 m0, s23, 9152
    s_nop 0
    buffer_load_dwordx4 v13, s[12:15], s25 offen offset:64 lds
    s_add_u32 m0, s23, 16256
    s_nop 0
    buffer_load_dwordx4 v13, s[12:15], s24 offen offset:128 lds
    s_add_u32 m0, s23, 17280
    s_nop 0
    buffer_load_dwordx4 v13, s[12:15], s25 offen offset:128 lds
    s_add_u32 m0, s23, 24384
    s_nop 0
    buffer_load_dwordx4 v13, s[12:15], s24 offen offset:192 lds
    s_add_u32 m0, s23, 25408
    s_nop 0
    buffer_load_dwordx4 v13, s[12:15], s25 offen offset:192 lds
    s_add_u32 m0, s23, 32512
    s_nop 0
    buffer_load_dwordx4 v13, s[12:15], s24 offen offset:256 lds
    s_add_u32 m0, s23, 33536
    s_nop 0
    buffer_load_dwordx4 v13, s[12:15], s25 offen offset:256 lds
    s_add_u32 m0, s23, 40640
    s_nop 0
    buffer_load_dwordx4 v13, s[12:15], s24 offen offset:320 lds
    s_add_u32 m0, s23, 41664
    s_nop 0
    buffer_load_dwordx4 v13, s[12:15], s25 offen offset:320 lds
    s_add_u32 m0, s23, 48768
    s_nop 0
    buffer_load_dwordx4 v13, s[12:15], s24 offen offset:384 lds
    s_add_u32 m0, s23, 49792
    s_nop 0
    buffer_load_dwordx4 v13, s[12:15], s25 offen offset:384 lds
    s_add_u32 m0, s23, 56896
    s_nop 0
    buffer_load_dwordx4 v13, s[12:15], s24 offen offset:448 lds
    s_add_u32 m0, s23, 57920
    s_nop 0
    buffer_load_dwordx4 v13, s[12:15], s25 offen offset:448 lds
    s_add_u32 m0, s23, 65024
    s_nop 0
    buffer_load_dwordx4 v13, s[12:15], s24 offen offset:512 lds
    s_add_u32 m0, s23, 66048
    s_nop 0
    buffer_load_dwordx4 v13, s[12:15], s25 offen offset:512 lds
    s_add_u32 m0, s23, 73152
    s_nop 0
    buffer_load_dwordx4 v13, s[12:15], s24 offen offset:576 lds
    s_add_u32 m0, s23, 74176
    s_nop 0
    buffer_load_dwordx4 v13, s[12:15], s25 offen offset:576 lds
    s_add_u32 m0, s23, 81280
    s_nop 0
    buffer_load_dwordx4 v13, s[12:15], s24 offen offset:640 lds
    s_add_u32 m0, s23, 82304
    s_nop 0
    buffer_load_dwordx4 v13, s[12:15], s25 offen offset:640 lds
    s_add_u32 m0, s23, 89408
    s_nop 0
    buffer_load_dwordx4 v13, s[12:15], s24 offen offset:704 lds
    s_add_u32 m0, s23, 90432
    s_nop 0
    buffer_load_dwordx4 v13, s[12:15], s25 offen offset:704 lds
    s_add_u32 m0, s23, 97536
    s_nop 0
    buffer_load_dwordx4 v13, s[12:15], s24 offen offset:768 lds
    s_add_u32 m0, s23, 98560
    s_nop 0
    buffer_load_dwordx4 v13, s[12:15], s25 offen offset:768 lds
    s_add_u32 m0, s23, 105664
    s_nop 0
    buffer_load_dwordx4 v13, s[12:15], s24 offen offset:832 lds
    s_add_u32 m0, s23, 106688
    s_nop 0
    buffer_load_dwordx4 v13, s[12:15], s25 offen offset:832 lds
    s_waitcnt vmcnt(0)
    v_bfe_u32 v1, v0, 4, 2
    v_mul_u32_u24 v10, 21504, v1
    v_bfe_u32 v1, v0, 0, 4
    v_lshl_add_u32 v10, v1, 2, v10
    v_and_b32 v1, 15, v0
    v_cmp_le_u32 vcc, 14, v1
    v_mov_b32 v2, 0x10000000
    s_nop 0
    v_cndmask_b32 v2, 0, v2, vcc
    v_add_u32 v10, v10, v2
    v_add_u32 v11, 5376, v10
    v_add_u32 v12, 10752, v10
    v_add_u32 v13, 16128, v10
    v_cndmask_b32 v15, 1.0, 0, vcc
    v_mul_f32 v3, s63, v15
    v_cmp_eq_u32 vcc, 14, v1
    v_mov_b32 v2, 0x3f803f80
    s_nop 0
    v_cndmask_b32 v4, 0, v2, vcc
    v_lshlrev_b32 v8, 2, v0
    s_barrier
    s_cmp_ge_u32 s9, 224
    s_cbranch_scc1 .b_p2
    s_and_b32 s31, s9, 1
    s_lshl_b32 s31, s31, 2
    s_add_u32 s31, s31, s8
    s_lshl_b32 s31, s31, 1
    s_mov_b32 s29, 0
.b_p1_102:
    s_mul_i32 s44, s31, 56
    s_add_u32 s44, s44, 896
    buffer_load_dword v80, v10, s[32:35], s44 offen
    buffer_load_dword v81, v10, s[32:35], s44 offen offset:2688
    buffer_load_dword v82, v11, s[32:35], s44 offen
    buffer_load_dword v83, v11, s[32:35], s44 offen offset:2688
    buffer_load_dword v84, v12, s[32:35], s44 offen
    buffer_load_dword v85, v12, s[32:35], s44 offen offset:2688
    buffer_load_dword v86, v13, s[32:35], s44 offen
    buffer_load_dword v87, v13, s[32:35], s44 offen offset:2688
    buffer_load_dword v88, v10, s[32:35], s44 offen offset:896
    buffer_load_dword v89, v10, s[32:35], s44 offen offset:3584
    buffer_load_dword v90, v11, s[32:35], s44 offen offset:896
    buffer_load_dword v91, v11, s[32:35], s44 offen offset:3584
    buffer_load_dword v92, v12, s[32:35], s44 offen offset:896
    buffer_load_dword v93, v12, s[32:35], s44 offen offset:3584
    buffer_load_dword v94, v13, s[32:35], s44 offen offset:896
    buffer_load_dword v95, v13, s[32:35], s44 offen offset:3584
    s_add_u32 s44, s44, 86016
    v_mov_b32 v14, v9
    ds_read_b128 v[16:19], v14
    ds_read_b128 v[20:23], v14 offset:1024
    ds_read_b128 v[24:27], v14 offset:2048
    ds_read_b128 v[28:31], v14 offset:3072
    ds_read_b128 v[32:35], v14 offset:4096
    ds_read_b128 v[36:39], v14 offset:5120
    ds_read_b128 v[40:43], v14 offset:6144
    ds_read_b128 v[44:47], v14 offset:7168
    v_add_u32 v14, 0x2000, v14
    v_mov_b32 v128, 0
    v_mov_b32 v129, 0
    v_mov_b32 v130, 0
    v_mov_b32 v131, 0
    v_mov_b32 v132, 0
    v_mov_b32 v133, 0
    v_mov_b32 v134, 0
    v_mov_b32 v135, 0
    v_mov_b32 v136, 0
    v_mov_b32 v137, 0
    v_mov_b32 v138, 0
    v_mov_b32 v139, 0
    v_mov_b32 v140, 0
    v_mov_b32 v141, 0
    v_mov_b32 v142, 0
    v_mov_b32 v143, 0
    v_mov_b32 v144, 0
    v_mov_b32 v145, 0
    v_mov_b32 v146, 0
    v_mov_b32 v147, 0
    v_mov_b32 v148, 0
    v_mov_b32 v149, 0
    v_mov_b32 v150, 0
    v_mov_b32 v151, 0
    v_mov_b32 v152, 0
    v_mov_b32 v153, 0
    v_mov_b32 v154, 0
    v_mov_b32 v155, 0
    v_mov_b32 v156, 0
    v_mov_b32 v157, 0
    v_mov_b32 v158, 0
    v_mov_b32 v159, 0
    v_mov_b32 v160, 0
    v_mov_b32 v161, 0
    v_mov_b32 v162, 0
    v_mov_b32 v163, 0
    v_mov_b32 v164, 0
    v_mov_b32 v165, 0
    v_mov_b32 v166, 0
    v_mov_b32 v167, 0
    v_mov_b32 v168, 0
    v_mov_b32 v169, 0
    v_mov_b32 v170, 0
    v_mov_b32 v171, 0
    v_mov_b32 v172, 0
    v_mov_b32 v173, 0
    v_mov_b32 v174, 0
    v_mov_b32 v175, 0
    v_mov_b32 v176, 0
    v_mov_b32 v177, 0
    v_mov_b32 v178, 0
    v_mov_b32 v179, 0
    v_mov_b32 v180, 0
    v_mov_b32 v181, 0
    v_mov_b32 v182, 0
    v_mov_b32 v183, 0
    v_mov_b32 v184, 0
    v_mov_b32 v185, 0
    v_mov_b32 v186, 0
    v_mov_b32 v187, 0
    v_mov_b32 v188, 0
    v_mov_b32 v189, 0
    v_mov_b32 v190, 0
    v_mov_b32 v191, 0
    v_mov_b32 v192, 0
    v_mov_b32 v193, 0
    v_mov_b32 v194, 0
    v_mov_b32 v195, 0
    v_mov_b32 v196, 0
    v_mov_b32 v197, 0
    v_mov_b32 v198, 0
    v_mov_b32 v199, 0
    v_mov_b32 v200, 0
    v_mov_b32 v201, 0
    v_mov_b32 v202, 0
    v_mov_b32 v203, 0
    v_mov_b32 v204, 0
    v_mov_b32 v205, 0
    v_mov_b32 v206, 0
    v_mov_b32 v207, 0
    v_mov_b32 v208, 0
    v_mov_b32 v209, 0
    v_mov_b32 v210, 0
    v_mov_b32 v211, 0
    v_mov_b32 v212, 0
    v_mov_b32 v213, 0
    v_mov_b32 v214, 0
    v_mov_b32 v215, 0
    v_mov_b32 v216, 0
    v_mov_b32 v217, 0
    v_mov_b32 v218, 0
    v_mov_b32 v219, 0
    v_mov_b32 v220, 0
    v_mov_b32 v221, 0
    v_mov_b32 v222, 0
    v_mov_b32 v223, 0
    v_mov_b32 v224, 0
    v_mov_b32 v225, 0
    v_mov_b32 v226, 0
    v_mov_b32 v227, 0
    v_mov_b32 v228, 0
    v_mov_b32 v229, 0
    v_mov_b32 v230, 0
    v_mov_b32 v231, 0
    v_mov_b32 v232, 0
    v_mov_b32 v233, 0
    v_mov_b32 v234, 0
    v_mov_b32 v235, 0
    v_mov_b32 v236, 0
    v_mov_b32 v237, 0
    v_mov_b32 v238, 0
    v_mov_b32 v239, 0
    v_mov_b32 v240, 0
    v_mov_b32 v241, 0
    v_mov_b32 v242, 0
    v_mov_b32 v243, 0
    v_mov_b32 v244, 0
    v_mov_b32 v245, 0
    v_mov_b32 v246, 0
    v_mov_b32 v247, 0
    v_mov_b32 v248, 0
    v_mov_b32 v249, 0
    v_mov_b32 v250, 0
    v_mov_b32 v251, 0
    v_mov_b32 v252, 0
    v_mov_b32 v253, 0
    v_mov_b32 v254, 0
    v_mov_b32 v255, 0
    s_mov_b32 s45, 7
.bg_103:
    buffer_load_dword v96, v10, s[32:35], s44 offen
    buffer_load_dword v97, v10, s[32:35], s44 offen offset:2688
    buffer_load_dword v98, v11, s[32:35], s44 offen
    buffer_load_dword v99, v11, s[32:35], s44 offen offset:2688
    buffer_load_dword v100, v12, s[32:35], s44 offen
    buffer_load_dword v101, v12, s[32:35], s44 offen offset:2688
    buffer_load_dword v102, v13, s[32:35], s44 offen
    buffer_load_dword v103, v13, s[32:35], s44 offen offset:2688
    buffer_load_dword v104, v10, s[32:35], s44 offen offset:896
    buffer_load_dword v105, v10, s[32:35], s44 offen offset:3584
    buffer_load_dword v106, v11, s[32:35], s44 offen offset:896
    buffer_load_dword v107, v11, s[32:35], s44 offen offset:3584
    buffer_load_dword v108, v12, s[32:35], s44 offen offset:896
    buffer_load_dword v109, v12, s[32:35], s44 offen offset:3584
    buffer_load_dword v110, v13, s[32:35], s44 offen offset:896
    buffer_load_dword v111, v13, s[32:35], s44 offen offset:3584
    s_add_u32 s44, s44, 86016
    s_waitcnt vmcnt(16)
    v_perm_b32 v112, v81, v80, s60
    v_perm_b32 v113, v83, v82, s60
    v_perm_b32 v114, v85, v84, s60
    v_perm_b32 v115, v87, v86, s60
    v_perm_b32 v116, v81, v80, s61
    v_perm_b32 v117, v83, v82, s61
    v_perm_b32 v118, v85, v84, s61
    v_perm_b32 v119, v87, v86, s61
    v_perm_b32 v120, v89, v88, s60
    v_perm_b32 v121, v91, v90, s60
    v_perm_b32 v122, v93, v92, s60
    v_perm_b32 v123, v95, v94, s60
    v_perm_b32 v124, v89, v88, s61
    v_perm_b32 v125, v91, v90, s61
    v_perm_b32 v126, v93, v92, s61
    v_perm_b32 v127, v95, v94, s61
    s_waitcnt lgkmcnt(0)
    ds_read_b128 v[48:51], v14
    ds_read_b128 v[52:55], v14 offset:1024
    ds_read_b128 v[56:59], v14 offset:2048
    ds_read_b128 v[60:63], v14 offset:3072
    ds_read_b128 v[64:67], v14 offset:4096
    ds_read_b128 v[68:71], v14 offset:5120
    ds_read_b128 v[72:75], v14 offset:6144
    ds_read_b128 v[76:79], v14 offset:7168
    v_add_u32 v14, 0x2000, v14
    v_mfma_f32_16x16x32_bf16 v[128:131], v[16:19], v[112:115], v[128:131]
    v_mfma_f32_16x16x32_bf16 v[160:163], v[16:19], v[116:119], v[160:163]
    v_mfma_f32_16x16x32_bf16 v[192:195], v[16:19], v[120:123], v[192:195]
    v_mfma_f32_16x16x32_bf16 v[224:227], v[16:19], v[124:127], v[224:227]
    v_mfma_f32_16x16x32_bf16 v[132:135], v[20:23], v[112:115], v[132:135]
    v_mfma_f32_16x16x32_bf16 v[164:167], v[20:23], v[116:119], v[164:167]
    v_mfma_f32_16x16x32_bf16 v[196:199], v[20:23], v[120:123], v[196:199]
    v_mfma_f32_16x16x32_bf16 v[228:231], v[20:23], v[124:127], v[228:231]
    v_mfma_f32_16x16x32_bf16 v[136:139], v[24:27], v[112:115], v[136:139]
    v_mfma_f32_16x16x32_bf16 v[168:171], v[24:27], v[116:119], v[168:171]
    v_mfma_f32_16x16x32_bf16 v[200:203], v[24:27], v[120:123], v[200:203]
    v_mfma_f32_16x16x32_bf16 v[232:235], v[24:27], v[124:127], v[232:235]
    v_mfma_f32_16x16x32_bf16 v[140:143], v[28:31], v[112:115], v[140:143]
    v_mfma_f32_16x16x32_bf16 v[172:175], v[28:31], v[116:119], v[172:175]
    v_mfma_f32_16x16x32_bf16 v[204:207], v[28:31], v[120:123], v[204:207]
    v_mfma_f32_16x16x32_bf16 v[236:239], v[28:31], v[124:127], v[236:239]
    v_mfma_f32_16x16x32_bf16 v[144:147], v[32:35], v[112:115], v[144:147]
    v_mfma_f32_16x16x32_bf16 v[176:179], v[32:35], v[116:119], v[176:179]
    v_mfma_f32_16x16x32_bf16 v[208:211], v[32:35], v[120:123], v[208:211]
    v_mfma_f32_16x16x32_bf16 v[240:243], v[32:35], v[124:127], v[240:243]
    v_mfma_f32_16x16x32_bf16 v[148:151], v[36:39], v[112:115], v[148:151]
    v_mfma_f32_16x16x32_bf16 v[180:183], v[36:39], v[116:119], v[180:183]
    v_mfma_f32_16x16x32_bf16 v[212:215], v[36:39], v[120:123], v[212:215]
    v_mfma_f32_16x16x32_bf16 v[244:247], v[36:39], v[124:127], v[244:247]
    v_mfma_f32_16x16x32_bf16 v[152:155], v[40:43], v[112:115], v[152:155]
    v_mfma_f32_16x16x32_bf16 v[184:187], v[40:43], v[116:119], v[184:187]
    v_mfma_f32_16x16x32_bf16 v[216:219], v[40:43], v[120:123], v[216:219]
    v_mfma_f32_16x16x32_bf16 v[248:251], v[40:43], v[124:127], v[248:251]
    v_mfma_f32_16x16x32_bf16 v[156:159], v[44:47], v[112:115], v[156:159]
    v_mfma_f32_16x16x32_bf16 v[188:191], v[44:47], v[116:119], v[188:191]
    v_mfma_f32_16x16x32_bf16 v[220:223], v[44:47], v[120:123], v[220:223]
    v_mfma_f32_16x16x32_bf16 v[252:255], v[44:47], v[124:127], v[252:255]
    buffer_load_dword v80, v10, s[32:35], s44 offen
    buffer_load_dword v81, v10, s[32:35], s44 offen offset:2688
    buffer_load_dword v82, v11, s[32:35], s44 offen
    buffer_load_dword v83, v11, s[32:35], s44 offen offset:2688
    buffer_load_dword v84, v12, s[32:35], s44 offen
    buffer_load_dword v85, v12, s[32:35], s44 offen offset:2688
    buffer_load_dword v86, v13, s[32:35], s44 offen
    buffer_load_dword v87, v13, s[32:35], s44 offen offset:2688
    buffer_load_dword v88, v10, s[32:35], s44 offen offset:896
    buffer_load_dword v89, v10, s[32:35], s44 offen offset:3584
    buffer_load_dword v90, v11, s[32:35], s44 offen offset:896
    buffer_load_dword v91, v11, s[32:35], s44 offen offset:3584
    buffer_load_dword v92, v12, s[32:35], s44 offen offset:896
    buffer_load_dword v93, v12, s[32:35], s44 offen offset:3584
    buffer_load_dword v94, v13, s[32:35], s44 offen offset:896
    buffer_load_dword v95, v13, s[32:35], s44 offen offset:3584
    s_add_u32 s44, s44, 86016
    s_waitcnt vmcnt(16)
    v_perm_b32 v112, v97, v96, s60
    v_perm_b32 v113, v99, v98, s60
    v_perm_b32 v114, v101, v100, s60
    v_perm_b32 v115, v103, v102, s60
    v_perm_b32 v116, v97, v96, s61
    v_perm_b32 v117, v99, v98, s61
    v_perm_b32 v118, v101, v100, s61
    v_perm_b32 v119, v103, v102, s61
    v_perm_b32 v120, v105, v104, s60
    v_perm_b32 v121, v107, v106, s60
    v_perm_b32 v122, v109, v108, s60
    v_perm_b32 v123, v111, v110, s60
    v_perm_b32 v124, v105, v104, s61
    v_perm_b32 v125, v107, v106, s61
    v_perm_b32 v126, v109, v108, s61
    v_perm_b32 v127, v111, v110, s61
    s_waitcnt lgkmcnt(0)
    ds_read_b128 v[16:19], v14
    ds_read_b128 v[20:23], v14 offset:1024
    ds_read_b128 v[24:27], v14 offset:2048
    ds_read_b128 v[28:31], v14 offset:3072
    ds_read_b128 v[32:35], v14 offset:4096
    ds_read_b128 v[36:39], v14 offset:5120
    ds_read_b128 v[40:43], v14 offset:6144
    ds_read_b128 v[44:47], v14 offset:7168
    v_add_u32 v14, 0x2000, v14
    v_mfma_f32_16x16x32_bf16 v[128:131], v[48:51], v[112:115], v[128:131]
    v_mfma_f32_16x16x32_bf16 v[160:163], v[48:51], v[116:119], v[160:163]
    v_mfma_f32_16x16x32_bf16 v[192:195], v[48:51], v[120:123], v[192:195]
    v_mfma_f32_16x16x32_bf16 v[224:227], v[48:51], v[124:127], v[224:227]
    v_mfma_f32_16x16x32_bf16 v[132:135], v[52:55], v[112:115], v[132:135]
    v_mfma_f32_16x16x32_bf16 v[164:167], v[52:55], v[116:119], v[164:167]
    v_mfma_f32_16x16x32_bf16 v[196:199], v[52:55], v[120:123], v[196:199]
    v_mfma_f32_16x16x32_bf16 v[228:231], v[52:55], v[124:127], v[228:231]
    v_mfma_f32_16x16x32_bf16 v[136:139], v[56:59], v[112:115], v[136:139]
    v_mfma_f32_16x16x32_bf16 v[168:171], v[56:59], v[116:119], v[168:171]
    v_mfma_f32_16x16x32_bf16 v[200:203], v[56:59], v[120:123], v[200:203]
    v_mfma_f32_16x16x32_bf16 v[232:235], v[56:59], v[124:127], v[232:235]
    v_mfma_f32_16x16x32_bf16 v[140:143], v[60:63], v[112:115], v[140:143]
    v_mfma_f32_16x16x32_bf16 v[172:175], v[60:63], v[116:119], v[172:175]
    v_mfma_f32_16x16x32_bf16 v[204:207], v[60:63], v[120:123], v[204:207]
    v_mfma_f32_16x16x32_bf16 v[236:239], v[60:63], v[124:127], v[236:239]
    v_mfma_f32_16x16x32_bf16 v[144:147], v[64:67], v[112:115], v[144:147]
    v_mfma_f32_16x16x32_bf16 v[176:179], v[64:67], v[116:119], v[176:179]
    v_mfma_f32_16x16x32_bf16 v[208:211], v[64:67], v[120:123], v[208:211]
    v_mfma_f32_16x16x32_bf16 v[240:243], v[64:67], v[124:127], v[240:243]
    v_mfma_f32_16x16x32_bf16 v[148:151], v[68:71], v[112:115], v[148:151]
    v_mfma_f32_16x16x32_bf16 v[180:183], v[68:71], v[116:119], v[180:183]
    v_mfma_f32_16x16x32_bf16 v[212:215], v[68:71], v[120:123], v[212:215]
    v_mfma_f32_16x16x32_bf16 v[244:247], v[68:71], v[124:127], v[244:247]
    v_mfma_f32_16x16x32_bf16 v[152:155], v[72:75], v[112:115], v[152:155]
    v_mfma_f32_16x16x32_bf16 v[184:187], v[72:75], v[116:119], v[184:187]
    v_mfma_f32_16x16x32_bf16 v[216:219], v[72:75], v[120:123], v[216:219]
    v_mfma_f32_16x16x32_bf16 v[248:251], v[72:75], v[124:127], v[248:251]
    v_mfma_f32_16x16x32_bf16 v[156:159], v[76:79], v[112:115], v[156:159]
    v_mfma_f32_16x16x32_bf16 v[188:191], v[76:79], v[116:119], v[188:191]
    v_mfma_f32_16x16x32_bf16 v[220:223], v[76:79], v[120:123], v[220:223]
    v_mfma_f32_16x16x32_bf16 v[252:255], v[76:79], v[124:127], v[252:255]
    s_sub_u32 s45, s45, 1
    s_cmp_lg_u32 s45, 0
    s_cbranch_scc1 .bg_103
    s_waitcnt vmcnt(0) lgkmcnt(0)
    s_nop 7
    v_mul_f32 v16, s62, v128
    v_mul_f32 v17, s62, v129
    v_mul_f32 v18, s62, v130
    v_mul_f32 v19, s62, v131
    v_mul_f32 v20, s62, v132
    v_mul_f32 v21, s62, v133
    v_mul_f32 v22, s62, v134
    v_mul_f32 v23, s62, v135
    v_mul_f32 v24, s62, v136
    v_mul_f32 v25, s62, v137
    v_mul_f32 v26, s62, v138
    v_mul_f32 v27, s62, v139
    v_mul_f32 v28, s62, v140
    v_mul_f32 v29, s62, v141
    v_mul_f32 v30, s62, v142
    v_mul_f32 v31, s62, v143
    v_mul_f32 v32, s62, v144
    v_mul_f32 v33, s62, v145
    v_mul_f32 v34, s62, v146
    v_mul_f32 v35, s62, v147
    v_mul_f32 v36, s62, v148
    v_mul_f32 v37, s62, v149
    v_mul_f32 v38, s62, v150
    v_mul_f32 v39, s62, v151
    v_mul_f32 v40, s62, v152
    v_mul_f32 v41, s62, v153
    v_mul_f32 v42, s62, v154
    v_mul_f32 v43, s62, v155
    v_mul_f32 v44, s62, v156
    v_mul_f32 v45, s62, v157
    v_mul_f32 v46, s62, v158
    v_mul_f32 v47, s62, v159
    v_mul_f32 v48, s62, v160
    v_mul_f32 v49, s62, v161
    v_mul_f32 v50, s62, v162
    v_mul_f32 v51, s62, v163
    v_mul_f32 v52, s62, v164
    v_mul_f32 v53, s62, v165
    v_mul_f32 v54, s62, v166
    v_mul_f32 v55, s62, v167
    v_mul_f32 v56, s62, v168
    v_mul_f32 v57, s62, v169
    v_mul_f32 v58, s62, v170
    v_mul_f32 v59, s62, v171
    v_mul_f32 v60, s62, v172
    v_mul_f32 v61, s62, v173
    v_mul_f32 v62, s62, v174
    v_mul_f32 v63, s62, v175
    v_mul_f32 v64, s62, v176
    v_mul_f32 v65, s62, v177
    v_mul_f32 v66, s62, v178
    v_mul_f32 v67, s62, v179
    v_mul_f32 v68, s62, v180
    v_mul_f32 v69, s62, v181
    v_mul_f32 v70, s62, v182
    v_mul_f32 v71, s62, v183
    v_mul_f32 v72, s62, v184
    v_mul_f32 v73, s62, v185
    v_mul_f32 v74, s62, v186
    v_mul_f32 v75, s62, v187
    v_mul_f32 v76, s62, v188
    v_mul_f32 v77, s62, v189
    v_mul_f32 v78, s62, v190
    v_mul_f32 v79, s62, v191
    v_min_f32 v16, 0, v16
    v_min_f32 v17, 0, v17
    v_min_f32 v18, 0, v18
    v_min_f32 v19, 0, v19
    v_min_f32 v20, 0, v20
    v_min_f32 v21, 0, v21
    v_min_f32 v22, 0, v22
    v_min_f32 v23, 0, v23
    v_min_f32 v24, 0, v24
    v_min_f32 v25, 0, v25
    v_min_f32 v26, 0, v26
    v_min_f32 v27, 0, v27
    v_min_f32 v28, 0, v28
    v_min_f32 v29, 0, v29
    v_min_f32 v30, 0, v30
    v_min_f32 v31, 0, v31
    v_min_f32 v32, 0, v32
    v_min_f32 v33, 0, v33
    v_min_f32 v34, 0, v34
    v_min_f32 v35, 0, v35
    v_min_f32 v36, 0, v36
    v_min_f32 v37, 0, v37
    v_min_f32 v38, 0, v38
    v_min_f32 v39, 0, v39
    v_min_f32 v40, 0, v40
    v_min_f32 v41, 0, v41
    v_min_f32 v42, 0, v42
    v_min_f32 v43, 0, v43
    v_min_f32 v44, 0, v44
    v_min_f32 v45, 0, v45
    v_min_f32 v46, 0, v46
    v_min_f32 v47, 0, v47
    v_min_f32 v48, 0, v48
    v_min_f32 v49, 0, v49
    v_min_f32 v50, 0, v50
    v_min_f32 v51, 0, v51
    v_min_f32 v52, 0, v52
    v_min_f32 v53, 0, v53
    v_min_f32 v54, 0, v54
    v_min_f32 v55, 0, v55
    v_min_f32 v56, 0, v56
    v_min_f32 v57, 0, v57
    v_min_f32 v58, 0, v58
    v_min_f32 v59, 0, v59
    v_min_f32 v60, 0, v60
    v_min_f32 v61, 0, v61
    v_min_f32 v62, 0, v62
    v_min_f32 v63, 0, v63
    v_min_f32 v64, 0, v64
    v_min_f32 v65, 0, v65
    v_min_f32 v66, 0, v66
    v_min_f32 v67, 0, v67
    v_min_f32 v68, 0, v68
    v_min_f32 v69, 0, v69
    v_min_f32 v70, 0, v70
    v_min_f32 v71, 0, v71
    v_min_f32 v72, 0, v72
    v_min_f32 v73, 0, v73
    v_min_f32 v74, 0, v74
    v_min_f32 v75, 0, v75
    v_min_f32 v76, 0, v76
    v_min_f32 v77, 0, v77
    v_min_f32 v78, 0, v78
    v_min_f32 v79, 0, v79
    v_exp_f32 v16, v16
    v_exp_f32 v17, v17
    v_exp_f32 v18, v18
    v_exp_f32 v19, v19
    v_exp_f32 v20, v20
    v_exp_f32 v21, v21
    v_exp_f32 v22, v22
    v_exp_f32 v23, v23
    v_exp_f32 v24, v24
    v_exp_f32 v25, v25
    v_exp_f32 v26, v26
    v_exp_f32 v27, v27
    v_exp_f32 v28, v28
    v_exp_f32 v29, v29
    v_exp_f32 v30, v30
    v_exp_f32 v31, v31
    v_exp_f32 v32, v32
    v_exp_f32 v33, v33
    v_exp_f32 v34, v34
    v_exp_f32 v35, v35
    v_exp_f32 v36, v36
    v_exp_f32 v37, v37
    v_exp_f32 v38, v38
    v_exp_f32 v39, v39
    v_exp_f32 v40, v40
    v_exp_f32 v41, v41
    v_exp_f32 v42, v42
    v_exp_f32 v43, v43
    v_exp_f32 v44, v44
    v_exp_f32 v45, v45
    v_exp_f32 v46, v46
    v_exp_f32 v47, v47
    v_exp_f32 v48, v48
    v_exp_f32 v49, v49
    v_exp_f32 v50, v50
    v_exp_f32 v51, v51
    v_exp_f32 v52, v52
    v_exp_f32 v53, v53
    v_exp_f32 v54, v54
    v_exp_f32 v55, v55
    v_exp_f32 v56, v56
    v_exp_f32 v57, v57
    v_exp_f32 v58, v58
    v_exp_f32 v59, v59
    v_exp_f32 v60, v60
    v_exp_f32 v61, v61
    v_exp_f32 v62, v62
    v_exp_f32 v63, v63
    v_exp_f32 v64, v64
    v_exp_f32 v65, v65
    v_exp_f32 v66, v66
    v_exp_f32 v67, v67
    v_exp_f32 v68, v68
    v_exp_f32 v69, v69
    v_exp_f32 v70, v70
    v_exp_f32 v71, v71
    v_exp_f32 v72, v72
    v_exp_f32 v73, v73
    v_exp_f32 v74, v74
    v_exp_f32 v75, v75
    v_exp_f32 v76, v76
    v_exp_f32 v77, v77
    v_exp_f32 v78, v78
    v_exp_f32 v79, v79
    v_max_f32 v128, 0, v128
    v_max_f32 v129, 0, v129
    v_max_f32 v130, 0, v130
    v_max_f32 v131, 0, v131
    v_max_f32 v132, 0, v132
    v_max_f32 v133, 0, v133
    v_max_f32 v134, 0, v134
    v_max_f32 v135, 0, v135
    v_max_f32 v136, 0, v136
    v_max_f32 v137, 0, v137
    v_max_f32 v138, 0, v138
    v_max_f32 v139, 0, v139
    v_max_f32 v140, 0, v140
    v_max_f32 v141, 0, v141
    v_max_f32 v142, 0, v142
    v_max_f32 v143, 0, v143
    v_max_f32 v144, 0, v144
    v_max_f32 v145, 0, v145
    v_max_f32 v146, 0, v146
    v_max_f32 v147, 0, v147
    v_max_f32 v148, 0, v148
    v_max_f32 v149, 0, v149
    v_max_f32 v150, 0, v150
    v_max_f32 v151, 0, v151
    v_max_f32 v152, 0, v152
    v_max_f32 v153, 0, v153
    v_max_f32 v154, 0, v154
    v_max_f32 v155, 0, v155
    v_max_f32 v156, 0, v156
    v_max_f32 v157, 0, v157
    v_max_f32 v158, 0, v158
    v_max_f32 v159, 0, v159
    v_max_f32 v160, 0, v160
    v_max_f32 v161, 0, v161
    v_max_f32 v162, 0, v162
    v_max_f32 v163, 0, v163
    v_max_f32 v164, 0, v164
    v_max_f32 v165, 0, v165
    v_max_f32 v166, 0, v166
    v_max_f32 v167, 0, v167
    v_max_f32 v168, 0, v168
    v_max_f32 v169, 0, v169
    v_max_f32 v170, 0, v170
    v_max_f32 v171, 0, v171
    v_max_f32 v172, 0, v172
    v_max_f32 v173, 0, v173
    v_max_f32 v174, 0, v174
    v_max_f32 v175, 0, v175
    v_max_f32 v176, 0, v176
    v_max_f32 v177, 0, v177
    v_max_f32 v178, 0, v178
    v_max_f32 v179, 0, v179
    v_max_f32 v180, 0, v180
    v_max_f32 v181, 0, v181
    v_max_f32 v182, 0, v182
    v_max_f32 v183, 0, v183
    v_max_f32 v184, 0, v184
    v_max_f32 v185, 0, v185
    v_max_f32 v186, 0, v186
    v_max_f32 v187, 0, v187
    v_max_f32 v188, 0, v188
    v_max_f32 v189, 0, v189
    v_max_f32 v190, 0, v190
    v_max_f32 v191, 0, v191
    v_add_f32 v128, v128, v16
    v_add_f32 v129, v129, v17
    v_add_f32 v130, v130, v18
    v_add_f32 v131, v131, v19
    v_add_f32 v132, v132, v20
    v_add_f32 v133, v133, v21
    v_add_f32 v134, v134, v22
    v_add_f32 v135, v135, v23
    v_add_f32 v136, v136, v24
    v_add_f32 v137, v137, v25
    v_add_f32 v138, v138, v26
    v_add_f32 v139, v139, v27
    v_add_f32 v140, v140, v28
    v_add_f32 v141, v141, v29
    v_add_f32 v142, v142, v30
    v_add_f32 v143, v143, v31
    v_add_f32 v144, v144, v32
    v_add_f32 v145, v145, v33
    v_add_f32 v146, v146, v34
    v_add_f32 v147, v147, v35
    v_add_f32 v148, v148, v36
    v_add_f32 v149, v149, v37
    v_add_f32 v150, v150, v38
    v_add_f32 v151, v151, v39
    v_add_f32 v152, v152, v40
    v_add_f32 v153, v153, v41
    v_add_f32 v154, v154, v42
    v_add_f32 v155, v155, v43
    v_add_f32 v156, v156, v44
    v_add_f32 v157, v157, v45
    v_add_f32 v158, v158, v46
    v_add_f32 v159, v159, v47
    v_add_f32 v160, v160, v48
    v_add_f32 v161, v161, v49
    v_add_f32 v162, v162, v50
    v_add_f32 v163, v163, v51
    v_add_f32 v164, v164, v52
    v_add_f32 v165, v165, v53
    v_add_f32 v166, v166, v54
    v_add_f32 v167, v167, v55
    v_add_f32 v168, v168, v56
    v_add_f32 v169, v169, v57
    v_add_f32 v170, v170, v58
    v_add_f32 v171, v171, v59
    v_add_f32 v172, v172, v60
    v_add_f32 v173, v173, v61
    v_add_f32 v174, v174, v62
    v_add_f32 v175, v175, v63
    v_add_f32 v176, v176, v64
    v_add_f32 v177, v177, v65
    v_add_f32 v178, v178, v66
    v_add_f32 v179, v179, v67
    v_add_f32 v180, v180, v68
    v_add_f32 v181, v181, v69
    v_add_f32 v182, v182, v70
    v_add_f32 v183, v183, v71
    v_add_f32 v184, v184, v72
    v_add_f32 v185, v185, v73
    v_add_f32 v186, v186, v74
    v_add_f32 v187, v187, v75
    v_add_f32 v188, v188, v76
    v_add_f32 v189, v189, v77
    v_add_f32 v190, v190, v78
    v_add_f32 v191, v191, v79
    v_fma_f32 v128, v128, v15, v3
    v_fma_f32 v129, v129, v15, v3
    v_fma_f32 v130, v130, v15, v3
    v_fma_f32 v131, v131, v15, v3
    v_fma_f32 v132, v132, v15, v3
    v_fma_f32 v133, v133, v15, v3
    v_fma_f32 v134, v134, v15, v3
    v_fma_f32 v135, v135, v15, v3
    v_fma_f32 v136, v136, v15, v3
    v_fma_f32 v137, v137, v15, v3
    v_fma_f32 v138, v138, v15, v3
    v_fma_f32 v139, v139, v15, v3
    v_fma_f32 v140, v140, v15, v3
    v_fma_f32 v141, v141, v15, v3
    v_fma_f32 v142, v142, v15, v3
    v_fma_f32 v143, v143, v15, v3
    v_fma_f32 v144, v144, v15, v3
    v_fma_f32 v145, v145, v15, v3
    v_fma_f32 v146, v146, v15, v3
    v_fma_f32 v147, v147, v15, v3
    v_fma_f32 v148, v148, v15, v3
    v_fma_f32 v149, v149, v15, v3
    v_fma_f32 v150, v150, v15, v3
    v_fma_f32 v151, v151, v15, v3
    v_fma_f32 v152, v152, v15, v3
    v_fma_f32 v153, v153, v15, v3
    v_fma_f32 v154, v154, v15, v3
    v_fma_f32 v155, v155, v15, v3
    v_fma_f32 v156, v156, v15, v3
    v_fma_f32 v157, v157, v15, v3
    v_fma_f32 v158, v158, v15, v3
    v_fma_f32 v159, v159, v15, v3
    v_fma_f32 v160, v160, v15, v3
    v_fma_f32 v161, v161, v15, v3
    v_fma_f32 v162, v162, v15, v3
    v_fma_f32 v163, v163, v15, v3
    v_fma_f32 v164, v164, v15, v3
    v_fma_f32 v165, v165, v15, v3
    v_fma_f32 v166, v166, v15, v3
    v_fma_f32 v167, v167, v15, v3
    v_fma_f32 v168, v168, v15, v3
    v_fma_f32 v169, v169, v15, v3
    v_fma_f32 v170, v170, v15, v3
    v_fma_f32 v171, v171, v15, v3
    v_fma_f32 v172, v172, v15, v3
    v_fma_f32 v173, v173, v15, v3
    v_fma_f32 v174, v174, v15, v3
    v_fma_f32 v175, v175, v15, v3
    v_fma_f32 v176, v176, v15, v3
    v_fma_f32 v177, v177, v15, v3
    v_fma_f32 v178, v178, v15, v3
    v_fma_f32 v179, v179, v15, v3
    v_fma_f32 v180, v180, v15, v3
    v_fma_f32 v181, v181, v15, v3
    v_fma_f32 v182, v182, v15, v3
    v_fma_f32 v183, v183, v15, v3
    v_fma_f32 v184, v184, v15, v3
    v_fma_f32 v185, v185, v15, v3
    v_fma_f32 v186, v186, v15, v3
    v_fma_f32 v187, v187, v15, v3
    v_fma_f32 v188, v188, v15, v3
    v_fma_f32 v189, v189, v15, v3
    v_fma_f32 v190, v190, v15, v3
    v_fma_f32 v191, v191, v15, v3
    v_cvt_pk_bf16_f32 v128, v128, v129
    v_cvt_pk_bf16_f32 v129, v130, v131
    v_cvt_pk_bf16_f32 v130, v132, v133
    v_cvt_pk_bf16_f32 v131, v134, v135
    v_cvt_pk_bf16_f32 v136, v136, v137
    v_cvt_pk_bf16_f32 v137, v138, v139
    v_cvt_pk_bf16_f32 v138, v140, v141
    v_cvt_pk_bf16_f32 v139, v142, v143
    v_cvt_pk_bf16_f32 v144, v144, v145
    v_cvt_pk_bf16_f32 v145, v146, v147
    v_cvt_pk_bf16_f32 v146, v148, v149
    v_cvt_pk_bf16_f32 v147, v150, v151
    v_cvt_pk_bf16_f32 v152, v152, v153
    v_cvt_pk_bf16_f32 v153, v154, v155
    v_cvt_pk_bf16_f32 v154, v156, v157
    v_cvt_pk_bf16_f32 v155, v158, v159
    v_cvt_pk_bf16_f32 v160, v160, v161
    v_cvt_pk_bf16_f32 v161, v162, v163
    v_cvt_pk_bf16_f32 v162, v164, v165
    v_cvt_pk_bf16_f32 v163, v166, v167
    v_cvt_pk_bf16_f32 v168, v168, v169
    v_cvt_pk_bf16_f32 v169, v170, v171
    v_cvt_pk_bf16_f32 v170, v172, v173
    v_cvt_pk_bf16_f32 v171, v174, v175
    v_cvt_pk_bf16_f32 v176, v176, v177
    v_cvt_pk_bf16_f32 v177, v178, v179
    v_cvt_pk_bf16_f32 v178, v180, v181
    v_cvt_pk_bf16_f32 v179, v182, v183
    v_cvt_pk_bf16_f32 v184, v184, v185
    v_cvt_pk_bf16_f32 v185, v186, v187
    v_cvt_pk_bf16_f32 v186, v188, v189
    v_cvt_pk_bf16_f32 v187, v190, v191
    v_cvt_pk_bf16_f32 v192, v192, v193
    v_or_b32 v192, v192, v4
    v_cvt_pk_bf16_f32 v193, v194, v195
    v_or_b32 v193, v193, v4
    v_cvt_pk_bf16_f32 v194, v196, v197
    v_or_b32 v194, v194, v4
    v_cvt_pk_bf16_f32 v195, v198, v199
    v_or_b32 v195, v195, v4
    v_cvt_pk_bf16_f32 v200, v200, v201
    v_or_b32 v200, v200, v4
    v_cvt_pk_bf16_f32 v201, v202, v203
    v_or_b32 v201, v201, v4
    v_cvt_pk_bf16_f32 v202, v204, v205
    v_or_b32 v202, v202, v4
    v_cvt_pk_bf16_f32 v203, v206, v207
    v_or_b32 v203, v203, v4
    v_cvt_pk_bf16_f32 v208, v208, v209
    v_or_b32 v208, v208, v4
    v_cvt_pk_bf16_f32 v209, v210, v211
    v_or_b32 v209, v209, v4
    v_cvt_pk_bf16_f32 v210, v212, v213
    v_or_b32 v210, v210, v4
    v_cvt_pk_bf16_f32 v211, v214, v215
    v_or_b32 v211, v211, v4
    v_cvt_pk_bf16_f32 v216, v216, v217
    v_or_b32 v216, v216, v4
    v_cvt_pk_bf16_f32 v217, v218, v219
    v_or_b32 v217, v217, v4
    v_cvt_pk_bf16_f32 v218, v220, v221
    v_or_b32 v218, v218, v4
    v_cvt_pk_bf16_f32 v219, v222, v223
    v_or_b32 v219, v219, v4
    v_cvt_pk_bf16_f32 v224, v224, v225
    v_cvt_pk_bf16_f32 v225, v226, v227
    v_cvt_pk_bf16_f32 v226, v228, v229
    v_cvt_pk_bf16_f32 v227, v230, v231
    v_cvt_pk_bf16_f32 v232, v232, v233
    v_cvt_pk_bf16_f32 v233, v234, v235
    v_cvt_pk_bf16_f32 v234, v236, v237
    v_cvt_pk_bf16_f32 v235, v238, v239
    v_cvt_pk_bf16_f32 v240, v240, v241
    v_cvt_pk_bf16_f32 v241, v242, v243
    v_cvt_pk_bf16_f32 v242, v244, v245
    v_cvt_pk_bf16_f32 v243, v246, v247
    v_cvt_pk_bf16_f32 v248, v248, v249
    v_cvt_pk_bf16_f32 v249, v250, v251
    v_cvt_pk_bf16_f32 v250, v252, v253
    v_cvt_pk_bf16_f32 v251, v254, v255
    s_nop 1
    v_mfma_f32_16x16x32_bf16 v[16:19], v[128:131], v[192:195], 0
    v_mfma_f32_16x16x32_bf16 v[20:23], v[128:131], v[224:227], 0
    v_mfma_f32_16x16x32_bf16 v[24:27], v[160:163], v[192:195], 0
    v_mfma_f32_16x16x32_bf16 v[28:31], v[160:163], v[224:227], 0
    v_mfma_f32_16x16x32_bf16 v[16:19], v[136:139], v[200:203], v[16:19]
    v_mfma_f32_16x16x32_bf16 v[20:23], v[136:139], v[232:235], v[20:23]
    v_mfma_f32_16x16x32_bf16 v[24:27], v[168:171], v[200:203], v[24:27]
    v_mfma_f32_16x16x32_bf16 v[28:31], v[168:171], v[232:235], v[28:31]
    v_mfma_f32_16x16x32_bf16 v[16:19], v[144:147], v[208:211], v[16:19]
    v_mfma_f32_16x16x32_bf16 v[20:23], v[144:147], v[240:243], v[20:23]
    v_mfma_f32_16x16x32_bf16 v[24:27], v[176:179], v[208:211], v[24:27]
    v_mfma_f32_16x16x32_bf16 v[28:31], v[176:179], v[240:243], v[28:31]
    v_mfma_f32_16x16x32_bf16 v[16:19], v[152:155], v[216:219], v[16:19]
    v_mfma_f32_16x16x32_bf16 v[20:23], v[152:155], v[248:251], v[20:23]
    v_mfma_f32_16x16x32_bf16 v[24:27], v[184:187], v[216:219], v[24:27]
    v_mfma_f32_16x16x32_bf16 v[28:31], v[184:187], v[248:251], v[28:31]
    s_lshl_b32 s22, s31, 12
    s_add_u32 s22, s22, 0x4810000
.wd_104:
    buffer_load_dword v1, off, s[92:95], 0 offset:132 sc1
    s_sub_u32 s19, s19, 1
    s_cbranch_scc1 .abort
    s_waitcnt vmcnt(0)
    v_readfirstlane_b32 s101, v1
    s_and_b32 s100, s101, 0x20
    s_cmp_eq_u32 s100, 0x20
    s_cbranch_scc1 .wdg_105
    s_sleep 2
    s_branch .wd_104
.wdg_105:
    s_nop 7
    buffer_atomic_add_f32 v16, v8, s[4:7], s22 offen
    buffer_atomic_add_f32 v17, v8, s[4:7], s22 offen offset:256
    buffer_atomic_add_f32 v18, v8, s[4:7], s22 offen offset:512
    buffer_atomic_add_f32 v19, v8, s[4:7], s22 offen offset:768
    buffer_atomic_add_f32 v20, v8, s[4:7], s22 offen offset:1024
    buffer_atomic_add_f32 v21, v8, s[4:7], s22 offen offset:1280
    buffer_atomic_add_f32 v22, v8, s[4:7], s22 offen offset:1536
    buffer_atomic_add_f32 v23, v8, s[4:7], s22 offen offset:1792
    buffer_atomic_add_f32 v24, v8, s[4:7], s22 offen offset:2048
    buffer_atomic_add_f32 v25, v8, s[4:7], s22 offen offset:2304
    buffer_atomic_add_f32 v26, v8, s[4:7], s22 offen offset:2560
    buffer_atomic_add_f32 v27, v8, s[4:7], s22 offen offset:2816
    buffer_atomic_add_f32 v28, v8, s[4:7], s22 offen offset:3072
    buffer_atomic_add_f32 v29, v8, s[4:7], s22 offen offset:3328
    buffer_atomic_add_f32 v30, v8, s[4:7], s22 offen offset:3584
    buffer_atomic_add_f32 v31, v8, s[4:7], s22 offen offset:3840
    s_add_u32 s31, s31, 1
    s_add_u32 s29, s29, 1
    s_cmp_lt_u32 s29, 2
    s_waitcnt vmcnt(0)
    s_cbranch_scc1 .b_p1_102
    s_mov_b32 s26, 0x4800580
    s_waitcnt vmcnt(0)
    s_barrier
    s_cmp_lg_u32 s8, 0
    s_cbranch_scc1 .sig_106
    s_mov_b64 exec, 1
    v_mov_b32 v1, 0
    v_mov_b32 v2, 1
    buffer_atomic_add v2, v1, s[4:7], s26 offen
    s_mov_b64 exec, -1
.sig_106:
    s_endpgm
.b_p2:
    s_mul_i32 s44, s8, 224
    s_add_u32 s44, s44, 0
    buffer_load_dword v80, v10, s[32:35], s44 offen
    buffer_load_dword v81, v10, s[32:35], s44 offen offset:2688
    buffer_load_dword v82, v11, s[32:35], s44 offen
    buffer_load_dword v83, v11, s[32:35], s44 offen offset:2688
    buffer_load_dword v84, v12, s[32:35], s44 offen
    buffer_load_dword v85, v12, s[32:35], s44 offen offset:2688
    buffer_load_dword v86, v13, s[32:35], s44 offen
    buffer_load_dword v87, v13, s[32:35], s44 offen offset:2688
    buffer_load_dword v88, v10, s[32:35], s44 offen offset:56
    buffer_load_dword v89, v10, s[32:35], s44 offen offset:2744
    buffer_load_dword v90, v11, s[32:35], s44 offen offset:56
    buffer_load_dword v91, v11, s[32:35], s44 offen offset:2744
    buffer_load_dword v92, v12, s[32:35], s44 offen offset:56
    buffer_load_dword v93, v12, s[32:35], s44 offen offset:2744
    buffer_load_dword v94, v13, s[32:35], s44 offen offset:56
    buffer_load_dword v95, v13, s[32:35], s44 offen offset:2744
    s_add_u32 s44, s44, 86016
    v_mov_b32 v14, v9
    ds_read_b128 v[16:19], v14
    ds_read_b128 v[20:23], v14 offset:1024
    ds_read_b128 v[24:27], v14 offset:2048
    ds_read_b128 v[28:31], v14 offset:3072
    ds_read_b128 v[32:35], v14 offset:4096
    ds_read_b128 v[36:39], v14 offset:5120
    ds_read_b128 v[40:43], v14 offset:6144
    ds_read_b128 v[44:47], v14 offset:7168
    v_add_u32 v14, 0x2000, v14
    v_mov_b32 v128, 0
    v_mov_b32 v129, 0
    v_mov_b32 v130, 0
    v_mov_b32 v131, 0
    v_mov_b32 v132, 0
    v_mov_b32 v133, 0
    v_mov_b32 v134, 0
    v_mov_b32 v135, 0
    v_mov_b32 v136, 0
    v_mov_b32 v137, 0
    v_mov_b32 v138, 0
    v_mov_b32 v139, 0
    v_mov_b32 v140, 0
    v_mov_b32 v141, 0
    v_mov_b32 v142, 0
    v_mov_b32 v143, 0
    v_mov_b32 v144, 0
    v_mov_b32 v145, 0
    v_mov_b32 v146, 0
    v_mov_b32 v147, 0
    v_mov_b32 v148, 0
    v_mov_b32 v149, 0
    v_mov_b32 v150, 0
    v_mov_b32 v151, 0
    v_mov_b32 v152, 0
    v_mov_b32 v153, 0
    v_mov_b32 v154, 0
    v_mov_b32 v155, 0
    v_mov_b32 v156, 0
    v_mov_b32 v157, 0
    v_mov_b32 v158, 0
    v_mov_b32 v159, 0
    v_mov_b32 v160, 0
    v_mov_b32 v161, 0
    v_mov_b32 v162, 0
    v_mov_b32 v163, 0
    v_mov_b32 v164, 0
    v_mov_b32 v165, 0
    v_mov_b32 v166, 0
    v_mov_b32 v167, 0
    v_mov_b32 v168, 0
    v_mov_b32 v169, 0
    v_mov_b32 v170, 0
    v_mov_b32 v171, 0
    v_mov_b32 v172, 0
    v_mov_b32 v173, 0
    v_mov_b32 v174, 0
    v_mov_b32 v175, 0
    v_mov_b32 v176, 0
    v_mov_b32 v177, 0
    v_mov_b32 v178, 0
    v_mov_b32 v179, 0
    v_mov_b32 v180, 0
    v_mov_b32 v181, 0
    v_mov_b32 v182, 0
    v_mov_b32 v183, 0
    v_mov_b32 v184, 0
    v_mov_b32 v185, 0
    v_mov_b32 v186, 0
    v_mov_b32 v187, 0
    v_mov_b32 v188, 0
    v_mov_b32 v189, 0
    v_mov_b32 v190, 0
    v_mov_b32 v191, 0
    v_mov_b32 v192, 0
    v_mov_b32 v193, 0
    v_mov_b32 v194, 0
    v_mov_b32 v195, 0
    v_mov_b32 v196, 0
    v_mov_b32 v197, 0
    v_mov_b32 v198, 0
    v_mov_b32 v199, 0
    v_mov_b32 v200, 0
    v_mov_b32 v201, 0
    v_mov_b32 v202, 0
    v_mov_b32 v203, 0
    v_mov_b32 v204, 0
    v_mov_b32 v205, 0
    v_mov_b32 v206, 0
    v_mov_b32 v207, 0
    v_mov_b32 v208, 0
    v_mov_b32 v209, 0
    v_mov_b32 v210, 0
    v_mov_b32 v211, 0
    v_mov_b32 v212, 0
    v_mov_b32 v213, 0
    v_mov_b32 v214, 0
    v_mov_b32 v215, 0
    v_mov_b32 v216, 0
    v_mov_b32 v217, 0
    v_mov_b32 v218, 0
    v_mov_b32 v219, 0
    v_mov_b32 v220, 0
    v_mov_b32 v221, 0
    v_mov_b32 v222, 0
    v_mov_b32 v223, 0
    v_mov_b32 v224, 0
    v_mov_b32 v225, 0
    v_mov_b32 v226, 0
    v_mov_b32 v227, 0
    v_mov_b32 v228, 0
    v_mov_b32 v229, 0
    v_mov_b32 v230, 0
    v_mov_b32 v231, 0
    v_mov_b32 v232, 0
    v_mov_b32 v233, 0
    v_mov_b32 v234, 0
    v_mov_b32 v235, 0
    v_mov_b32 v236, 0
    v_mov_b32 v237, 0
    v_mov_b32 v238, 0
    v_mov_b32 v239, 0
    v_mov_b32 v240, 0
    v_mov_b32 v241, 0
    v_mov_b32 v242, 0
    v_mov_b32 v243, 0
    v_mov_b32 v244, 0
    v_mov_b32 v245, 0
    v_mov_b32 v246, 0
    v_mov_b32 v247, 0
    v_mov_b32 v248, 0
    v_mov_b32 v249, 0
    v_mov_b32 v250, 0
    v_mov_b32 v251, 0
    v_mov_b32 v252, 0
    v_mov_b32 v253, 0
    v_mov_b32 v254, 0
    v_mov_b32 v255, 0
    s_mov_b32 s45, 7
.bg_107:
    buffer_load_dword v96, v10, s[32:35], s44 offen
    buffer_load_dword v97, v10, s[32:35], s44 offen offset:2688
    buffer_load_dword v98, v11, s[32:35], s44 offen
    buffer_load_dword v99, v11, s[32:35], s44 offen offset:2688
    buffer_load_dword v100, v12, s[32:35], s44 offen
    buffer_load_dword v101, v12, s[32:35], s44 offen offset:2688
    buffer_load_dword v102, v13, s[32:35], s44 offen
    buffer_load_dword v103, v13, s[32:35], s44 offen offset:2688
    buffer_load_dword v104, v10, s[32:35], s44 offen offset:56
    buffer_load_dword v105, v10, s[32:35], s44 offen offset:2744
    buffer_load_dword v106, v11, s[32:35], s44 offen offset:56
    buffer_load_dword v107, v11, s[32:35], s44 offen offset:2744
    buffer_load_dword v108, v12, s[32:35], s44 offen offset:56
    buffer_load_dword v109, v12, s[32:35], s44 offen offset:2744
    buffer_load_dword v110, v13, s[32:35], s44 offen offset:56
    buffer_load_dword v111, v13, s[32:35], s44 offen offset:2744
    s_add_u32 s44, s44, 86016
    s_waitcnt vmcnt(16)
    v_perm_b32 v112, v81, v80, s60
    v_perm_b32 v113, v83, v82, s60
    v_perm_b32 v114, v85, v84, s60
    v_perm_b32 v115, v87, v86, s60
    v_perm_b32 v116, v81, v80, s61
    v_perm_b32 v117, v83, v82, s61
    v_perm_b32 v118, v85, v84, s61
    v_perm_b32 v119, v87, v86, s61
    v_perm_b32 v120, v89, v88, s60
    v_perm_b32 v121, v91, v90, s60
    v_perm_b32 v122, v93, v92, s60
    v_perm_b32 v123, v95, v94, s60
    v_perm_b32 v124, v89, v88, s61
    v_perm_b32 v125, v91, v90, s61
    v_perm_b32 v126, v93, v92, s61
    v_perm_b32 v127, v95, v94, s61
    s_waitcnt lgkmcnt(0)
    ds_read_b128 v[48:51], v14
    ds_read_b128 v[52:55], v14 offset:1024
    ds_read_b128 v[56:59], v14 offset:2048
    ds_read_b128 v[60:63], v14 offset:3072
    ds_read_b128 v[64:67], v14 offset:4096
    ds_read_b128 v[68:71], v14 offset:5120
    ds_read_b128 v[72:75], v14 offset:6144
    ds_read_b128 v[76:79], v14 offset:7168
    v_add_u32 v14, 0x2000, v14
    v_mfma_f32_16x16x32_bf16 v[128:131], v[112:115], v[16:19], v[128:131]
    v_mfma_f32_16x16x32_bf16 v[160:163], v[116:119], v[16:19], v[160:163]
    v_mfma_f32_16x16x32_bf16 v[192:195], v[120:123], v[16:19], v[192:195]
    v_mfma_f32_16x16x32_bf16 v[224:227], v[124:127], v[16:19], v[224:227]
    v_mfma_f32_16x16x32_bf16 v[132:135], v[112:115], v[20:23], v[132:135]
    v_mfma_f32_16x16x32_bf16 v[164:167], v[116:119], v[20:23], v[164:167]
    v_mfma_f32_16x16x32_bf16 v[196:199], v[120:123], v[20:23], v[196:199]
    v_mfma_f32_16x16x32_bf16 v[228:231], v[124:127], v[20:23], v[228:231]
    v_mfma_f32_16x16x32_bf16 v[136:139], v[112:115], v[24:27], v[136:139]
    v_mfma_f32_16x16x32_bf16 v[168:171], v[116:119], v[24:27], v[168:171]
    v_mfma_f32_16x16x32_bf16 v[200:203], v[120:123], v[24:27], v[200:203]
    v_mfma_f32_16x16x32_bf16 v[232:235], v[124:127], v[24:27], v[232:235]
    v_mfma_f32_16x16x32_bf16 v[140:143], v[112:115], v[28:31], v[140:143]
    v_mfma_f32_16x16x32_bf16 v[172:175], v[116:119], v[28:31], v[172:175]
    v_mfma_f32_16x16x32_bf16 v[204:207], v[120:123], v[28:31], v[204:207]
    v_mfma_f32_16x16x32_bf16 v[236:239], v[124:127], v[28:31], v[236:239]
    v_mfma_f32_16x16x32_bf16 v[144:147], v[112:115], v[32:35], v[144:147]
    v_mfma_f32_16x16x32_bf16 v[176:179], v[116:119], v[32:35], v[176:179]
    v_mfma_f32_16x16x32_bf16 v[208:211], v[120:123], v[32:35], v[208:211]
    v_mfma_f32_16x16x32_bf16 v[240:243], v[124:127], v[32:35], v[240:243]
    v_mfma_f32_16x16x32_bf16 v[148:151], v[112:115], v[36:39], v[148:151]
    v_mfma_f32_16x16x32_bf16 v[180:183], v[116:119], v[36:39], v[180:183]
    v_mfma_f32_16x16x32_bf16 v[212:215], v[120:123], v[36:39], v[212:215]
    v_mfma_f32_16x16x32_bf16 v[244:247], v[124:127], v[36:39], v[244:247]
    v_mfma_f32_16x16x32_bf16 v[152:155], v[112:115], v[40:43], v[152:155]
    v_mfma_f32_16x16x32_bf16 v[184:187], v[116:119], v[40:43], v[184:187]
    v_mfma_f32_16x16x32_bf16 v[216:219], v[120:123], v[40:43], v[216:219]
    v_mfma_f32_16x16x32_bf16 v[248:251], v[124:127], v[40:43], v[248:251]
    v_mfma_f32_16x16x32_bf16 v[156:159], v[112:115], v[44:47], v[156:159]
    v_mfma_f32_16x16x32_bf16 v[188:191], v[116:119], v[44:47], v[188:191]
    v_mfma_f32_16x16x32_bf16 v[220:223], v[120:123], v[44:47], v[220:223]
    v_mfma_f32_16x16x32_bf16 v[252:255], v[124:127], v[44:47], v[252:255]
    buffer_load_dword v80, v10, s[32:35], s44 offen
    buffer_load_dword v81, v10, s[32:35], s44 offen offset:2688
    buffer_load_dword v82, v11, s[32:35], s44 offen
    buffer_load_dword v83, v11, s[32:35], s44 offen offset:2688
    buffer_load_dword v84, v12, s[32:35], s44 offen
    buffer_load_dword v85, v12, s[32:35], s44 offen offset:2688
    buffer_load_dword v86, v13, s[32:35], s44 offen
    buffer_load_dword v87, v13, s[32:35], s44 offen offset:2688
    buffer_load_dword v88, v10, s[32:35], s44 offen offset:56
    buffer_load_dword v89, v10, s[32:35], s44 offen offset:2744
    buffer_load_dword v90, v11, s[32:35], s44 offen offset:56
    buffer_load_dword v91, v11, s[32:35], s44 offen offset:2744
    buffer_load_dword v92, v12, s[32:35], s44 offen offset:56
    buffer_load_dword v93, v12, s[32:35], s44 offen offset:2744
    buffer_load_dword v94, v13, s[32:35], s44 offen offset:56
    buffer_load_dword v95, v13, s[32:35], s44 offen offset:2744
    s_add_u32 s44, s44, 86016
    s_waitcnt vmcnt(16)
    v_perm_b32 v112, v97, v96, s60
    v_perm_b32 v113, v99, v98, s60
    v_perm_b32 v114, v101, v100, s60
    v_perm_b32 v115, v103, v102, s60
    v_perm_b32 v116, v97, v96, s61
    v_perm_b32 v117, v99, v98, s61
    v_perm_b32 v118, v101, v100, s61
    v_perm_b32 v119, v103, v102, s61
    v_perm_b32 v120, v105, v104, s60
    v_perm_b32 v121, v107, v106, s60
    v_perm_b32 v122, v109, v108, s60
    v_perm_b32 v123, v111, v110, s60
    v_perm_b32 v124, v105, v104, s61
    v_perm_b32 v125, v107, v106, s61
    v_perm_b32 v126, v109, v108, s61
    v_perm_b32 v127, v111, v110, s61
    s_waitcnt lgkmcnt(0)
    ds_read_b128 v[16:19], v14
    ds_read_b128 v[20:23], v14 offset:1024
    ds_read_b128 v[24:27], v14 offset:2048
    ds_read_b128 v[28:31], v14 offset:3072
    ds_read_b128 v[32:35], v14 offset:4096
    ds_read_b128 v[36:39], v14 offset:5120
    ds_read_b128 v[40:43], v14 offset:6144
    ds_read_b128 v[44:47], v14 offset:7168
    v_add_u32 v14, 0x2000, v14
    v_mfma_f32_16x16x32_bf16 v[128:131], v[112:115], v[48:51], v[128:131]
    v_mfma_f32_16x16x32_bf16 v[160:163], v[116:119], v[48:51], v[160:163]
    v_mfma_f32_16x16x32_bf16 v[192:195], v[120:123], v[48:51], v[192:195]
    v_mfma_f32_16x16x32_bf16 v[224:227], v[124:127], v[48:51], v[224:227]
    v_mfma_f32_16x16x32_bf16 v[132:135], v[112:115], v[52:55], v[132:135]
    v_mfma_f32_16x16x32_bf16 v[164:167], v[116:119], v[52:55], v[164:167]
    v_mfma_f32_16x16x32_bf16 v[196:199], v[120:123], v[52:55], v[196:199]
    v_mfma_f32_16x16x32_bf16 v[228:231], v[124:127], v[52:55], v[228:231]
    v_mfma_f32_16x16x32_bf16 v[136:139], v[112:115], v[56:59], v[136:139]
    v_mfma_f32_16x16x32_bf16 v[168:171], v[116:119], v[56:59], v[168:171]
    v_mfma_f32_16x16x32_bf16 v[200:203], v[120:123], v[56:59], v[200:203]
    v_mfma_f32_16x16x32_bf16 v[232:235], v[124:127], v[56:59], v[232:235]
    v_mfma_f32_16x16x32_bf16 v[140:143], v[112:115], v[60:63], v[140:143]
    v_mfma_f32_16x16x32_bf16 v[172:175], v[116:119], v[60:63], v[172:175]
    v_mfma_f32_16x16x32_bf16 v[204:207], v[120:123], v[60:63], v[204:207]
    v_mfma_f32_16x16x32_bf16 v[236:239], v[124:127], v[60:63], v[236:239]
    v_mfma_f32_16x16x32_bf16 v[144:147], v[112:115], v[64:67], v[144:147]
    v_mfma_f32_16x16x32_bf16 v[176:179], v[116:119], v[64:67], v[176:179]
    v_mfma_f32_16x16x32_bf16 v[208:211], v[120:123], v[64:67], v[208:211]
    v_mfma_f32_16x16x32_bf16 v[240:243], v[124:127], v[64:67], v[240:243]
    v_mfma_f32_16x16x32_bf16 v[148:151], v[112:115], v[68:71], v[148:151]
    v_mfma_f32_16x16x32_bf16 v[180:183], v[116:119], v[68:71], v[180:183]
    v_mfma_f32_16x16x32_bf16 v[212:215], v[120:123], v[68:71], v[212:215]
    v_mfma_f32_16x16x32_bf16 v[244:247], v[124:127], v[68:71], v[244:247]
    v_mfma_f32_16x16x32_bf16 v[152:155], v[112:115], v[72:75], v[152:155]
    v_mfma_f32_16x16x32_bf16 v[184:187], v[116:119], v[72:75], v[184:187]
    v_mfma_f32_16x16x32_bf16 v[216:219], v[120:123], v[72:75], v[216:219]
    v_mfma_f32_16x16x32_bf16 v[248:251], v[124:127], v[72:75], v[248:251]
    v_mfma_f32_16x16x32_bf16 v[156:159], v[112:115], v[76:79], v[156:159]
    v_mfma_f32_16x16x32_bf16 v[188:191], v[116:119], v[76:79], v[188:191]
    v_mfma_f32_16x16x32_bf16 v[220:223], v[120:123], v[76:79], v[220:223]
    v_mfma_f32_16x16x32_bf16 v[252:255], v[124:127], v[76:79], v[252:255]
    s_sub_u32 s45, s45, 1
    s_cmp_lg_u32 s45, 0
    s_cbranch_scc1 .bg_107
    s_waitcnt vmcnt(0) lgkmcnt(0)
    s_nop 7
    v_mul_f32 v16, s62, v128
    v_mul_f32 v17, s62, v129
    v_mul_f32 v18, s62, v130
    v_mul_f32 v19, s62, v131
    v_mul_f32 v20, s62, v132
    v_mul_f32 v21, s62, v133
    v_mul_f32 v22, s62, v134
    v_mul_f32 v23, s62, v135
    v_mul_f32 v24, s62, v136
    v_mul_f32 v25, s62, v137
    v_mul_f32 v26, s62, v138
    v_mul_f32 v27, s62, v139
    v_mul_f32 v28, s62, v140
    v_mul_f32 v29, s62, v141
    v_mul_f32 v30, s62, v142
    v_mul_f32 v31, s62, v143
    v_mul_f32 v32, s62, v144
    v_mul_f32 v33, s62, v145
    v_mul_f32 v34, s62, v146
    v_mul_f32 v35, s62, v147
    v_mul_f32 v36, s62, v148
    v_mul_f32 v37, s62, v149
    v_mul_f32 v38, s62, v150
    v_mul_f32 v39, s62, v151
    v_mul_f32 v40, s62, v152
    v_mul_f32 v41, s62, v153
    v_mul_f32 v42, s62, v154
    v_mul_f32 v43, s62, v155
    v_mul_f32 v44, s62, v156
    v_mul_f32 v45, s62, v157
    v_mul_f32 v46, s62, v158
    v_mul_f32 v47, s62, v159
    v_mul_f32 v48, s62, v160
    v_mul_f32 v49, s62, v161
    v_mul_f32 v50, s62, v162
    v_mul_f32 v51, s62, v163
    v_mul_f32 v52, s62, v164
    v_mul_f32 v53, s62, v165
    v_mul_f32 v54, s62, v166
    v_mul_f32 v55, s62, v167
    v_mul_f32 v56, s62, v168
    v_mul_f32 v57, s62, v169
    v_mul_f32 v58, s62, v170
    v_mul_f32 v59, s62, v171
    v_mul_f32 v60, s62, v172
    v_mul_f32 v61, s62, v173
    v_mul_f32 v62, s62, v174
    v_mul_f32 v63, s62, v175
    v_mul_f32 v64, s62, v176
    v_mul_f32 v65, s62, v177
    v_mul_f32 v66, s62, v178
    v_mul_f32 v67, s62, v179
    v_mul_f32 v68, s62, v180
    v_mul_f32 v69, s62, v181
    v_mul_f32 v70, s62, v182
    v_mul_f32 v71, s62, v183
    v_mul_f32 v72, s62, v184
    v_mul_f32 v73, s62, v185
    v_mul_f32 v74, s62, v186
    v_mul_f32 v75, s62, v187
    v_mul_f32 v76, s62, v188
    v_mul_f32 v77, s62, v189
    v_mul_f32 v78, s62, v190
    v_mul_f32 v79, s62, v191
    v_min_f32 v16, 0, v16
    v_min_f32 v17, 0, v17
    v_min_f32 v18, 0, v18
    v_min_f32 v19, 0, v19
    v_min_f32 v20, 0, v20
    v_min_f32 v21, 0, v21
    v_min_f32 v22, 0, v22
    v_min_f32 v23, 0, v23
    v_min_f32 v24, 0, v24
    v_min_f32 v25, 0, v25
    v_min_f32 v26, 0, v26
    v_min_f32 v27, 0, v27
    v_min_f32 v28, 0, v28
    v_min_f32 v29, 0, v29
    v_min_f32 v30, 0, v30
    v_min_f32 v31, 0, v31
    v_min_f32 v32, 0, v32
    v_min_f32 v33, 0, v33
    v_min_f32 v34, 0, v34
    v_min_f32 v35, 0, v35
    v_min_f32 v36, 0, v36
    v_min_f32 v37, 0, v37
    v_min_f32 v38, 0, v38
    v_min_f32 v39, 0, v39
    v_min_f32 v40, 0, v40
    v_min_f32 v41, 0, v41
    v_min_f32 v42, 0, v42
    v_min_f32 v43, 0, v43
    v_min_f32 v44, 0, v44
    v_min_f32 v45, 0, v45
    v_min_f32 v46, 0, v46
    v_min_f32 v47, 0, v47
    v_min_f32 v48, 0, v48
    v_min_f32 v49, 0, v49
    v_min_f32 v50, 0, v50
    v_min_f32 v51, 0, v51
    v_min_f32 v52, 0, v52
    v_min_f32 v53, 0, v53
    v_min_f32 v54, 0, v54
    v_min_f32 v55, 0, v55
    v_min_f32 v56, 0, v56
    v_min_f32 v57, 0, v57
    v_min_f32 v58, 0, v58
    v_min_f32 v59, 0, v59
    v_min_f32 v60, 0, v60
    v_min_f32 v61, 0, v61
    v_min_f32 v62, 0, v62
    v_min_f32 v63, 0, v63
    v_min_f32 v64, 0, v64
    v_min_f32 v65, 0, v65
    v_min_f32 v66, 0, v66
    v_min_f32 v67, 0, v67
    v_min_f32 v68, 0, v68
    v_min_f32 v69, 0, v69
    v_min_f32 v70, 0, v70
    v_min_f32 v71, 0, v71
    v_min_f32 v72, 0, v72
    v_min_f32 v73, 0, v73
    v_min_f32 v74, 0, v74
    v_min_f32 v75, 0, v75
    v_min_f32 v76, 0, v76
    v_min_f32 v77, 0, v77
    v_min_f32 v78, 0, v78
    v_min_f32 v79, 0, v79
    v_exp_f32 v16, v16
    v_exp_f32 v17, v17
    v_exp_f32 v18, v18
    v_exp_f32 v19, v19
    v_exp_f32 v20, v20
    v_exp_f32 v21, v21
    v_exp_f32 v22, v22
    v_exp_f32 v23, v23
    v_exp_f32 v24, v24
    v_exp_f32 v25, v25
    v_exp_f32 v26, v26
    v_exp_f32 v27, v27
    v_exp_f32 v28, v28
    v_exp_f32 v29, v29
    v_exp_f32 v30, v30
    v_exp_f32 v31, v31
    v_exp_f32 v32, v32
    v_exp_f32 v33, v33
    v_exp_f32 v34, v34
    v_exp_f32 v35, v35
    v_exp_f32 v36, v36
    v_exp_f32 v37, v37
    v_exp_f32 v38, v38
    v_exp_f32 v39, v39
    v_exp_f32 v40, v40
    v_exp_f32 v41, v41
    v_exp_f32 v42, v42
    v_exp_f32 v43, v43
    v_exp_f32 v44, v44
    v_exp_f32 v45, v45
    v_exp_f32 v46, v46
    v_exp_f32 v47, v47
    v_exp_f32 v48, v48
    v_exp_f32 v49, v49
    v_exp_f32 v50, v50
    v_exp_f32 v51, v51
    v_exp_f32 v52, v52
    v_exp_f32 v53, v53
    v_exp_f32 v54, v54
    v_exp_f32 v55, v55
    v_exp_f32 v56, v56
    v_exp_f32 v57, v57
    v_exp_f32 v58, v58
    v_exp_f32 v59, v59
    v_exp_f32 v60, v60
    v_exp_f32 v61, v61
    v_exp_f32 v62, v62
    v_exp_f32 v63, v63
    v_exp_f32 v64, v64
    v_exp_f32 v65, v65
    v_exp_f32 v66, v66
    v_exp_f32 v67, v67
    v_exp_f32 v68, v68
    v_exp_f32 v69, v69
    v_exp_f32 v70, v70
    v_exp_f32 v71, v71
    v_exp_f32 v72, v72
    v_exp_f32 v73, v73
    v_exp_f32 v74, v74
    v_exp_f32 v75, v75
    v_exp_f32 v76, v76
    v_exp_f32 v77, v77
    v_exp_f32 v78, v78
    v_exp_f32 v79, v79
    v_max_f32 v128, 0, v128
    v_max_f32 v129, 0, v129
    v_max_f32 v130, 0, v130
    v_max_f32 v131, 0, v131
    v_max_f32 v132, 0, v132
    v_max_f32 v133, 0, v133
    v_max_f32 v134, 0, v134
    v_max_f32 v135, 0, v135
    v_max_f32 v136, 0, v136
    v_max_f32 v137, 0, v137
    v_max_f32 v138, 0, v138
    v_max_f32 v139, 0, v139
    v_max_f32 v140, 0, v140
    v_max_f32 v141, 0, v141
    v_max_f32 v142, 0, v142
    v_max_f32 v143, 0, v143
    v_max_f32 v144, 0, v144
    v_max_f32 v145, 0, v145
    v_max_f32 v146, 0, v146
    v_max_f32 v147, 0, v147
    v_max_f32 v148, 0, v148
    v_max_f32 v149, 0, v149
    v_max_f32 v150, 0, v150
    v_max_f32 v151, 0, v151
    v_max_f32 v152, 0, v152
    v_max_f32 v153, 0, v153
    v_max_f32 v154, 0, v154
    v_max_f32 v155, 0, v155
    v_max_f32 v156, 0, v156
    v_max_f32 v157, 0, v157
    v_max_f32 v158, 0, v158
    v_max_f32 v159, 0, v159
    v_max_f32 v160, 0, v160
    v_max_f32 v161, 0, v161
    v_max_f32 v162, 0, v162
    v_max_f32 v163, 0, v163
    v_max_f32 v164, 0, v164
    v_max_f32 v165, 0, v165
    v_max_f32 v166, 0, v166
    v_max_f32 v167, 0, v167
    v_max_f32 v168, 0, v168
    v_max_f32 v169, 0, v169
    v_max_f32 v170, 0, v170
    v_max_f32 v171, 0, v171
    v_max_f32 v172, 0, v172
    v_max_f32 v173, 0, v173
    v_max_f32 v174, 0, v174
    v_max_f32 v175, 0, v175
    v_max_f32 v176, 0, v176
    v_max_f32 v177, 0, v177
    v_max_f32 v178, 0, v178
    v_max_f32 v179, 0, v179
    v_max_f32 v180, 0, v180
    v_max_f32 v181, 0, v181
    v_max_f32 v182, 0, v182
    v_max_f32 v183, 0, v183
    v_max_f32 v184, 0, v184
    v_max_f32 v185, 0, v185
    v_max_f32 v186, 0, v186
    v_max_f32 v187, 0, v187
    v_max_f32 v188, 0, v188
    v_max_f32 v189, 0, v189
    v_max_f32 v190, 0, v190
    v_max_f32 v191, 0, v191
    v_add_f32 v128, v128, v16
    v_add_f32 v129, v129, v17
    v_add_f32 v130, v130, v18
    v_add_f32 v131, v131, v19
    v_add_f32 v132, v132, v20
    v_add_f32 v133, v133, v21
    v_add_f32 v134, v134, v22
    v_add_f32 v135, v135, v23
    v_add_f32 v136, v136, v24
    v_add_f32 v137, v137, v25
    v_add_f32 v138, v138, v26
    v_add_f32 v139, v139, v27
    v_add_f32 v140, v140, v28
    v_add_f32 v141, v141, v29
    v_add_f32 v142, v142, v30
    v_add_f32 v143, v143, v31
    v_add_f32 v144, v144, v32
    v_add_f32 v145, v145, v33
    v_add_f32 v146, v146, v34
    v_add_f32 v147, v147, v35
    v_add_f32 v148, v148, v36
    v_add_f32 v149, v149, v37
    v_add_f32 v150, v150, v38
    v_add_f32 v151, v151, v39
    v_add_f32 v152, v152, v40
    v_add_f32 v153, v153, v41
    v_add_f32 v154, v154, v42
    v_add_f32 v155, v155, v43
    v_add_f32 v156, v156, v44
    v_add_f32 v157, v157, v45
    v_add_f32 v158, v158, v46
    v_add_f32 v159, v159, v47
    v_add_f32 v160, v160, v48
    v_add_f32 v161, v161, v49
    v_add_f32 v162, v162, v50
    v_add_f32 v163, v163, v51
    v_add_f32 v164, v164, v52
    v_add_f32 v165, v165, v53
    v_add_f32 v166, v166, v54
    v_add_f32 v167, v167, v55
    v_add_f32 v168, v168, v56
    v_add_f32 v169, v169, v57
    v_add_f32 v170, v170, v58
    v_add_f32 v171, v171, v59
    v_add_f32 v172, v172, v60
    v_add_f32 v173, v173, v61
    v_add_f32 v174, v174, v62
    v_add_f32 v175, v175, v63
    v_add_f32 v176, v176, v64
    v_add_f32 v177, v177, v65
    v_add_f32 v178, v178, v66
    v_add_f32 v179, v179, v67
    v_add_f32 v180, v180, v68
    v_add_f32 v181, v181, v69
    v_add_f32 v182, v182, v70
    v_add_f32 v183, v183, v71
    v_add_f32 v184, v184, v72
    v_add_f32 v185, v185, v73
    v_add_f32 v186, v186, v74
    v_add_f32 v187, v187, v75
    v_add_f32 v188, v188, v76
    v_add_f32 v189, v189, v77
    v_add_f32 v190, v190, v78
    v_add_f32 v191, v191, v79
    v_add_f32 v128, s63, v128
    v_add_f32 v129, s63, v129
    v_add_f32 v130, s63, v130
    v_add_f32 v131, s63, v131
    v_add_f32 v132, s63, v132
    v_add_f32 v133, s63, v133
    v_add_f32 v134, s63, v134
    v_add_f32 v135, s63, v135
    v_add_f32 v136, s63, v136
    v_add_f32 v137, s63, v137
    v_add_f32 v138, s63, v138
    v_add_f32 v139, s63, v139
    v_add_f32 v140, s63, v140
    v_add_f32 v141, s63, v141
    v_add_f32 v142, s63, v142
    v_add_f32 v143, s63, v143
    v_add_f32 v144, s63, v144
    v_add_f32 v145, s63, v145
    v_add_f32 v146, s63, v146
    v_add_f32 v147, s63, v147
    v_add_f32 v148, s63, v148
    v_add_f32 v149, s63, v149
    v_add_f32 v150, s63, v150
    v_add_f32 v151, s63, v151
    v_add_f32 v152, s63, v152
    v_add_f32 v153, s63, v153
    v_add_f32 v154, s63, v154
    v_add_f32 v155, s63, v155
    v_add_f32 v156, s63, v156
    v_add_f32 v157, s63, v157
    v_add_f32 v158, s63, v158
    v_add_f32 v159, s63, v159
    v_add_f32 v160, s63, v160
    v_add_f32 v161, s63, v161
    v_add_f32 v162, s63, v162
    v_add_f32 v163, s63, v163
    v_add_f32 v164, s63, v164
    v_add_f32 v165, s63, v165
    v_add_f32 v166, s63, v166
    v_add_f32 v167, s63, v167
    v_add_f32 v168, s63, v168
    v_add_f32 v169, s63, v169
    v_add_f32 v170, s63, v170
    v_add_f32 v171, s63, v171
    v_add_f32 v172, s63, v172
    v_add_f32 v173, s63, v173
    v_add_f32 v174, s63, v174
    v_add_f32 v175, s63, v175
    v_add_f32 v176, s63, v176
    v_add_f32 v177, s63, v177
    v_add_f32 v178, s63, v178
    v_add_f32 v179, s63, v179
    v_add_f32 v180, s63, v180
    v_add_f32 v181, s63, v181
    v_add_f32 v182, s63, v182
    v_add_f32 v183, s63, v183
    v_add_f32 v184, s63, v184
    v_add_f32 v185, s63, v185
    v_add_f32 v186, s63, v186
    v_add_f32 v187, s63, v187
    v_add_f32 v188, s63, v188
    v_add_f32 v189, s63, v189
    v_add_f32 v190, s63, v190
    v_add_f32 v191, s63, v191
    v_mul_f32 v16, s62, v192
    v_mul_f32 v17, s62, v193
    v_mul_f32 v18, s62, v194
    v_mul_f32 v19, s62, v195
    v_mul_f32 v20, s62, v196
    v_mul_f32 v21, s62, v197
    v_mul_f32 v22, s62, v198
    v_mul_f32 v23, s62, v199
    v_mul_f32 v24, s62, v200
    v_mul_f32 v25, s62, v201
    v_mul_f32 v26, s62, v202
    v_mul_f32 v27, s62, v203
    v_mul_f32 v28, s62, v204
    v_mul_f32 v29, s62, v205
    v_mul_f32 v30, s62, v206
    v_mul_f32 v31, s62, v207
    v_mul_f32 v32, s62, v208
    v_mul_f32 v33, s62, v209
    v_mul_f32 v34, s62, v210
    v_mul_f32 v35, s62, v211
    v_mul_f32 v36, s62, v212
    v_mul_f32 v37, s62, v213
    v_mul_f32 v38, s62, v214
    v_mul_f32 v39, s62, v215
    v_mul_f32 v40, s62, v216
    v_mul_f32 v41, s62, v217
    v_mul_f32 v42, s62, v218
    v_mul_f32 v43, s62, v219
    v_mul_f32 v44, s62, v220
    v_mul_f32 v45, s62, v221
    v_mul_f32 v46, s62, v222
    v_mul_f32 v47, s62, v223
    v_mul_f32 v48, s62, v224
    v_mul_f32 v49, s62, v225
    v_mul_f32 v50, s62, v226
    v_mul_f32 v51, s62, v227
    v_mul_f32 v52, s62, v228
    v_mul_f32 v53, s62, v229
    v_mul_f32 v54, s62, v230
    v_mul_f32 v55, s62, v231
    v_mul_f32 v56, s62, v232
    v_mul_f32 v57, s62, v233
    v_mul_f32 v58, s62, v234
    v_mul_f32 v59, s62, v235
    v_mul_f32 v60, s62, v236
    v_mul_f32 v61, s62, v237
    v_mul_f32 v62, s62, v238
    v_mul_f32 v63, s62, v239
    v_mul_f32 v64, s62, v240
    v_mul_f32 v65, s62, v241
    v_mul_f32 v66, s62, v242
    v_mul_f32 v67, s62, v243
    v_mul_f32 v68, s62, v244
    v_mul_f32 v69, s62, v245
    v_mul_f32 v70, s62, v246
    v_mul_f32 v71, s62, v247
    v_mul_f32 v72, s62, v248
    v_mul_f32 v73, s62, v249
    v_mul_f32 v74, s62, v250
    v_mul_f32 v75, s62, v251
    v_mul_f32 v76, s62, v252
    v_mul_f32 v77, s62, v253
    v_mul_f32 v78, s62, v254
    v_mul_f32 v79, s62, v255
    v_min_f32 v16, 0, v16
    v_min_f32 v17, 0, v17
    v_min_f32 v18, 0, v18
    v_min_f32 v19, 0, v19
    v_min_f32 v20, 0, v20
    v_min_f32 v21, 0, v21
    v_min_f32 v22, 0, v22
    v_min_f32 v23, 0, v23
    v_min_f32 v24, 0, v24
    v_min_f32 v25, 0, v25
    v_min_f32 v26, 0, v26
    v_min_f32 v27, 0, v27
    v_min_f32 v28, 0, v28
    v_min_f32 v29, 0, v29
    v_min_f32 v30, 0, v30
    v_min_f32 v31, 0, v31
    v_min_f32 v32, 0, v32
    v_min_f32 v33, 0, v33
    v_min_f32 v34, 0, v34
    v_min_f32 v35, 0, v35
    v_min_f32 v36, 0, v36
    v_min_f32 v37, 0, v37
    v_min_f32 v38, 0, v38
    v_min_f32 v39, 0, v39
    v_min_f32 v40, 0, v40
    v_min_f32 v41, 0, v41
    v_min_f32 v42, 0, v42
    v_min_f32 v43, 0, v43
    v_min_f32 v44, 0, v44
    v_min_f32 v45, 0, v45
    v_min_f32 v46, 0, v46
    v_min_f32 v47, 0, v47
    v_min_f32 v48, 0, v48
    v_min_f32 v49, 0, v49
    v_min_f32 v50, 0, v50
    v_min_f32 v51, 0, v51
    v_min_f32 v52, 0, v52
    v_min_f32 v53, 0, v53
    v_min_f32 v54, 0, v54
    v_min_f32 v55, 0, v55
    v_min_f32 v56, 0, v56
    v_min_f32 v57, 0, v57
    v_min_f32 v58, 0, v58
    v_min_f32 v59, 0, v59
    v_min_f32 v60, 0, v60
    v_min_f32 v61, 0, v61
    v_min_f32 v62, 0, v62
    v_min_f32 v63, 0, v63
    v_min_f32 v64, 0, v64
    v_min_f32 v65, 0, v65
    v_min_f32 v66, 0, v66
    v_min_f32 v67, 0, v67
    v_min_f32 v68, 0, v68
    v_min_f32 v69, 0, v69
    v_min_f32 v70, 0, v70
    v_min_f32 v71, 0, v71
    v_min_f32 v72, 0, v72
    v_min_f32 v73, 0, v73
    v_min_f32 v74, 0, v74
    v_min_f32 v75, 0, v75
    v_min_f32 v76, 0, v76
    v_min_f32 v77, 0, v77
    v_min_f32 v78, 0, v78
    v_min_f32 v79, 0, v79
    v_exp_f32 v16, v16
    v_exp_f32 v17, v17
    v_exp_f32 v18, v18
    v_exp_f32 v19, v19
    v_exp_f32 v20, v20
    v_exp_f32 v21, v21
    v_exp_f32 v22, v22
    v_exp_f32 v23, v23
    v_exp_f32 v24, v24
    v_exp_f32 v25, v25
    v_exp_f32 v26, v26
    v_exp_f32 v27, v27
    v_exp_f32 v28, v28
    v_exp_f32 v29, v29
    v_exp_f32 v30, v30
    v_exp_f32 v31, v31
    v_exp_f32 v32, v32
    v_exp_f32 v33, v33
    v_exp_f32 v34, v34
    v_exp_f32 v35, v35
    v_exp_f32 v36, v36
    v_exp_f32 v37, v37
    v_exp_f32 v38, v38
    v_exp_f32 v39, v39
    v_exp_f32 v40, v40
    v_exp_f32 v41, v41
    v_exp_f32 v42, v42
    v_exp_f32 v43, v43
    v_exp_f32 v44, v44
    v_exp_f32 v45, v45
    v_exp_f32 v46, v46
    v_exp_f32 v47, v47
    v_exp_f32 v48, v48
    v_exp_f32 v49, v49
    v_exp_f32 v50, v50
    v_exp_f32 v51, v51
    v_exp_f32 v52, v52
    v_exp_f32 v53, v53
    v_exp_f32 v54, v54
    v_exp_f32 v55, v55
    v_exp_f32 v56, v56
    v_exp_f32 v57, v57
    v_exp_f32 v58, v58
    v_exp_f32 v59, v59
    v_exp_f32 v60, v60
    v_exp_f32 v61, v61
    v_exp_f32 v62, v62
    v_exp_f32 v63, v63
    v_exp_f32 v64, v64
    v_exp_f32 v65, v65
    v_exp_f32 v66, v66
    v_exp_f32 v67, v67
    v_exp_f32 v68, v68
    v_exp_f32 v69, v69
    v_exp_f32 v70, v70
    v_exp_f32 v71, v71
    v_exp_f32 v72, v72
    v_exp_f32 v73, v73
    v_exp_f32 v74, v74
    v_exp_f32 v75, v75
    v_exp_f32 v76, v76
    v_exp_f32 v77, v77
    v_exp_f32 v78, v78
    v_exp_f32 v79, v79
    v_max_f32 v192, 0, v192
    v_max_f32 v193, 0, v193
    v_max_f32 v194, 0, v194
    v_max_f32 v195, 0, v195
    v_max_f32 v196, 0, v196
    v_max_f32 v197, 0, v197
    v_max_f32 v198, 0, v198
    v_max_f32 v199, 0, v199
    v_max_f32 v200, 0, v200
    v_max_f32 v201, 0, v201
    v_max_f32 v202, 0, v202
    v_max_f32 v203, 0, v203
    v_max_f32 v204, 0, v204
    v_max_f32 v205, 0, v205
    v_max_f32 v206, 0, v206
    v_max_f32 v207, 0, v207
    v_max_f32 v208, 0, v208
    v_max_f32 v209, 0, v209
    v_max_f32 v210, 0, v210
    v_max_f32 v211, 0, v211
    v_max_f32 v212, 0, v212
    v_max_f32 v213, 0, v213
    v_max_f32 v214, 0, v214
    v_max_f32 v215, 0, v215
    v_max_f32 v216, 0, v216
    v_max_f32 v217, 0, v217
    v_max_f32 v218, 0, v218
    v_max_f32 v219, 0, v219
    v_max_f32 v220, 0, v220
    v_max_f32 v221, 0, v221
    v_max_f32 v222, 0, v222
    v_max_f32 v223, 0, v223
    v_max_f32 v224, 0, v224
    v_max_f32 v225, 0, v225
    v_max_f32 v226, 0, v226
    v_max_f32 v227, 0, v227
    v_max_f32 v228, 0, v228
    v_max_f32 v229, 0, v229
    v_max_f32 v230, 0, v230
    v_max_f32 v231, 0, v231
    v_max_f32 v232, 0, v232
    v_max_f32 v233, 0, v233
    v_max_f32 v234, 0, v234
    v_max_f32 v235, 0, v235
    v_max_f32 v236, 0, v236
    v_max_f32 v237, 0, v237
    v_max_f32 v238, 0, v238
    v_max_f32 v239, 0, v239
    v_max_f32 v240, 0, v240
    v_max_f32 v241, 0, v241
    v_max_f32 v242, 0, v242
    v_max_f32 v243, 0, v243
    v_max_f32 v244, 0, v244
    v_max_f32 v245, 0, v245
    v_max_f32 v246, 0, v246
    v_max_f32 v247, 0, v247
    v_max_f32 v248, 0, v248
    v_max_f32 v249, 0, v249
    v_max_f32 v250, 0, v250
    v_max_f32 v251, 0, v251
    v_max_f32 v252, 0, v252
    v_max_f32 v253, 0, v253
    v_max_f32 v254, 0, v254
    v_max_f32 v255, 0, v255
    v_add_f32 v192, v192, v16
    v_add_f32 v193, v193, v17
    v_add_f32 v194, v194, v18
    v_add_f32 v195, v195, v19
    v_add_f32 v196, v196, v20
    v_add_f32 v197, v197, v21
    v_add_f32 v198, v198, v22
    v_add_f32 v199, v199, v23
    v_add_f32 v200, v200, v24
    v_add_f32 v201, v201, v25
    v_add_f32 v202, v202, v26
    v_add_f32 v203, v203, v27
    v_add_f32 v204, v204, v28
    v_add_f32 v205, v205, v29
    v_add_f32 v206, v206, v30
    v_add_f32 v207, v207, v31
    v_add_f32 v208, v208, v32
    v_add_f32 v209, v209, v33
    v_add_f32 v210, v210, v34
    v_add_f32 v211, v211, v35
    v_add_f32 v212, v212, v36
    v_add_f32 v213, v213, v37
    v_add_f32 v214, v214, v38
    v_add_f32 v215, v215, v39
    v_add_f32 v216, v216, v40
    v_add_f32 v217, v217, v41
    v_add_f32 v218, v218, v42
    v_add_f32 v219, v219, v43
    v_add_f32 v220, v220, v44
    v_add_f32 v221, v221, v45
    v_add_f32 v222, v222, v46
    v_add_f32 v223, v223, v47
    v_add_f32 v224, v224, v48
    v_add_f32 v225, v225, v49
    v_add_f32 v226, v226, v50
    v_add_f32 v227, v227, v51
    v_add_f32 v228, v228, v52
    v_add_f32 v229, v229, v53
    v_add_f32 v230, v230, v54
    v_add_f32 v231, v231, v55
    v_add_f32 v232, v232, v56
    v_add_f32 v233, v233, v57
    v_add_f32 v234, v234, v58
    v_add_f32 v235, v235, v59
    v_add_f32 v236, v236, v60
    v_add_f32 v237, v237, v61
    v_add_f32 v238, v238, v62
    v_add_f32 v239, v239, v63
    v_add_f32 v240, v240, v64
    v_add_f32 v241, v241, v65
    v_add_f32 v242, v242, v66
    v_add_f32 v243, v243, v67
    v_add_f32 v244, v244, v68
    v_add_f32 v245, v245, v69
    v_add_f32 v246, v246, v70
    v_add_f32 v247, v247, v71
    v_add_f32 v248, v248, v72
    v_add_f32 v249, v249, v73
    v_add_f32 v250, v250, v74
    v_add_f32 v251, v251, v75
    v_add_f32 v252, v252, v76
    v_add_f32 v253, v253, v77
    v_add_f32 v254, v254, v78
    v_add_f32 v255, v255, v79
    v_add_f32 v192, s63, v192
    v_add_f32 v193, s63, v193
    v_add_f32 v194, s63, v194
    v_add_f32 v195, s63, v195
    v_add_f32 v196, s63, v196
    v_add_f32 v197, s63, v197
    v_add_f32 v198, s63, v198
    v_add_f32 v199, s63, v199
    v_add_f32 v200, s63, v200
    v_add_f32 v201, s63, v201
    v_add_f32 v202, s63, v202
    v_add_f32 v203, s63, v203
    v_add_f32 v204, s63, v204
    v_add_f32 v205, s63, v205
    v_add_f32 v206, s63, v206
    v_add_f32 v207, s63, v207
    v_add_f32 v208, s63, v208
    v_add_f32 v209, s63, v209
    v_add_f32 v210, s63, v210
    v_add_f32 v211, s63, v211
    v_add_f32 v212, s63, v212
    v_add_f32 v213, s63, v213
    v_add_f32 v214, s63, v214
    v_add_f32 v215, s63, v215
    v_add_f32 v216, s63, v216
    v_add_f32 v217, s63, v217
    v_add_f32 v218, s63, v218
    v_add_f32 v219, s63, v219
    v_add_f32 v220, s63, v220
    v_add_f32 v221, s63, v221
    v_add_f32 v222, s63, v222
    v_add_f32 v223, s63, v223
    v_add_f32 v224, s63, v224
    v_add_f32 v225, s63, v225
    v_add_f32 v226, s63, v226
    v_add_f32 v227, s63, v227
    v_add_f32 v228, s63, v228
    v_add_f32 v229, s63, v229
    v_add_f32 v230, s63, v230
    v_add_f32 v231, s63, v231
    v_add_f32 v232, s63, v232
    v_add_f32 v233, s63, v233
    v_add_f32 v234, s63, v234
    v_add_f32 v235, s63, v235
    v_add_f32 v236, s63, v236
    v_add_f32 v237, s63, v237
    v_add_f32 v238, s63, v238
    v_add_f32 v239, s63, v239
    v_add_f32 v240, s63, v240
    v_add_f32 v241, s63, v241
    v_add_f32 v242, s63, v242
    v_add_f32 v243, s63, v243
    v_add_f32 v244, s63, v244
    v_add_f32 v245, s63, v245
    v_add_f32 v246, s63, v246
    v_add_f32 v247, s63, v247
    v_add_f32 v248, s63, v248
    v_add_f32 v249, s63, v249
    v_add_f32 v250, s63, v250
    v_add_f32 v251, s63, v251
    v_add_f32 v252, s63, v252
    v_add_f32 v253, s63, v253
    v_add_f32 v254, s63, v254
    v_add_f32 v255, s63, v255
    v_cvt_pk_bf16_f32 v128, v128, v129
    v_cvt_pk_bf16_f32 v129, v130, v131
    v_accvgpr_write_b32 a0, v128
    v_accvgpr_write_b32 a1, v129
    v_cvt_pk_bf16_f32 v160, v160, v161
    v_cvt_pk_bf16_f32 v161, v162, v163
    v_accvgpr_write_b32 a2, v160
    v_accvgpr_write_b32 a3, v161
    v_cvt_pk_bf16_f32 v132, v132, v133
    v_cvt_pk_bf16_f32 v133, v134, v135
    v_accvgpr_write_b32 a4, v132
    v_accvgpr_write_b32 a5, v133
    v_cvt_pk_bf16_f32 v164, v164, v165
    v_cvt_pk_bf16_f32 v165, v166, v167
    v_accvgpr_write_b32 a6, v164
    v_accvgpr_write_b32 a7, v165
    v_cvt_pk_bf16_f32 v136, v136, v137
    v_cvt_pk_bf16_f32 v137, v138, v139
    v_accvgpr_write_b32 a8, v136
    v_accvgpr_write_b32 a9, v137
    v_cvt_pk_bf16_f32 v168, v168, v169
    v_cvt_pk_bf16_f32 v169, v170, v171
    v_accvgpr_write_b32 a10, v168
    v_accvgpr_write_b32 a11, v169
    v_cvt_pk_bf16_f32 v140, v140, v141
    v_cvt_pk_bf16_f32 v141, v142, v143
    v_accvgpr_write_b32 a12, v140
    v_accvgpr_write_b32 a13, v141
    v_cvt_pk_bf16_f32 v172, v172, v173
    v_cvt_pk_bf16_f32 v173, v174, v175
    v_accvgpr_write_b32 a14, v172
    v_accvgpr_write_b32 a15, v173
    v_cvt_pk_bf16_f32 v144, v144, v145
    v_cvt_pk_bf16_f32 v145, v146, v147
    v_accvgpr_write_b32 a16, v144
    v_accvgpr_write_b32 a17, v145
    v_cvt_pk_bf16_f32 v176, v176, v177
    v_cvt_pk_bf16_f32 v177, v178, v179
    v_accvgpr_write_b32 a18, v176
    v_accvgpr_write_b32 a19, v177
    v_cvt_pk_bf16_f32 v148, v148, v149
    v_cvt_pk_bf16_f32 v149, v150, v151
    v_accvgpr_write_b32 a20, v148
    v_accvgpr_write_b32 a21, v149
    v_cvt_pk_bf16_f32 v180, v180, v181
    v_cvt_pk_bf16_f32 v181, v182, v183
    v_accvgpr_write_b32 a22, v180
    v_accvgpr_write_b32 a23, v181
    v_cvt_pk_bf16_f32 v152, v152, v153
    v_cvt_pk_bf16_f32 v153, v154, v155
    v_accvgpr_write_b32 a24, v152
    v_accvgpr_write_b32 a25, v153
    v_cvt_pk_bf16_f32 v184, v184, v185
    v_cvt_pk_bf16_f32 v185, v186, v187
    v_accvgpr_write_b32 a26, v184
    v_accvgpr_write_b32 a27, v185
    v_cvt_pk_bf16_f32 v156, v156, v157
    v_cvt_pk_bf16_f32 v157, v158, v159
    v_accvgpr_write_b32 a28, v156
    v_accvgpr_write_b32 a29, v157
    v_cvt_pk_bf16_f32 v188, v188, v189
    v_cvt_pk_bf16_f32 v189, v190, v191
    v_accvgpr_write_b32 a30, v188
    v_accvgpr_write_b32 a31, v189
    v_cvt_pk_bf16_f32 v192, v192, v193
    v_cvt_pk_bf16_f32 v193, v194, v195
    v_accvgpr_write_b32 a32, v192
    v_accvgpr_write_b32 a33, v193
    v_cvt_pk_bf16_f32 v224, v224, v225
    v_cvt_pk_bf16_f32 v225, v226, v227
    v_accvgpr_write_b32 a34, v224
    v_accvgpr_write_b32 a35, v225
    v_cvt_pk_bf16_f32 v196, v196, v197
    v_cvt_pk_bf16_f32 v197, v198, v199
    v_accvgpr_write_b32 a36, v196
    v_accvgpr_write_b32 a37, v197
    v_cvt_pk_bf16_f32 v228, v228, v229
    v_cvt_pk_bf16_f32 v229, v230, v231
    v_accvgpr_write_b32 a38, v228
    v_accvgpr_write_b32 a39, v229
    v_cvt_pk_bf16_f32 v200, v200, v201
    v_cvt_pk_bf16_f32 v201, v202, v203
    v_accvgpr_write_b32 a40, v200
    v_accvgpr_write_b32 a41, v201
    v_cvt_pk_bf16_f32 v232, v232, v233
    v_cvt_pk_bf16_f32 v233, v234, v235
    v_accvgpr_write_b32 a42, v232
    v_accvgpr_write_b32 a43, v233
    v_cvt_pk_bf16_f32 v204, v204, v205
    v_cvt_pk_bf16_f32 v205, v206, v207
    v_accvgpr_write_b32 a44, v204
    v_accvgpr_write_b32 a45, v205
    v_cvt_pk_bf16_f32 v236, v236, v237
    v_cvt_pk_bf16_f32 v237, v238, v239
    v_accvgpr_write_b32 a46, v236
    v_accvgpr_write_b32 a47, v237
    v_cvt_pk_bf16_f32 v208, v208, v209
    v_cvt_pk_bf16_f32 v209, v210, v211
    v_accvgpr_write_b32 a48, v208
    v_accvgpr_write_b32 a49, v209
    v_cvt_pk_bf16_f32 v240, v240, v241
    v_cvt_pk_bf16_f32 v241, v242, v243
    v_accvgpr_write_b32 a50, v240
    v_accvgpr_write_b32 a51, v241
    v_cvt_pk_bf16_f32 v212, v212, v213
    v_cvt_pk_bf16_f32 v213, v214, v215
    v_accvgpr_write_b32 a52, v212
    v_accvgpr_write_b32 a53, v213
    v_cvt_pk_bf16_f32 v244, v244, v245
    v_cvt_pk_bf16_f32 v245, v246, v247
    v_accvgpr_write_b32 a54, v244
    v_accvgpr_write_b32 a55, v245
    v_cvt_pk_bf16_f32 v216, v216, v217
    v_cvt_pk_bf16_f32 v217, v218, v219
    v_accvgpr_write_b32 a56, v216
    v_accvgpr_write_b32 a57, v217
    v_cvt_pk_bf16_f32 v248, v248, v249
    v_cvt_pk_bf16_f32 v249, v250, v251
    v_accvgpr_write_b32 a58, v248
    v_accvgpr_write_b32 a59, v249
    v_cvt_pk_bf16_f32 v220, v220, v221
    v_cvt_pk_bf16_f32 v221, v222, v223
    v_accvgpr_write_b32 a60, v220
    v_accvgpr_write_b32 a61, v221
    v_cvt_pk_bf16_f32 v252, v252, v253
    v_cvt_pk_bf16_f32 v253, v254, v255
    v_accvgpr_write_b32 a62, v252
    v_accvgpr_write_b32 a63, v253
    s_mul_i32 s44, s8, 224
    s_add_u32 s44, s44, 112
    buffer_load_dword v80, v10, s[32:35], s44 offen
    buffer_load_dword v81, v10, s[32:35], s44 offen offset:2688
    buffer_load_dword v82, v11, s[32:35], s44 offen
    buffer_load_dword v83, v11, s[32:35], s44 offen offset:2688
    buffer_load_dword v84, v12, s[32:35], s44 offen
    buffer_load_dword v85, v12, s[32:35], s44 offen offset:2688
    buffer_load_dword v86, v13, s[32:35], s44 offen
    buffer_load_dword v87, v13, s[32:35], s44 offen offset:2688
    buffer_load_dword v88, v10, s[32:35], s44 offen offset:56
    buffer_load_dword v89, v10, s[32:35], s44 offen offset:2744
    buffer_load_dword v90, v11, s[32:35], s44 offen offset:56
    buffer_load_dword v91, v11, s[32:35], s44 offen offset:2744
    buffer_load_dword v92, v12, s[32:35], s44 offen offset:56
    buffer_load_dword v93, v12, s[32:35], s44 offen offset:2744
    buffer_load_dword v94, v13, s[32:35], s44 offen offset:56
    buffer_load_dword v95, v13, s[32:35], s44 offen offset:2744
    s_add_u32 s44, s44, 86016
    v_mov_b32 v14, v9
    ds_read_b128 v[16:19], v14
    ds_read_b128 v[20:23], v14 offset:1024
    ds_read_b128 v[24:27], v14 offset:2048
    ds_read_b128 v[28:31], v14 offset:3072
    ds_read_b128 v[32:35], v14 offset:4096
    ds_read_b128 v[36:39], v14 offset:5120
    ds_read_b128 v[40:43], v14 offset:6144
    ds_read_b128 v[44:47], v14 offset:7168
    v_add_u32 v14, 0x2000, v14
    v_mov_b32 v128, 0
    v_mov_b32 v129, 0
    v_mov_b32 v130, 0
    v_mov_b32 v131, 0
    v_mov_b32 v132, 0
    v_mov_b32 v133, 0
    v_mov_b32 v134, 0
    v_mov_b32 v135, 0
    v_mov_b32 v136, 0
    v_mov_b32 v137, 0
    v_mov_b32 v138, 0
    v_mov_b32 v139, 0
    v_mov_b32 v140, 0
    v_mov_b32 v141, 0
    v_mov_b32 v142, 0
    v_mov_b32 v143, 0
    v_mov_b32 v144, 0
    v_mov_b32 v145, 0
    v_mov_b32 v146, 0
    v_mov_b32 v147, 0
    v_mov_b32 v148, 0
    v_mov_b32 v149, 0
    v_mov_b32 v150, 0
    v_mov_b32 v151, 0
    v_mov_b32 v152, 0
    v_mov_b32 v153, 0
    v_mov_b32 v154, 0
    v_mov_b32 v155, 0
    v_mov_b32 v156, 0
    v_mov_b32 v157, 0
    v_mov_b32 v158, 0
    v_mov_b32 v159, 0
    v_mov_b32 v160, 0
    v_mov_b32 v161, 0
    v_mov_b32 v162, 0
    v_mov_b32 v163, 0
    v_mov_b32 v164, 0
    v_mov_b32 v165, 0
    v_mov_b32 v166, 0
    v_mov_b32 v167, 0
    v_mov_b32 v168, 0
    v_mov_b32 v169, 0
    v_mov_b32 v170, 0
    v_mov_b32 v171, 0
    v_mov_b32 v172, 0
    v_mov_b32 v173, 0
    v_mov_b32 v174, 0
    v_mov_b32 v175, 0
    v_mov_b32 v176, 0
    v_mov_b32 v177, 0
    v_mov_b32 v178, 0
    v_mov_b32 v179, 0
    v_mov_b32 v180, 0
    v_mov_b32 v181, 0
    v_mov_b32 v182, 0
    v_mov_b32 v183, 0
    v_mov_b32 v184, 0
    v_mov_b32 v185, 0
    v_mov_b32 v186, 0
    v_mov_b32 v187, 0
    v_mov_b32 v188, 0
    v_mov_b32 v189, 0
    v_mov_b32 v190, 0
    v_mov_b32 v191, 0
    v_mov_b32 v192, 0
    v_mov_b32 v193, 0
    v_mov_b32 v194, 0
    v_mov_b32 v195, 0
    v_mov_b32 v196, 0
    v_mov_b32 v197, 0
    v_mov_b32 v198, 0
    v_mov_b32 v199, 0
    v_mov_b32 v200, 0
    v_mov_b32 v201, 0
    v_mov_b32 v202, 0
    v_mov_b32 v203, 0
    v_mov_b32 v204, 0
    v_mov_b32 v205, 0
    v_mov_b32 v206, 0
    v_mov_b32 v207, 0
    v_mov_b32 v208, 0
    v_mov_b32 v209, 0
    v_mov_b32 v210, 0
    v_mov_b32 v211, 0
    v_mov_b32 v212, 0
    v_mov_b32 v213, 0
    v_mov_b32 v214, 0
    v_mov_b32 v215, 0
    v_mov_b32 v216, 0
    v_mov_b32 v217, 0
    v_mov_b32 v218, 0
    v_mov_b32 v219, 0
    v_mov_b32 v220, 0
    v_mov_b32 v221, 0
    v_mov_b32 v222, 0
    v_mov_b32 v223, 0
    v_mov_b32 v224, 0
    v_mov_b32 v225, 0
    v_mov_b32 v226, 0
    v_mov_b32 v227, 0
    v_mov_b32 v228, 0
    v_mov_b32 v229, 0
    v_mov_b32 v230, 0
    v_mov_b32 v231, 0
    v_mov_b32 v232, 0
    v_mov_b32 v233, 0
    v_mov_b32 v234, 0
    v_mov_b32 v235, 0
    v_mov_b32 v236, 0
    v_mov_b32 v237, 0
    v_mov_b32 v238, 0
    v_mov_b32 v239, 0
    v_mov_b32 v240, 0
    v_mov_b32 v241, 0
    v_mov_b32 v242, 0
    v_mov_b32 v243, 0
    v_mov_b32 v244, 0
    v_mov_b32 v245, 0
    v_mov_b32 v246, 0
    v_mov_b32 v247, 0
    v_mov_b32 v248, 0
    v_mov_b32 v249, 0
    v_mov_b32 v250, 0
    v_mov_b32 v251, 0
    v_mov_b32 v252, 0
    v_mov_b32 v253, 0
    v_mov_b32 v254, 0
    v_mov_b32 v255, 0
    s_mov_b32 s45, 7
.bg_108:
    buffer_load_dword v96, v10, s[32:35], s44 offen
    buffer_load_dword v97, v10, s[32:35], s44 offen offset:2688
    buffer_load_dword v98, v11, s[32:35], s44 offen
    buffer_load_dword v99, v11, s[32:35], s44 offen offset:2688
    buffer_load_dword v100, v12, s[32:35], s44 offen
    buffer_load_dword v101, v12, s[32:35], s44 offen offset:2688
    buffer_load_dword v102, v13, s[32:35], s44 offen
    buffer_load_dword v103, v13, s[32:35], s44 offen offset:2688
    buffer_load_dword v104, v10, s[32:35], s44 offen offset:56
    buffer_load_dword v105, v10, s[32:35], s44 offen offset:2744
    buffer_load_dword v106, v11, s[32:35], s44 offen offset:56
    buffer_load_dword v107, v11, s[32:35], s44 offen offset:2744
    buffer_load_dword v108, v12, s[32:35], s44 offen offset:56
    buffer_load_dword v109, v12, s[32:35], s44 offen offset:2744
    buffer_load_dword v110, v13, s[32:35], s44 offen offset:56
    buffer_load_dword v111, v13, s[32:35], s44 offen offset:2744
    s_add_u32 s44, s44, 86016
    s_waitcnt vmcnt(16)
    v_perm_b32 v112, v81, v80, s60
    v_perm_b32 v113, v83, v82, s60
    v_perm_b32 v114, v85, v84, s60
    v_perm_b32 v115, v87, v86, s60
    v_perm_b32 v116, v81, v80, s61
    v_perm_b32 v117, v83, v82, s61
    v_perm_b32 v118, v85, v84, s61
    v_perm_b32 v119, v87, v86, s61
    v_perm_b32 v120, v89, v88, s60
    v_perm_b32 v121, v91, v90, s60
    v_perm_b32 v122, v93, v92, s60
    v_perm_b32 v123, v95, v94, s60
    v_perm_b32 v124, v89, v88, s61
    v_perm_b32 v125, v91, v90, s61
    v_perm_b32 v126, v93, v92, s61
    v_perm_b32 v127, v95, v94, s61
    s_waitcnt lgkmcnt(0)
    ds_read_b128 v[48:51], v14
    ds_read_b128 v[52:55], v14 offset:1024
    ds_read_b128 v[56:59], v14 offset:2048
    ds_read_b128 v[60:63], v14 offset:3072
    ds_read_b128 v[64:67], v14 offset:4096
    ds_read_b128 v[68:71], v14 offset:5120
    ds_read_b128 v[72:75], v14 offset:6144
    ds_read_b128 v[76:79], v14 offset:7168
    v_add_u32 v14, 0x2000, v14
    v_mfma_f32_16x16x32_bf16 v[128:131], v[112:115], v[16:19], v[128:131]
    v_mfma_f32_16x16x32_bf16 v[160:163], v[116:119], v[16:19], v[160:163]
    v_mfma_f32_16x16x32_bf16 v[192:195], v[120:123], v[16:19], v[192:195]
    v_mfma_f32_16x16x32_bf16 v[224:227], v[124:127], v[16:19], v[224:227]
    v_mfma_f32_16x16x32_bf16 v[132:135], v[112:115], v[20:23], v[132:135]
    v_mfma_f32_16x16x32_bf16 v[164:167], v[116:119], v[20:23], v[164:167]
    v_mfma_f32_16x16x32_bf16 v[196:199], v[120:123], v[20:23], v[196:199]
    v_mfma_f32_16x16x32_bf16 v[228:231], v[124:127], v[20:23], v[228:231]
    v_mfma_f32_16x16x32_bf16 v[136:139], v[112:115], v[24:27], v[136:139]
    v_mfma_f32_16x16x32_bf16 v[168:171], v[116:119], v[24:27], v[168:171]
    v_mfma_f32_16x16x32_bf16 v[200:203], v[120:123], v[24:27], v[200:203]
    v_mfma_f32_16x16x32_bf16 v[232:235], v[124:127], v[24:27], v[232:235]
    v_mfma_f32_16x16x32_bf16 v[140:143], v[112:115], v[28:31], v[140:143]
    v_mfma_f32_16x16x32_bf16 v[172:175], v[116:119], v[28:31], v[172:175]
    v_mfma_f32_16x16x32_bf16 v[204:207], v[120:123], v[28:31], v[204:207]
    v_mfma_f32_16x16x32_bf16 v[236:239], v[124:127], v[28:31], v[236:239]
    v_mfma_f32_16x16x32_bf16 v[144:147], v[112:115], v[32:35], v[144:147]
    v_mfma_f32_16x16x32_bf16 v[176:179], v[116:119], v[32:35], v[176:179]
    v_mfma_f32_16x16x32_bf16 v[208:211], v[120:123], v[32:35], v[208:211]
    v_mfma_f32_16x16x32_bf16 v[240:243], v[124:127], v[32:35], v[240:243]
    v_mfma_f32_16x16x32_bf16 v[148:151], v[112:115], v[36:39], v[148:151]
    v_mfma_f32_16x16x32_bf16 v[180:183], v[116:119], v[36:39], v[180:183]
    v_mfma_f32_16x16x32_bf16 v[212:215], v[120:123], v[36:39], v[212:215]
    v_mfma_f32_16x16x32_bf16 v[244:247], v[124:127], v[36:39], v[244:247]
    v_mfma_f32_16x16x32_bf16 v[152:155], v[112:115], v[40:43], v[152:155]
    v_mfma_f32_16x16x32_bf16 v[184:187], v[116:119], v[40:43], v[184:187]
    v_mfma_f32_16x16x32_bf16 v[216:219], v[120:123], v[40:43], v[216:219]
    v_mfma_f32_16x16x32_bf16 v[248:251], v[124:127], v[40:43], v[248:251]
    v_mfma_f32_16x16x32_bf16 v[156:159], v[112:115], v[44:47], v[156:159]
    v_mfma_f32_16x16x32_bf16 v[188:191], v[116:119], v[44:47], v[188:191]
    v_mfma_f32_16x16x32_bf16 v[220:223], v[120:123], v[44:47], v[220:223]
    v_mfma_f32_16x16x32_bf16 v[252:255], v[124:127], v[44:47], v[252:255]
    buffer_load_dword v80, v10, s[32:35], s44 offen
    buffer_load_dword v81, v10, s[32:35], s44 offen offset:2688
    buffer_load_dword v82, v11, s[32:35], s44 offen
    buffer_load_dword v83, v11, s[32:35], s44 offen offset:2688
    buffer_load_dword v84, v12, s[32:35], s44 offen
    buffer_load_dword v85, v12, s[32:35], s44 offen offset:2688
    buffer_load_dword v86, v13, s[32:35], s44 offen
    buffer_load_dword v87, v13, s[32:35], s44 offen offset:2688
    buffer_load_dword v88, v10, s[32:35], s44 offen offset:56
    buffer_load_dword v89, v10, s[32:35], s44 offen offset:2744
    buffer_load_dword v90, v11, s[32:35], s44 offen offset:56
    buffer_load_dword v91, v11, s[32:35], s44 offen offset:2744
    buffer_load_dword v92, v12, s[32:35], s44 offen offset:56
    buffer_load_dword v93, v12, s[32:35], s44 offen offset:2744
    buffer_load_dword v94, v13, s[32:35], s44 offen offset:56
    buffer_load_dword v95, v13, s[32:35], s44 offen offset:2744
    s_add_u32 s44, s44, 86016
    s_waitcnt vmcnt(16)
    v_perm_b32 v112, v97, v96, s60
    v_perm_b32 v113, v99, v98, s60
    v_perm_b32 v114, v101, v100, s60
    v_perm_b32 v115, v103, v102, s60
    v_perm_b32 v116, v97, v96, s61
    v_perm_b32 v117, v99, v98, s61
    v_perm_b32 v118, v101, v100, s61
    v_perm_b32 v119, v103, v102, s61
    v_perm_b32 v120, v105, v104, s60
    v_perm_b32 v121, v107, v106, s60
    v_perm_b32 v122, v109, v108, s60
    v_perm_b32 v123, v111, v110, s60
    v_perm_b32 v124, v105, v104, s61
    v_perm_b32 v125, v107, v106, s61
    v_perm_b32 v126, v109, v108, s61
    v_perm_b32 v127, v111, v110, s61
    s_waitcnt lgkmcnt(0)
    ds_read_b128 v[16:19], v14
    ds_read_b128 v[20:23], v14 offset:1024
    ds_read_b128 v[24:27], v14 offset:2048
    ds_read_b128 v[28:31], v14 offset:3072
    ds_read_b128 v[32:35], v14 offset:4096
    ds_read_b128 v[36:39], v14 offset:5120
    ds_read_b128 v[40:43], v14 offset:6144
    ds_read_b128 v[44:47], v14 offset:7168
    v_add_u32 v14, 0x2000, v14
    v_mfma_f32_16x16x32_bf16 v[128:131], v[112:115], v[48:51], v[128:131]
    v_mfma_f32_16x16x32_bf16 v[160:163], v[116:119], v[48:51], v[160:163]
    v_mfma_f32_16x16x32_bf16 v[192:195], v[120:123], v[48:51], v[192:195]
    v_mfma_f32_16x16x32_bf16 v[224:227], v[124:127], v[48:51], v[224:227]
    v_mfma_f32_16x16x32_bf16 v[132:135], v[112:115], v[52:55], v[132:135]
    v_mfma_f32_16x16x32_bf16 v[164:167], v[116:119], v[52:55], v[164:167]
    v_mfma_f32_16x16x32_bf16 v[196:199], v[120:123], v[52:55], v[196:199]
    v_mfma_f32_16x16x32_bf16 v[228:231], v[124:127], v[52:55], v[228:231]
    v_mfma_f32_16x16x32_bf16 v[136:139], v[112:115], v[56:59], v[136:139]
    v_mfma_f32_16x16x32_bf16 v[168:171], v[116:119], v[56:59], v[168:171]
    v_mfma_f32_16x16x32_bf16 v[200:203], v[120:123], v[56:59], v[200:203]
    v_mfma_f32_16x16x32_bf16 v[232:235], v[124:127], v[56:59], v[232:235]
    v_mfma_f32_16x16x32_bf16 v[140:143], v[112:115], v[60:63], v[140:143]
    v_mfma_f32_16x16x32_bf16 v[172:175], v[116:119], v[60:63], v[172:175]
    v_mfma_f32_16x16x32_bf16 v[204:207], v[120:123], v[60:63], v[204:207]
    v_mfma_f32_16x16x32_bf16 v[236:239], v[124:127], v[60:63], v[236:239]
    v_mfma_f32_16x16x32_bf16 v[144:147], v[112:115], v[64:67], v[144:147]
    v_mfma_f32_16x16x32_bf16 v[176:179], v[116:119], v[64:67], v[176:179]
    v_mfma_f32_16x16x32_bf16 v[208:211], v[120:123], v[64:67], v[208:211]
    v_mfma_f32_16x16x32_bf16 v[240:243], v[124:127], v[64:67], v[240:243]
    v_mfma_f32_16x16x32_bf16 v[148:151], v[112:115], v[68:71], v[148:151]
    v_mfma_f32_16x16x32_bf16 v[180:183], v[116:119], v[68:71], v[180:183]
    v_mfma_f32_16x16x32_bf16 v[212:215], v[120:123], v[68:71], v[212:215]
    v_mfma_f32_16x16x32_bf16 v[244:247], v[124:127], v[68:71], v[244:247]
    v_mfma_f32_16x16x32_bf16 v[152:155], v[112:115], v[72:75], v[152:155]
    v_mfma_f32_16x16x32_bf16 v[184:187], v[116:119], v[72:75], v[184:187]
    v_mfma_f32_16x16x32_bf16 v[216:219], v[120:123], v[72:75], v[216:219]
    v_mfma_f32_16x16x32_bf16 v[248:251], v[124:127], v[72:75], v[248:251]
    v_mfma_f32_16x16x32_bf16 v[156:159], v[112:115], v[76:79], v[156:159]
    v_mfma_f32_16x16x32_bf16 v[188:191], v[116:119], v[76:79], v[188:191]
    v_mfma_f32_16x16x32_bf16 v[220:223], v[120:123], v[76:79], v[220:223]
    v_mfma_f32_16x16x32_bf16 v[252:255], v[124:127], v[76:79], v[252:255]
    s_sub_u32 s45, s45, 1
    s_cmp_lg_u32 s45, 0
    s_cbranch_scc1 .bg_108
    s_waitcnt vmcnt(0) lgkmcnt(0)
    s_nop 7
    v_mul_f32 v16, s62, v128
    v_mul_f32 v17, s62, v129
    v_mul_f32 v18, s62, v130
    v_mul_f32 v19, s62, v131
    v_mul_f32 v20, s62, v132
    v_mul_f32 v21, s62, v133
    v_mul_f32 v22, s62, v134
    v_mul_f32 v23, s62, v135
    v_mul_f32 v24, s62, v136
    v_mul_f32 v25, s62, v137
    v_mul_f32 v26, s62, v138
    v_mul_f32 v27, s62, v139
    v_mul_f32 v28, s62, v140
    v_mul_f32 v29, s62, v141
    v_mul_f32 v30, s62, v142
    v_mul_f32 v31, s62, v143
    v_mul_f32 v32, s62, v144
    v_mul_f32 v33, s62, v145
    v_mul_f32 v34, s62, v146
    v_mul_f32 v35, s62, v147
    v_mul_f32 v36, s62, v148
    v_mul_f32 v37, s62, v149
    v_mul_f32 v38, s62, v150
    v_mul_f32 v39, s62, v151
    v_mul_f32 v40, s62, v152
    v_mul_f32 v41, s62, v153
    v_mul_f32 v42, s62, v154
    v_mul_f32 v43, s62, v155
    v_mul_f32 v44, s62, v156
    v_mul_f32 v45, s62, v157
    v_mul_f32 v46, s62, v158
    v_mul_f32 v47, s62, v159
    v_mul_f32 v48, s62, v160
    v_mul_f32 v49, s62, v161
    v_mul_f32 v50, s62, v162
    v_mul_f32 v51, s62, v163
    v_mul_f32 v52, s62, v164
    v_mul_f32 v53, s62, v165
    v_mul_f32 v54, s62, v166
    v_mul_f32 v55, s62, v167
    v_mul_f32 v56, s62, v168
    v_mul_f32 v57, s62, v169
    v_mul_f32 v58, s62, v170
    v_mul_f32 v59, s62, v171
    v_mul_f32 v60, s62, v172
    v_mul_f32 v61, s62, v173
    v_mul_f32 v62, s62, v174
    v_mul_f32 v63, s62, v175
    v_mul_f32 v64, s62, v176
    v_mul_f32 v65, s62, v177
    v_mul_f32 v66, s62, v178
    v_mul_f32 v67, s62, v179
    v_mul_f32 v68, s62, v180
    v_mul_f32 v69, s62, v181
    v_mul_f32 v70, s62, v182
    v_mul_f32 v71, s62, v183
    v_mul_f32 v72, s62, v184
    v_mul_f32 v73, s62, v185
    v_mul_f32 v74, s62, v186
    v_mul_f32 v75, s62, v187
    v_mul_f32 v76, s62, v188
    v_mul_f32 v77, s62, v189
    v_mul_f32 v78, s62, v190
    v_mul_f32 v79, s62, v191
    v_min_f32 v16, 0, v16
    v_min_f32 v17, 0, v17
    v_min_f32 v18, 0, v18
    v_min_f32 v19, 0, v19
    v_min_f32 v20, 0, v20
    v_min_f32 v21, 0, v21
    v_min_f32 v22, 0, v22
    v_min_f32 v23, 0, v23
    v_min_f32 v24, 0, v24
    v_min_f32 v25, 0, v25
    v_min_f32 v26, 0, v26
    v_min_f32 v27, 0, v27
    v_min_f32 v28, 0, v28
    v_min_f32 v29, 0, v29
    v_min_f32 v30, 0, v30
    v_min_f32 v31, 0, v31
    v_min_f32 v32, 0, v32
    v_min_f32 v33, 0, v33
    v_min_f32 v34, 0, v34
    v_min_f32 v35, 0, v35
    v_min_f32 v36, 0, v36
    v_min_f32 v37, 0, v37
    v_min_f32 v38, 0, v38
    v_min_f32 v39, 0, v39
    v_min_f32 v40, 0, v40
    v_min_f32 v41, 0, v41
    v_min_f32 v42, 0, v42
    v_min_f32 v43, 0, v43
    v_min_f32 v44, 0, v44
    v_min_f32 v45, 0, v45
    v_min_f32 v46, 0, v46
    v_min_f32 v47, 0, v47
    v_min_f32 v48, 0, v48
    v_min_f32 v49, 0, v49
    v_min_f32 v50, 0, v50
    v_min_f32 v51, 0, v51
    v_min_f32 v52, 0, v52
    v_min_f32 v53, 0, v53
    v_min_f32 v54, 0, v54
    v_min_f32 v55, 0, v55
    v_min_f32 v56, 0, v56
    v_min_f32 v57, 0, v57
    v_min_f32 v58, 0, v58
    v_min_f32 v59, 0, v59
    v_min_f32 v60, 0, v60
    v_min_f32 v61, 0, v61
    v_min_f32 v62, 0, v62
    v_min_f32 v63, 0, v63
    v_min_f32 v64, 0, v64
    v_min_f32 v65, 0, v65
    v_min_f32 v66, 0, v66
    v_min_f32 v67, 0, v67
    v_min_f32 v68, 0, v68
    v_min_f32 v69, 0, v69
    v_min_f32 v70, 0, v70
    v_min_f32 v71, 0, v71
    v_min_f32 v72, 0, v72
    v_min_f32 v73, 0, v73
    v_min_f32 v74, 0, v74
    v_min_f32 v75, 0, v75
    v_min_f32 v76, 0, v76
    v_min_f32 v77, 0, v77
    v_min_f32 v78, 0, v78
    v_min_f32 v79, 0, v79
    v_exp_f32 v16, v16
    v_exp_f32 v17, v17
    v_exp_f32 v18, v18
    v_exp_f32 v19, v19
    v_exp_f32 v20, v20
    v_exp_f32 v21, v21
    v_exp_f32 v22, v22
    v_exp_f32 v23, v23
    v_exp_f32 v24, v24
    v_exp_f32 v25, v25
    v_exp_f32 v26, v26
    v_exp_f32 v27, v27
    v_exp_f32 v28, v28
    v_exp_f32 v29, v29
    v_exp_f32 v30, v30
    v_exp_f32 v31, v31
    v_exp_f32 v32, v32
    v_exp_f32 v33, v33
    v_exp_f32 v34, v34
    v_exp_f32 v35, v35
    v_exp_f32 v36, v36
    v_exp_f32 v37, v37
    v_exp_f32 v38, v38
    v_exp_f32 v39, v39
    v_exp_f32 v40, v40
    v_exp_f32 v41, v41
    v_exp_f32 v42, v42
    v_exp_f32 v43, v43
    v_exp_f32 v44, v44
    v_exp_f32 v45, v45
    v_exp_f32 v46, v46
    v_exp_f32 v47, v47
    v_exp_f32 v48, v48
    v_exp_f32 v49, v49
    v_exp_f32 v50, v50
    v_exp_f32 v51, v51
    v_exp_f32 v52, v52
    v_exp_f32 v53, v53
    v_exp_f32 v54, v54
    v_exp_f32 v55, v55
    v_exp_f32 v56, v56
    v_exp_f32 v57, v57
    v_exp_f32 v58, v58
    v_exp_f32 v59, v59
    v_exp_f32 v60, v60
    v_exp_f32 v61, v61
    v_exp_f32 v62, v62
    v_exp_f32 v63, v63
    v_exp_f32 v64, v64
    v_exp_f32 v65, v65
    v_exp_f32 v66, v66
    v_exp_f32 v67, v67
    v_exp_f32 v68, v68
    v_exp_f32 v69, v69
    v_exp_f32 v70, v70
    v_exp_f32 v71, v71
    v_exp_f32 v72, v72
    v_exp_f32 v73, v73
    v_exp_f32 v74, v74
    v_exp_f32 v75, v75
    v_exp_f32 v76, v76
    v_exp_f32 v77, v77
    v_exp_f32 v78, v78
    v_exp_f32 v79, v79
    v_max_f32 v128, 0, v128
    v_max_f32 v129, 0, v129
    v_max_f32 v130, 0, v130
    v_max_f32 v131, 0, v131
    v_max_f32 v132, 0, v132
    v_max_f32 v133, 0, v133
    v_max_f32 v134, 0, v134
    v_max_f32 v135, 0, v135
    v_max_f32 v136, 0, v136
    v_max_f32 v137, 0, v137
    v_max_f32 v138, 0, v138
    v_max_f32 v139, 0, v139
    v_max_f32 v140, 0, v140
    v_max_f32 v141, 0, v141
    v_max_f32 v142, 0, v142
    v_max_f32 v143, 0, v143
    v_max_f32 v144, 0, v144
    v_max_f32 v145, 0, v145
    v_max_f32 v146, 0, v146
    v_max_f32 v147, 0, v147
    v_max_f32 v148, 0, v148
    v_max_f32 v149, 0, v149
    v_max_f32 v150, 0, v150
    v_max_f32 v151, 0, v151
    v_max_f32 v152, 0, v152
    v_max_f32 v153, 0, v153
    v_max_f32 v154, 0, v154
    v_max_f32 v155, 0, v155
    v_max_f32 v156, 0, v156
    v_max_f32 v157, 0, v157
    v_max_f32 v158, 0, v158
    v_max_f32 v159, 0, v159
    v_max_f32 v160, 0, v160
    v_max_f32 v161, 0, v161
    v_max_f32 v162, 0, v162
    v_max_f32 v163, 0, v163
    v_max_f32 v164, 0, v164
    v_max_f32 v165, 0, v165
    v_max_f32 v166, 0, v166
    v_max_f32 v167, 0, v167
    v_max_f32 v168, 0, v168
    v_max_f32 v169, 0, v169
    v_max_f32 v170, 0, v170
    v_max_f32 v171, 0, v171
    v_max_f32 v172, 0, v172
    v_max_f32 v173, 0, v173
    v_max_f32 v174, 0, v174
    v_max_f32 v175, 0, v175
    v_max_f32 v176, 0, v176
    v_max_f32 v177, 0, v177
    v_max_f32 v178, 0, v178
    v_max_f32 v179, 0, v179
    v_max_f32 v180, 0, v180
    v_max_f32 v181, 0, v181
    v_max_f32 v182, 0, v182
    v_max_f32 v183, 0, v183
    v_max_f32 v184, 0, v184
    v_max_f32 v185, 0, v185
    v_max_f32 v186, 0, v186
    v_max_f32 v187, 0, v187
    v_max_f32 v188, 0, v188
    v_max_f32 v189, 0, v189
    v_max_f32 v190, 0, v190
    v_max_f32 v191, 0, v191
    v_add_f32 v128, v128, v16
    v_add_f32 v129, v129, v17
    v_add_f32 v130, v130, v18
    v_add_f32 v131, v131, v19
    v_add_f32 v132, v132, v20
    v_add_f32 v133, v133, v21
    v_add_f32 v134, v134, v22
    v_add_f32 v135, v135, v23
    v_add_f32 v136, v136, v24
    v_add_f32 v137, v137, v25
    v_add_f32 v138, v138, v26
    v_add_f32 v139, v139, v27
    v_add_f32 v140, v140, v28
    v_add_f32 v141, v141, v29
    v_add_f32 v142, v142, v30
    v_add_f32 v143, v143, v31
    v_add_f32 v144, v144, v32
    v_add_f32 v145, v145, v33
    v_add_f32 v146, v146, v34
    v_add_f32 v147, v147, v35
    v_add_f32 v148, v148, v36
    v_add_f32 v149, v149, v37
    v_add_f32 v150, v150, v38
    v_add_f32 v151, v151, v39
    v_add_f32 v152, v152, v40
    v_add_f32 v153, v153, v41
    v_add_f32 v154, v154, v42
    v_add_f32 v155, v155, v43
    v_add_f32 v156, v156, v44
    v_add_f32 v157, v157, v45
    v_add_f32 v158, v158, v46
    v_add_f32 v159, v159, v47
    v_add_f32 v160, v160, v48
    v_add_f32 v161, v161, v49
    v_add_f32 v162, v162, v50
    v_add_f32 v163, v163, v51
    v_add_f32 v164, v164, v52
    v_add_f32 v165, v165, v53
    v_add_f32 v166, v166, v54
    v_add_f32 v167, v167, v55
    v_add_f32 v168, v168, v56
    v_add_f32 v169, v169, v57
    v_add_f32 v170, v170, v58
    v_add_f32 v171, v171, v59
    v_add_f32 v172, v172, v60
    v_add_f32 v173, v173, v61
    v_add_f32 v174, v174, v62
    v_add_f32 v175, v175, v63
    v_add_f32 v176, v176, v64
    v_add_f32 v177, v177, v65
    v_add_f32 v178, v178, v66
    v_add_f32 v179, v179, v67
    v_add_f32 v180, v180, v68
    v_add_f32 v181, v181, v69
    v_add_f32 v182, v182, v70
    v_add_f32 v183, v183, v71
    v_add_f32 v184, v184, v72
    v_add_f32 v185, v185, v73
    v_add_f32 v186, v186, v74
    v_add_f32 v187, v187, v75
    v_add_f32 v188, v188, v76
    v_add_f32 v189, v189, v77
    v_add_f32 v190, v190, v78
    v_add_f32 v191, v191, v79
    v_add_f32 v128, s63, v128
    v_add_f32 v129, s63, v129
    v_add_f32 v130, s63, v130
    v_add_f32 v131, s63, v131
    v_add_f32 v132, s63, v132
    v_add_f32 v133, s63, v133
    v_add_f32 v134, s63, v134
    v_add_f32 v135, s63, v135
    v_add_f32 v136, s63, v136
    v_add_f32 v137, s63, v137
    v_add_f32 v138, s63, v138
    v_add_f32 v139, s63, v139
    v_add_f32 v140, s63, v140
    v_add_f32 v141, s63, v141
    v_add_f32 v142, s63, v142
    v_add_f32 v143, s63, v143
    v_add_f32 v144, s63, v144
    v_add_f32 v145, s63, v145
    v_add_f32 v146, s63, v146
    v_add_f32 v147, s63, v147
    v_add_f32 v148, s63, v148
    v_add_f32 v149, s63, v149
    v_add_f32 v150, s63, v150
    v_add_f32 v151, s63, v151
    v_add_f32 v152, s63, v152
    v_add_f32 v153, s63, v153
    v_add_f32 v154, s63, v154
    v_add_f32 v155, s63, v155
    v_add_f32 v156, s63, v156
    v_add_f32 v157, s63, v157
    v_add_f32 v158, s63, v158
    v_add_f32 v159, s63, v159
    v_add_f32 v160, s63, v160
    v_add_f32 v161, s63, v161
    v_add_f32 v162, s63, v162
    v_add_f32 v163, s63, v163
    v_add_f32 v164, s63, v164
    v_add_f32 v165, s63, v165
    v_add_f32 v166, s63, v166
    v_add_f32 v167, s63, v167
    v_add_f32 v168, s63, v168
    v_add_f32 v169, s63, v169
    v_add_f32 v170, s63, v170
    v_add_f32 v171, s63, v171
    v_add_f32 v172, s63, v172
    v_add_f32 v173, s63, v173
    v_add_f32 v174, s63, v174
    v_add_f32 v175, s63, v175
    v_add_f32 v176, s63, v176
    v_add_f32 v177, s63, v177
    v_add_f32 v178, s63, v178
    v_add_f32 v179, s63, v179
    v_add_f32 v180, s63, v180
    v_add_f32 v181, s63, v181
    v_add_f32 v182, s63, v182
    v_add_f32 v183, s63, v183
    v_add_f32 v184, s63, v184
    v_add_f32 v185, s63, v185
    v_add_f32 v186, s63, v186
    v_add_f32 v187, s63, v187
    v_add_f32 v188, s63, v188
    v_add_f32 v189, s63, v189
    v_add_f32 v190, s63, v190
    v_add_f32 v191, s63, v191
    v_mul_f32 v16, s62, v192
    v_mul_f32 v17, s62, v193
    v_mul_f32 v18, s62, v194
    v_mul_f32 v19, s62, v195
    v_mul_f32 v20, s62, v196
    v_mul_f32 v21, s62, v197
    v_mul_f32 v22, s62, v198
    v_mul_f32 v23, s62, v199
    v_mul_f32 v24, s62, v200
    v_mul_f32 v25, s62, v201
    v_mul_f32 v26, s62, v202
    v_mul_f32 v27, s62, v203
    v_mul_f32 v28, s62, v204
    v_mul_f32 v29, s62, v205
    v_mul_f32 v30, s62, v206
    v_mul_f32 v31, s62, v207
    v_mul_f32 v32, s62, v208
    v_mul_f32 v33, s62, v209
    v_mul_f32 v34, s62, v210
    v_mul_f32 v35, s62, v211
    v_mul_f32 v36, s62, v212
    v_mul_f32 v37, s62, v213
    v_mul_f32 v38, s62, v214
    v_mul_f32 v39, s62, v215
    v_mul_f32 v40, s62, v216
    v_mul_f32 v41, s62, v217
    v_mul_f32 v42, s62, v218
    v_mul_f32 v43, s62, v219
    v_mul_f32 v44, s62, v220
    v_mul_f32 v45, s62, v221
    v_mul_f32 v46, s62, v222
    v_mul_f32 v47, s62, v223
    v_mul_f32 v48, s62, v224
    v_mul_f32 v49, s62, v225
    v_mul_f32 v50, s62, v226
    v_mul_f32 v51, s62, v227
    v_mul_f32 v52, s62, v228
    v_mul_f32 v53, s62, v229
    v_mul_f32 v54, s62, v230
    v_mul_f32 v55, s62, v231
    v_mul_f32 v56, s62, v232
    v_mul_f32 v57, s62, v233
    v_mul_f32 v58, s62, v234
    v_mul_f32 v59, s62, v235
    v_mul_f32 v60, s62, v236
    v_mul_f32 v61, s62, v237
    v_mul_f32 v62, s62, v238
    v_mul_f32 v63, s62, v239
    v_mul_f32 v64, s62, v240
    v_mul_f32 v65, s62, v241
    v_mul_f32 v66, s62, v242
    v_mul_f32 v67, s62, v243
    v_mul_f32 v68, s62, v244
    v_mul_f32 v69, s62, v245
    v_mul_f32 v70, s62, v246
    v_mul_f32 v71, s62, v247
    v_mul_f32 v72, s62, v248
    v_mul_f32 v73, s62, v249
    v_mul_f32 v74, s62, v250
    v_mul_f32 v75, s62, v251
    v_mul_f32 v76, s62, v252
    v_mul_f32 v77, s62, v253
    v_mul_f32 v78, s62, v254
    v_mul_f32 v79, s62, v255
    v_min_f32 v16, 0, v16
    v_min_f32 v17, 0, v17
    v_min_f32 v18, 0, v18
    v_min_f32 v19, 0, v19
    v_min_f32 v20, 0, v20
    v_min_f32 v21, 0, v21
    v_min_f32 v22, 0, v22
    v_min_f32 v23, 0, v23
    v_min_f32 v24, 0, v24
    v_min_f32 v25, 0, v25
    v_min_f32 v26, 0, v26
    v_min_f32 v27, 0, v27
    v_min_f32 v28, 0, v28
    v_min_f32 v29, 0, v29
    v_min_f32 v30, 0, v30
    v_min_f32 v31, 0, v31
    v_min_f32 v32, 0, v32
    v_min_f32 v33, 0, v33
    v_min_f32 v34, 0, v34
    v_min_f32 v35, 0, v35
    v_min_f32 v36, 0, v36
    v_min_f32 v37, 0, v37
    v_min_f32 v38, 0, v38
    v_min_f32 v39, 0, v39
    v_min_f32 v40, 0, v40
    v_min_f32 v41, 0, v41
    v_min_f32 v42, 0, v42
    v_min_f32 v43, 0, v43
    v_min_f32 v44, 0, v44
    v_min_f32 v45, 0, v45
    v_min_f32 v46, 0, v46
    v_min_f32 v47, 0, v47
    v_min_f32 v48, 0, v48
    v_min_f32 v49, 0, v49
    v_min_f32 v50, 0, v50
    v_min_f32 v51, 0, v51
    v_min_f32 v52, 0, v52
    v_min_f32 v53, 0, v53
    v_min_f32 v54, 0, v54
    v_min_f32 v55, 0, v55
    v_min_f32 v56, 0, v56
    v_min_f32 v57, 0, v57
    v_min_f32 v58, 0, v58
    v_min_f32 v59, 0, v59
    v_min_f32 v60, 0, v60
    v_min_f32 v61, 0, v61
    v_min_f32 v62, 0, v62
    v_min_f32 v63, 0, v63
    v_min_f32 v64, 0, v64
    v_min_f32 v65, 0, v65
    v_min_f32 v66, 0, v66
    v_min_f32 v67, 0, v67
    v_min_f32 v68, 0, v68
    v_min_f32 v69, 0, v69
    v_min_f32 v70, 0, v70
    v_min_f32 v71, 0, v71
    v_min_f32 v72, 0, v72
    v_min_f32 v73, 0, v73
    v_min_f32 v74, 0, v74
    v_min_f32 v75, 0, v75
    v_min_f32 v76, 0, v76
    v_min_f32 v77, 0, v77
    v_min_f32 v78, 0, v78
    v_min_f32 v79, 0, v79
    v_exp_f32 v16, v16
    v_exp_f32 v17, v17
    v_exp_f32 v18, v18
    v_exp_f32 v19, v19
    v_exp_f32 v20, v20
    v_exp_f32 v21, v21
    v_exp_f32 v22, v22
    v_exp_f32 v23, v23
    v_exp_f32 v24, v24
    v_exp_f32 v25, v25
    v_exp_f32 v26, v26
    v_exp_f32 v27, v27
    v_exp_f32 v28, v28
    v_exp_f32 v29, v29
    v_exp_f32 v30, v30
    v_exp_f32 v31, v31
    v_exp_f32 v32, v32
    v_exp_f32 v33, v33
    v_exp_f32 v34, v34
    v_exp_f32 v35, v35
    v_exp_f32 v36, v36
    v_exp_f32 v37, v37
    v_exp_f32 v38, v38
    v_exp_f32 v39, v39
    v_exp_f32 v40, v40
    v_exp_f32 v41, v41
    v_exp_f32 v42, v42
    v_exp_f32 v43, v43
    v_exp_f32 v44, v44
    v_exp_f32 v45, v45
    v_exp_f32 v46, v46
    v_exp_f32 v47, v47
    v_exp_f32 v48, v48
    v_exp_f32 v49, v49
    v_exp_f32 v50, v50
    v_exp_f32 v51, v51
    v_exp_f32 v52, v52
    v_exp_f32 v53, v53
    v_exp_f32 v54, v54
    v_exp_f32 v55, v55
    v_exp_f32 v56, v56
    v_exp_f32 v57, v57
    v_exp_f32 v58, v58
    v_exp_f32 v59, v59
    v_exp_f32 v60, v60
    v_exp_f32 v61, v61
    v_exp_f32 v62, v62
    v_exp_f32 v63, v63
    v_exp_f32 v64, v64
    v_exp_f32 v65, v65
    v_exp_f32 v66, v66
    v_exp_f32 v67, v67
    v_exp_f32 v68, v68
    v_exp_f32 v69, v69
    v_exp_f32 v70, v70
    v_exp_f32 v71, v71
    v_exp_f32 v72, v72
    v_exp_f32 v73, v73
    v_exp_f32 v74, v74
    v_exp_f32 v75, v75
    v_exp_f32 v76, v76
    v_exp_f32 v77, v77
    v_exp_f32 v78, v78
    v_exp_f32 v79, v79
    v_max_f32 v192, 0, v192
    v_max_f32 v193, 0, v193
    v_max_f32 v194, 0, v194
    v_max_f32 v195, 0, v195
    v_max_f32 v196, 0, v196
    v_max_f32 v197, 0, v197
    v_max_f32 v198, 0, v198
    v_max_f32 v199, 0, v199
    v_max_f32 v200, 0, v200
    v_max_f32 v201, 0, v201
    v_max_f32 v202, 0, v202
    v_max_f32 v203, 0, v203
    v_max_f32 v204, 0, v204
    v_max_f32 v205, 0, v205
    v_max_f32 v206, 0, v206
    v_max_f32 v207, 0, v207
    v_max_f32 v208, 0, v208
    v_max_f32 v209, 0, v209
    v_max_f32 v210, 0, v210
    v_max_f32 v211, 0, v211
    v_max_f32 v212, 0, v212
    v_max_f32 v213, 0, v213
    v_max_f32 v214, 0, v214
    v_max_f32 v215, 0, v215
    v_max_f32 v216, 0, v216
    v_max_f32 v217, 0, v217
    v_max_f32 v218, 0, v218
    v_max_f32 v219, 0, v219
    v_max_f32 v220, 0, v220
    v_max_f32 v221, 0, v221
    v_max_f32 v222, 0, v222
    v_max_f32 v223, 0, v223
    v_max_f32 v224, 0, v224
    v_max_f32 v225, 0, v225
    v_max_f32 v226, 0, v226
    v_max_f32 v227, 0, v227
    v_max_f32 v228, 0, v228
    v_max_f32 v229, 0, v229
    v_max_f32 v230, 0, v230
    v_max_f32 v231, 0, v231
    v_max_f32 v232, 0, v232
    v_max_f32 v233, 0, v233
    v_max_f32 v234, 0, v234
    v_max_f32 v235, 0, v235
    v_max_f32 v236, 0, v236
    v_max_f32 v237, 0, v237
    v_max_f32 v238, 0, v238
    v_max_f32 v239, 0, v239
    v_max_f32 v240, 0, v240
    v_max_f32 v241, 0, v241
    v_max_f32 v242, 0, v242
    v_max_f32 v243, 0, v243
    v_max_f32 v244, 0, v244
    v_max_f32 v245, 0, v245
    v_max_f32 v246, 0, v246
    v_max_f32 v247, 0, v247
    v_max_f32 v248, 0, v248
    v_max_f32 v249, 0, v249
    v_max_f32 v250, 0, v250
    v_max_f32 v251, 0, v251
    v_max_f32 v252, 0, v252
    v_max_f32 v253, 0, v253
    v_max_f32 v254, 0, v254
    v_max_f32 v255, 0, v255
    v_add_f32 v192, v192, v16
    v_add_f32 v193, v193, v17
    v_add_f32 v194, v194, v18
    v_add_f32 v195, v195, v19
    v_add_f32 v196, v196, v20
    v_add_f32 v197, v197, v21
    v_add_f32 v198, v198, v22
    v_add_f32 v199, v199, v23
    v_add_f32 v200, v200, v24
    v_add_f32 v201, v201, v25
    v_add_f32 v202, v202, v26
    v_add_f32 v203, v203, v27
    v_add_f32 v204, v204, v28
    v_add_f32 v205, v205, v29
    v_add_f32 v206, v206, v30
    v_add_f32 v207, v207, v31
    v_add_f32 v208, v208, v32
    v_add_f32 v209, v209, v33
    v_add_f32 v210, v210, v34
    v_add_f32 v211, v211, v35
    v_add_f32 v212, v212, v36
    v_add_f32 v213, v213, v37
    v_add_f32 v214, v214, v38
    v_add_f32 v215, v215, v39
    v_add_f32 v216, v216, v40
    v_add_f32 v217, v217, v41
    v_add_f32 v218, v218, v42
    v_add_f32 v219, v219, v43
    v_add_f32 v220, v220, v44
    v_add_f32 v221, v221, v45
    v_add_f32 v222, v222, v46
    v_add_f32 v223, v223, v47
    v_add_f32 v224, v224, v48
    v_add_f32 v225, v225, v49
    v_add_f32 v226, v226, v50
    v_add_f32 v227, v227, v51
    v_add_f32 v228, v228, v52
    v_add_f32 v229, v229, v53
    v_add_f32 v230, v230, v54
    v_add_f32 v231, v231, v55
    v_add_f32 v232, v232, v56
    v_add_f32 v233, v233, v57
    v_add_f32 v234, v234, v58
    v_add_f32 v235, v235, v59
    v_add_f32 v236, v236, v60
    v_add_f32 v237, v237, v61
    v_add_f32 v238, v238, v62
    v_add_f32 v239, v239, v63
    v_add_f32 v240, v240, v64
    v_add_f32 v241, v241, v65
    v_add_f32 v242, v242, v66
    v_add_f32 v243, v243, v67
    v_add_f32 v244, v244, v68
    v_add_f32 v245, v245, v69
    v_add_f32 v246, v246, v70
    v_add_f32 v247, v247, v71
    v_add_f32 v248, v248, v72
    v_add_f32 v249, v249, v73
    v_add_f32 v250, v250, v74
    v_add_f32 v251, v251, v75
    v_add_f32 v252, v252, v76
    v_add_f32 v253, v253, v77
    v_add_f32 v254, v254, v78
    v_add_f32 v255, v255, v79
    v_add_f32 v192, s63, v192
    v_add_f32 v193, s63, v193
    v_add_f32 v194, s63, v194
    v_add_f32 v195, s63, v195
    v_add_f32 v196, s63, v196
    v_add_f32 v197, s63, v197
    v_add_f32 v198, s63, v198
    v_add_f32 v199, s63, v199
    v_add_f32 v200, s63, v200
    v_add_f32 v201, s63, v201
    v_add_f32 v202, s63, v202
    v_add_f32 v203, s63, v203
    v_add_f32 v204, s63, v204
    v_add_f32 v205, s63, v205
    v_add_f32 v206, s63, v206
    v_add_f32 v207, s63, v207
    v_add_f32 v208, s63, v208
    v_add_f32 v209, s63, v209
    v_add_f32 v210, s63, v210
    v_add_f32 v211, s63, v211
    v_add_f32 v212, s63, v212
    v_add_f32 v213, s63, v213
    v_add_f32 v214, s63, v214
    v_add_f32 v215, s63, v215
    v_add_f32 v216, s63, v216
    v_add_f32 v217, s63, v217
    v_add_f32 v218, s63, v218
    v_add_f32 v219, s63, v219
    v_add_f32 v220, s63, v220
    v_add_f32 v221, s63, v221
    v_add_f32 v222, s63, v222
    v_add_f32 v223, s63, v223
    v_add_f32 v224, s63, v224
    v_add_f32 v225, s63, v225
    v_add_f32 v226, s63, v226
    v_add_f32 v227, s63, v227
    v_add_f32 v228, s63, v228
    v_add_f32 v229, s63, v229
    v_add_f32 v230, s63, v230
    v_add_f32 v231, s63, v231
    v_add_f32 v232, s63, v232
    v_add_f32 v233, s63, v233
    v_add_f32 v234, s63, v234
    v_add_f32 v235, s63, v235
    v_add_f32 v236, s63, v236
    v_add_f32 v237, s63, v237
    v_add_f32 v238, s63, v238
    v_add_f32 v239, s63, v239
    v_add_f32 v240, s63, v240
    v_add_f32 v241, s63, v241
    v_add_f32 v242, s63, v242
    v_add_f32 v243, s63, v243
    v_add_f32 v244, s63, v244
    v_add_f32 v245, s63, v245
    v_add_f32 v246, s63, v246
    v_add_f32 v247, s63, v247
    v_add_f32 v248, s63, v248
    v_add_f32 v249, s63, v249
    v_add_f32 v250, s63, v250
    v_add_f32 v251, s63, v251
    v_add_f32 v252, s63, v252
    v_add_f32 v253, s63, v253
    v_add_f32 v254, s63, v254
    v_add_f32 v255, s63, v255
    v_cvt_pk_bf16_f32 v128, v128, v129
    v_cvt_pk_bf16_f32 v129, v130, v131
    v_accvgpr_write_b32 a64, v128
    v_accvgpr_write_b32 a65, v129
    v_cvt_pk_bf16_f32 v160, v160, v161
    v_cvt_pk_bf16_f32 v161, v162, v163
    v_accvgpr_write_b32 a66, v160
    v_accvgpr_write_b32 a67, v161
    v_cvt_pk_bf16_f32 v132, v132, v133
    v_cvt_pk_bf16_f32 v133, v134, v135
    v_accvgpr_write_b32 a68, v132
    v_accvgpr_write_b32 a69, v133
    v_cvt_pk_bf16_f32 v164, v164, v165
    v_cvt_pk_bf16_f32 v165, v166, v167
    v_accvgpr_write_b32 a70, v164
    v_accvgpr_write_b32 a71, v165
    v_cvt_pk_bf16_f32 v136, v136, v137
    v_cvt_pk_bf16_f32 v137, v138, v139
    v_accvgpr_write_b32 a72, v136
    v_accvgpr_write_b32 a73, v137
    v_cvt_pk_bf16_f32 v168, v168, v169
    v_cvt_pk_bf16_f32 v169, v170, v171
    v_accvgpr_write_b32 a74, v168
    v_accvgpr_write_b32 a75, v169
    v_cvt_pk_bf16_f32 v140, v140, v141
    v_cvt_pk_bf16_f32 v141, v142, v143
    v_accvgpr_write_b32 a76, v140
    v_accvgpr_write_b32 a77, v141
    v_cvt_pk_bf16_f32 v172, v172, v173
    v_cvt_pk_bf16_f32 v173, v174, v175
    v_accvgpr_write_b32 a78, v172
    v_accvgpr_write_b32 a79, v173
    v_cvt_pk_bf16_f32 v144, v144, v145
    v_cvt_pk_bf16_f32 v145, v146, v147
    v_accvgpr_write_b32 a80, v144
    v_accvgpr_write_b32 a81, v145
    v_cvt_pk_bf16_f32 v176, v176, v177
    v_cvt_pk_bf16_f32 v177, v178, v179
    v_accvgpr_write_b32 a82, v176
    v_accvgpr_write_b32 a83, v177
    v_cvt_pk_bf16_f32 v148, v148, v149
    v_cvt_pk_bf16_f32 v149, v150, v151
    v_accvgpr_write_b32 a84, v148
    v_accvgpr_write_b32 a85, v149
    v_cvt_pk_bf16_f32 v180, v180, v181
    v_cvt_pk_bf16_f32 v181, v182, v183
    v_accvgpr_write_b32 a86, v180
    v_accvgpr_write_b32 a87, v181
    v_cvt_pk_bf16_f32 v152, v152, v153
    v_cvt_pk_bf16_f32 v153, v154, v155
    v_accvgpr_write_b32 a88, v152
    v_accvgpr_write_b32 a89, v153
    v_cvt_pk_bf16_f32 v184, v184, v185
    v_cvt_pk_bf16_f32 v185, v186, v187
    v_accvgpr_write_b32 a90, v184
    v_accvgpr_write_b32 a91, v185
    v_cvt_pk_bf16_f32 v156, v156, v157
    v_cvt_pk_bf16_f32 v157, v158, v159
    v_accvgpr_write_b32 a92, v156
    v_accvgpr_write_b32 a93, v157
    v_cvt_pk_bf16_f32 v188, v188, v189
    v_cvt_pk_bf16_f32 v189, v190, v191
    v_accvgpr_write_b32 a94, v188
    v_accvgpr_write_b32 a95, v189
    v_cvt_pk_bf16_f32 v192, v192, v193
    v_cvt_pk_bf16_f32 v193, v194, v195
    v_accvgpr_write_b32 a96, v192
    v_accvgpr_write_b32 a97, v193
    v_cvt_pk_bf16_f32 v224, v224, v225
    v_cvt_pk_bf16_f32 v225, v226, v227
    v_accvgpr_write_b32 a98, v224
    v_accvgpr_write_b32 a99, v225
    v_cvt_pk_bf16_f32 v196, v196, v197
    v_cvt_pk_bf16_f32 v197, v198, v199
    v_accvgpr_write_b32 a100, v196
    v_accvgpr_write_b32 a101, v197
    v_cvt_pk_bf16_f32 v228, v228, v229
    v_cvt_pk_bf16_f32 v229, v230, v231
    v_accvgpr_write_b32 a102, v228
    v_accvgpr_write_b32 a103, v229
    v_cvt_pk_bf16_f32 v200, v200, v201
    v_cvt_pk_bf16_f32 v201, v202, v203
    v_accvgpr_write_b32 a104, v200
    v_accvgpr_write_b32 a105, v201
    v_cvt_pk_bf16_f32 v232, v232, v233
    v_cvt_pk_bf16_f32 v233, v234, v235
    v_accvgpr_write_b32 a106, v232
    v_accvgpr_write_b32 a107, v233
    v_cvt_pk_bf16_f32 v204, v204, v205
    v_cvt_pk_bf16_f32 v205, v206, v207
    v_accvgpr_write_b32 a108, v204
    v_accvgpr_write_b32 a109, v205
    v_cvt_pk_bf16_f32 v236, v236, v237
    v_cvt_pk_bf16_f32 v237, v238, v239
    v_accvgpr_write_b32 a110, v236
    v_accvgpr_write_b32 a111, v237
    v_cvt_pk_bf16_f32 v208, v208, v209
    v_cvt_pk_bf16_f32 v209, v210, v211
    v_accvgpr_write_b32 a112, v208
    v_accvgpr_write_b32 a113, v209
    v_cvt_pk_bf16_f32 v240, v240, v241
    v_cvt_pk_bf16_f32 v241, v242, v243
    v_accvgpr_write_b32 a114, v240
    v_accvgpr_write_b32 a115, v241
    v_cvt_pk_bf16_f32 v212, v212, v213
    v_cvt_pk_bf16_f32 v213, v214, v215
    v_accvgpr_write_b32 a116, v212
    v_accvgpr_write_b32 a117, v213
    v_cvt_pk_bf16_f32 v244, v244, v245
    v_cvt_pk_bf16_f32 v245, v246, v247
    v_accvgpr_write_b32 a118, v244
    v_accvgpr_write_b32 a119, v245
    v_cvt_pk_bf16_f32 v216, v216, v217
    v_cvt_pk_bf16_f32 v217, v218, v219
    v_accvgpr_write_b32 a120, v216
    v_accvgpr_write_b32 a121, v217
    v_cvt_pk_bf16_f32 v248, v248, v249
    v_cvt_pk_bf16_f32 v249, v250, v251
    v_accvgpr_write_b32 a122, v248
    v_accvgpr_write_b32 a123, v249
    v_cvt_pk_bf16_f32 v220, v220, v221
    v_cvt_pk_bf16_f32 v221, v222, v223
    v_accvgpr_write_b32 a124, v220
    v_accvgpr_write_b32 a125, v221
    v_cvt_pk_bf16_f32 v252, v252, v253
    v_cvt_pk_bf16_f32 v253, v254, v255
    v_accvgpr_write_b32 a126, v252
    v_accvgpr_write_b32 a127, v253
    v_mov_b32 v1, 0
    s_mov_b32 s22, 0x4800580
.wc_109:
    buffer_load_dword v2, v1, s[4:7], s22 offen sc1
    s_waitcnt vmcnt(0)
    v_readfirstlane_b32 s23, v2
    s_cmp_ge_u32 s23, 32
    s_cbranch_scc1 .wcg_110
    s_sub_u32 s19, s19, 1
    s_cbranch_scc1 .abort
    s_sleep 4
    s_branch .wc_109
.wcg_110:
    s_barrier
    v_mov_b32 v10, 56
    v_bfe_u32 v1, v0, 4, 2
    v_lshl_add_u32 v10, v1, 6, v10
    v_cmp_gt_u32 vcc, 48, v0
    s_lshl_b32 s22, s8, 15
    v_add_u32 v12, s22, v9
    v_cndmask_b32 v11, 0, -1, vcc
    s_lshl_b32 s22, s8, 14
    s_add_u32 s22, s22, 0x4810000
    buffer_load_dword v128, v8, s[4:7], s22 offen sc1
    buffer_load_dword v129, v8, s[4:7], s22 offen offset:256 sc1
    buffer_load_dword v130, v8, s[4:7], s22 offen offset:512 sc1
    buffer_load_dword v131, v8, s[4:7], s22 offen offset:768 sc1
    buffer_load_dword v132, v8, s[4:7], s22 offen offset:1024 sc1
    buffer_load_dword v133, v8, s[4:7], s22 offen offset:1280 sc1
    buffer_load_dword v134, v8, s[4:7], s22 offen offset:1536 sc1
    buffer_load_dword v135, v8, s[4:7], s22 offen offset:1792 sc1
    buffer_load_dword v136, v8, s[4:7], s22 offen offset:2048 sc1
    buffer_load_dword v137, v8, s[4:7], s22 offen offset:2304 sc1
    buffer_load_dword v138, v8, s[4:7], s22 offen offset:2560 sc1
    buffer_load_dword v139, v8, s[4:7], s22 offen offset:2816 sc1
    buffer_load_dword v140, v8, s[4:7], s22 offen offset:3072 sc1
    buffer_load_dword v141, v8, s[4:7], s22 offen offset:3328 sc1
    buffer_load_dword v142, v8, s[4:7], s22 offen offset:3584 sc1
    buffer_load_dword v143, v8, s[4:7], s22 offen offset:3840 sc1
    buffer_load_dword v144, v10, s[4:7], s22 offen sc1
    buffer_load_dword v145, v10, s[4:7], s22 offen offset:256 sc1
    buffer_load_dword v146, v10, s[4:7], s22 offen offset:512 sc1
    buffer_load_dword v147, v10, s[4:7], s22 offen offset:768 sc1
    buffer_load_dword v148, v10, s[4:7], s22 offen offset:2048 sc1
    buffer_load_dword v149, v10, s[4:7], s22 offen offset:2304 sc1
    buffer_load_dword v150, v10, s[4:7], s22 offen offset:2560 sc1
    buffer_load_dword v151, v10, s[4:7], s22 offen offset:2816 sc1
    s_add_u32 s22, s22, 4096
    buffer_load_dword v152, v8, s[4:7], s22 offen sc1
    buffer_load_dword v153, v8, s[4:7], s22 offen offset:256 sc1
    buffer_load_dword v154, v8, s[4:7], s22 offen offset:512 sc1
    buffer_load_dword v155, v8, s[4:7], s22 offen offset:768 sc1
    buffer_load_dword v156, v8, s[4:7], s22 offen offset:1024 sc1
    buffer_load_dword v157, v8, s[4:7], s22 offen offset:1280 sc1
    buffer_load_dword v158, v8, s[4:7], s22 offen offset:1536 sc1
    buffer_load_dword v159, v8, s[4:7], s22 offen offset:1792 sc1
    buffer_load_dword v160, v8, s[4:7], s22 offen offset:2048 sc1
    buffer_load_dword v161, v8, s[4:7], s22 offen offset:2304 sc1
    buffer_load_dword v162, v8, s[4:7], s22 offen offset:2560 sc1
    buffer_load_dword v163, v8, s[4:7], s22 offen offset:2816 sc1
    buffer_load_dword v164, v8, s[4:7], s22 offen offset:3072 sc1
    buffer_load_dword v165, v8, s[4:7], s22 offen offset:3328 sc1
    buffer_load_dword v166, v8, s[4:7], s22 offen offset:3584 sc1
    buffer_load_dword v167, v8, s[4:7], s22 offen offset:3840 sc1
    buffer_load_dword v168, v10, s[4:7], s22 offen sc1
    buffer_load_dword v169, v10, s[4:7], s22 offen offset:256 sc1
    buffer_load_dword v170, v10, s[4:7], s22 offen offset:512 sc1
    buffer_load_dword v171, v10, s[4:7], s22 offen offset:768 sc1
    buffer_load_dword v172, v10, s[4:7], s22 offen offset:2048 sc1
    buffer_load_dword v173, v10, s[4:7], s22 offen offset:2304 sc1
    buffer_load_dword v174, v10, s[4:7], s22 offen offset:2560 sc1
    buffer_load_dword v175, v10, s[4:7], s22 offen offset:2816 sc1
    s_add_u32 s22, s22, 4096
    s_waitcnt vmcnt(0)
    buffer_load_dword v176, v8, s[4:7], s22 offen sc1
    buffer_load_dword v177, v8, s[4:7], s22 offen offset:256 sc1
    buffer_load_dword v178, v8, s[4:7], s22 offen offset:512 sc1
    buffer_load_dword v179, v8, s[4:7], s22 offen offset:768 sc1
    buffer_load_dword v180, v8, s[4:7], s22 offen offset:1024 sc1
    buffer_load_dword v181, v8, s[4:7], s22 offen offset:1280 sc1
    buffer_load_dword v182, v8, s[4:7], s22 offen offset:1536 sc1
    buffer_load_dword v183, v8, s[4:7], s22 offen offset:1792 sc1
    buffer_load_dword v184, v8, s[4:7], s22 offen offset:2048 sc1
    buffer_load_dword v185, v8, s[4:7], s22 offen offset:2304 sc1
    buffer_load_dword v186, v8, s[4:7], s22 offen offset:2560 sc1
    buffer_load_dword v187, v8, s[4:7], s22 offen offset:2816 sc1
    buffer_load_dword v188, v8, s[4:7], s22 offen offset:3072 sc1
    buffer_load_dword v189, v8, s[4:7], s22 offen offset:3328 sc1
    buffer_load_dword v190, v8, s[4:7], s22 offen offset:3584 sc1
    buffer_load_dword v191, v8, s[4:7], s22 offen offset:3840 sc1
    buffer_load_dword v192, v10, s[4:7], s22 offen sc1
    buffer_load_dword v193, v10, s[4:7], s22 offen offset:256 sc1
    buffer_load_dword v194, v10, s[4:7], s22 offen offset:512 sc1
    buffer_load_dword v195, v10, s[4:7], s22 offen offset:768 sc1
    buffer_load_dword v196, v10, s[4:7], s22 offen offset:2048 sc1
    buffer_load_dword v197, v10, s[4:7], s22 offen offset:2304 sc1
    buffer_load_dword v198, v10, s[4:7], s22 offen offset:2560 sc1
    buffer_load_dword v199, v10, s[4:7], s22 offen offset:2816 sc1
    s_add_u32 s22, s22, 4096
    buffer_load_dword v200, v8, s[4:7], s22 offen sc1
    buffer_load_dword v201, v8, s[4:7], s22 offen offset:256 sc1
    buffer_load_dword v202, v8, s[4:7], s22 offen offset:512 sc1
    buffer_load_dword v203, v8, s[4:7], s22 offen offset:768 sc1
    buffer_load_dword v204, v8, s[4:7], s22 offen offset:1024 sc1
    buffer_load_dword v205, v8, s[4:7], s22 offen offset:1280 sc1
    buffer_load_dword v206, v8, s[4:7], s22 offen offset:1536 sc1
    buffer_load_dword v207, v8, s[4:7], s22 offen offset:1792 sc1
    buffer_load_dword v208, v8, s[4:7], s22 offen offset:2048 sc1
    buffer_load_dword v209, v8, s[4:7], s22 offen offset:2304 sc1
    buffer_load_dword v210, v8, s[4:7], s22 offen offset:2560 sc1
    buffer_load_dword v211, v8, s[4:7], s22 offen offset:2816 sc1
    buffer_load_dword v212, v8, s[4:7], s22 offen offset:3072 sc1
    buffer_load_dword v213, v8, s[4:7], s22 offen offset:3328 sc1
    buffer_load_dword v214, v8, s[4:7], s22 offen offset:3584 sc1
    buffer_load_dword v215, v8, s[4:7], s22 offen offset:3840 sc1
    buffer_load_dword v216, v10, s[4:7], s22 offen sc1
    buffer_load_dword v217, v10, s[4:7], s22 offen offset:256 sc1
    buffer_load_dword v218, v10, s[4:7], s22 offen offset:512 sc1
    buffer_load_dword v219, v10, s[4:7], s22 offen offset:768 sc1
    buffer_load_dword v220, v10, s[4:7], s22 offen offset:2048 sc1
    buffer_load_dword v221, v10, s[4:7], s22 offen offset:2304 sc1
    buffer_load_dword v222, v10, s[4:7], s22 offen offset:2560 sc1
    buffer_load_dword v223, v10, s[4:7], s22 offen offset:2816 sc1
    s_add_u32 s22, s22, 4096
    s_waitcnt vmcnt(0)
    v_cvt_pk_bf16_f32 v80, v128, v129
    v_cvt_pk_bf16_f32 v81, v130, v131
    v_cvt_pk_bf16_f32 v82, v136, v137
    v_cvt_pk_bf16_f32 v83, v138, v139
    v_cvt_pk_bf16_f32 v84, v132, v133
    v_cvt_pk_bf16_f32 v85, v134, v135
    v_cvt_pk_bf16_f32 v86, v140, v141
    v_cvt_pk_bf16_f32 v87, v142, v143
    v_cvt_pk_bf16_f32 v88, v144, v145
    v_cvt_pk_bf16_f32 v89, v146, v147
    v_cvt_pk_bf16_f32 v90, v148, v149
    v_cvt_pk_bf16_f32 v91, v150, v151
    v_cvt_pk_bf16_f32 v92, v152, v153
    v_cvt_pk_bf16_f32 v93, v154, v155
    v_cvt_pk_bf16_f32 v94, v160, v161
    v_cvt_pk_bf16_f32 v95, v162, v163
    v_cvt_pk_bf16_f32 v96, v156, v157
    v_cvt_pk_bf16_f32 v97, v158, v159
    v_cvt_pk_bf16_f32 v98, v164, v165
    v_cvt_pk_bf16_f32 v99, v166, v167
    v_cvt_pk_bf16_f32 v100, v168, v169
    v_cvt_pk_bf16_f32 v101, v170, v171
    v_cvt_pk_bf16_f32 v102, v172, v173
    v_cvt_pk_bf16_f32 v103, v174, v175
    v_cvt_pk_bf16_f32 v104, v176, v177
    v_cvt_pk_bf16_f32 v105, v178, v179
    v_cvt_pk_bf16_f32 v106, v184, v185
    v_cvt_pk_bf16_f32 v107, v186, v187
    v_cvt_pk_bf16_f32 v108, v180, v181
    v_cvt_pk_bf16_f32 v109, v182, v183
    v_cvt_pk_bf16_f32 v110, v188, v189
    v_cvt_pk_bf16_f32 v111, v190, v191
    v_cvt_pk_bf16_f32 v112, v192, v193
    v_cvt_pk_bf16_f32 v113, v194, v195
    v_cvt_pk_bf16_f32 v114, v196, v197
    v_cvt_pk_bf16_f32 v115, v198, v199
    v_cvt_pk_bf16_f32 v116, v200, v201
    v_cvt_pk_bf16_f32 v117, v202, v203
    v_cvt_pk_bf16_f32 v118, v208, v209
    v_cvt_pk_bf16_f32 v119, v210, v211
    v_cvt_pk_bf16_f32 v120, v204, v205
    v_cvt_pk_bf16_f32 v121, v206, v207
    v_cvt_pk_bf16_f32 v122, v212, v213
    v_cvt_pk_bf16_f32 v123, v214, v215
    v_cvt_pk_bf16_f32 v124, v216, v217
    v_cvt_pk_bf16_f32 v125, v218, v219
    v_cvt_pk_bf16_f32 v126, v220, v221
    v_cvt_pk_bf16_f32 v127, v222, v223
    s_nop 1
    v_mfma_f32_16x16x32_bf16 v[128:131], v[80:83], a[0:3], 0
    v_mfma_f32_16x16x32_bf16 v[132:135], v[84:87], a[0:3], 0
    v_mfma_f32_16x16x32_bf16 v[136:139], v[88:91], a[0:3], 0
    v_mfma_f32_16x16x32_bf16 v[140:143], v[80:83], a[4:7], 0
    v_mfma_f32_16x16x32_bf16 v[144:147], v[84:87], a[4:7], 0
    v_mfma_f32_16x16x32_bf16 v[148:151], v[88:91], a[4:7], 0
    v_mfma_f32_16x16x32_bf16 v[152:155], v[80:83], a[8:11], 0
    v_mfma_f32_16x16x32_bf16 v[156:159], v[84:87], a[8:11], 0
    v_mfma_f32_16x16x32_bf16 v[160:163], v[88:91], a[8:11], 0
    v_mfma_f32_16x16x32_bf16 v[164:167], v[80:83], a[12:15], 0
    v_mfma_f32_16x16x32_bf16 v[168:171], v[84:87], a[12:15], 0
    v_mfma_f32_16x16x32_bf16 v[172:175], v[88:91], a[12:15], 0
    v_mfma_f32_16x16x32_bf16 v[176:179], v[80:83], a[16:19], 0
    v_mfma_f32_16x16x32_bf16 v[180:183], v[84:87], a[16:19], 0
    v_mfma_f32_16x16x32_bf16 v[184:187], v[88:91], a[16:19], 0
    v_mfma_f32_16x16x32_bf16 v[188:191], v[80:83], a[20:23], 0
    v_mfma_f32_16x16x32_bf16 v[192:195], v[84:87], a[20:23], 0
    v_mfma_f32_16x16x32_bf16 v[196:199], v[88:91], a[20:23], 0
    v_mfma_f32_16x16x32_bf16 v[200:203], v[80:83], a[24:27], 0
    v_mfma_f32_16x16x32_bf16 v[204:207], v[84:87], a[24:27], 0
    v_mfma_f32_16x16x32_bf16 v[208:211], v[88:91], a[24:27], 0
    v_mfma_f32_16x16x32_bf16 v[212:215], v[80:83], a[28:31], 0
    v_mfma_f32_16x16x32_bf16 v[216:219], v[84:87], a[28:31], 0
    v_mfma_f32_16x16x32_bf16 v[220:223], v[88:91], a[28:31], 0
    s_nop 7
    v_add_f32 v136, s63, v136
    v_rcp_f32 v136, v136
    s_nop 0
    v_mul_f32 v128, v128, v136
    v_mul_f32 v129, v129, v136
    v_mul_f32 v130, v130, v136
    v_mul_f32 v131, v131, v136
    v_mul_f32 v132, v132, v136
    v_mul_f32 v133, v133, v136
    v_mul_f32 v134, v134, v136
    v_mul_f32 v135, v135, v136
    v_cvt_pk_bf16_f32 v128, v128, v129
    v_cvt_pk_bf16_f32 v129, v130, v131
    v_cvt_pk_bf16_f32 v130, v132, v133
    v_cvt_pk_bf16_f32 v131, v134, v135
    v_and_b32 v129, v129, v11
    v_and_b32 v131, v131, v11
    ds_write_b128 v12, v[128:131]
    v_add_f32 v148, s63, v148
    v_rcp_f32 v148, v148
    s_nop 0
    v_mul_f32 v140, v140, v148
    v_mul_f32 v141, v141, v148
    v_mul_f32 v142, v142, v148
    v_mul_f32 v143, v143, v148
    v_mul_f32 v144, v144, v148
    v_mul_f32 v145, v145, v148
    v_mul_f32 v146, v146, v148
    v_mul_f32 v147, v147, v148
    v_cvt_pk_bf16_f32 v140, v140, v141
    v_cvt_pk_bf16_f32 v141, v142, v143
    v_cvt_pk_bf16_f32 v142, v144, v145
    v_cvt_pk_bf16_f32 v143, v146, v147
    v_and_b32 v141, v141, v11
    v_and_b32 v143, v143, v11
    ds_write_b128 v12, v[140:143] offset:1024
    v_add_f32 v160, s63, v160
    v_rcp_f32 v160, v160
    s_nop 0
    v_mul_f32 v152, v152, v160
    v_mul_f32 v153, v153, v160
    v_mul_f32 v154, v154, v160
    v_mul_f32 v155, v155, v160
    v_mul_f32 v156, v156, v160
    v_mul_f32 v157, v157, v160
    v_mul_f32 v158, v158, v160
    v_mul_f32 v159, v159, v160
    v_cvt_pk_bf16_f32 v152, v152, v153
    v_cvt_pk_bf16_f32 v153, v154, v155
    v_cvt_pk_bf16_f32 v154, v156, v157
    v_cvt_pk_bf16_f32 v155, v158, v159
    v_and_b32 v153, v153, v11
    v_and_b32 v155, v155, v11
    ds_write_b128 v12, v[152:155] offset:2048
    v_add_f32 v172, s63, v172
    v_rcp_f32 v172, v172
    s_nop 0
    v_mul_f32 v164, v164, v172
    v_mul_f32 v165, v165, v172
    v_mul_f32 v166, v166, v172
    v_mul_f32 v167, v167, v172
    v_mul_f32 v168, v168, v172
    v_mul_f32 v169, v169, v172
    v_mul_f32 v170, v170, v172
    v_mul_f32 v171, v171, v172
    v_cvt_pk_bf16_f32 v164, v164, v165
    v_cvt_pk_bf16_f32 v165, v166, v167
    v_cvt_pk_bf16_f32 v166, v168, v169
    v_cvt_pk_bf16_f32 v167, v170, v171
    v_and_b32 v165, v165, v11
    v_and_b32 v167, v167, v11
    ds_write_b128 v12, v[164:167] offset:3072
    v_add_f32 v184, s63, v184
    v_rcp_f32 v184, v184
    s_nop 0
    v_mul_f32 v176, v176, v184
    v_mul_f32 v177, v177, v184
    v_mul_f32 v178, v178, v184
    v_mul_f32 v179, v179, v184
    v_mul_f32 v180, v180, v184
    v_mul_f32 v181, v181, v184
    v_mul_f32 v182, v182, v184
    v_mul_f32 v183, v183, v184
    v_cvt_pk_bf16_f32 v176, v176, v177
    v_cvt_pk_bf16_f32 v177, v178, v179
    v_cvt_pk_bf16_f32 v178, v180, v181
    v_cvt_pk_bf16_f32 v179, v182, v183
    v_and_b32 v177, v177, v11
    v_and_b32 v179, v179, v11
    ds_write_b128 v12, v[176:179] offset:4096
    v_add_f32 v196, s63, v196
    v_rcp_f32 v196, v196
    s_nop 0
    v_mul_f32 v188, v188, v196
    v_mul_f32 v189, v189, v196
    v_mul_f32 v190, v190, v196
    v_mul_f32 v191, v191, v196
    v_mul_f32 v192, v192, v196
    v_mul_f32 v193, v193, v196
    v_mul_f32 v194, v194, v196
    v_mul_f32 v195, v195, v196
    v_cvt_pk_bf16_f32 v188, v188, v189
    v_cvt_pk_bf16_f32 v189, v190, v191
    v_cvt_pk_bf16_f32 v190, v192, v193
    v_cvt_pk_bf16_f32 v191, v194, v195
    v_and_b32 v189, v189, v11
    v_and_b32 v191, v191, v11
    ds_write_b128 v12, v[188:191] offset:5120
    v_add_f32 v208, s63, v208
    v_rcp_f32 v208, v208
    s_nop 0
    v_mul_f32 v200, v200, v208
    v_mul_f32 v201, v201, v208
    v_mul_f32 v202, v202, v208
    v_mul_f32 v203, v203, v208
    v_mul_f32 v204, v204, v208
    v_mul_f32 v205, v205, v208
    v_mul_f32 v206, v206, v208
    v_mul_f32 v207, v207, v208
    v_cvt_pk_bf16_f32 v200, v200, v201
    v_cvt_pk_bf16_f32 v201, v202, v203
    v_cvt_pk_bf16_f32 v202, v204, v205
    v_cvt_pk_bf16_f32 v203, v206, v207
    v_and_b32 v201, v201, v11
    v_and_b32 v203, v203, v11
    ds_write_b128 v12, v[200:203] offset:6144
    v_add_f32 v220, s63, v220
    v_rcp_f32 v220, v220
    s_nop 0
    v_mul_f32 v212, v212, v220
    v_mul_f32 v213, v213, v220
    v_mul_f32 v214, v214, v220
    v_mul_f32 v215, v215, v220
    v_mul_f32 v216, v216, v220
    v_mul_f32 v217, v217, v220
    v_mul_f32 v218, v218, v220
    v_mul_f32 v219, v219, v220
    v_cvt_pk_bf16_f32 v212, v212, v213
    v_cvt_pk_bf16_f32 v213, v214, v215
    v_cvt_pk_bf16_f32 v214, v216, v217
    v_cvt_pk_bf16_f32 v215, v218, v219
    v_and_b32 v213, v213, v11
    v_and_b32 v215, v215, v11
    ds_write_b128 v12, v[212:215] offset:7168
    s_waitcnt lgkmcnt(0)
    v_mfma_f32_16x16x32_bf16 v[128:131], v[92:95], a[32:35], 0
    v_mfma_f32_16x16x32_bf16 v[132:135], v[96:99], a[32:35], 0
    v_mfma_f32_16x16x32_bf16 v[136:139], v[100:103], a[32:35], 0
    v_mfma_f32_16x16x32_bf16 v[140:143], v[92:95], a[36:39], 0
    v_mfma_f32_16x16x32_bf16 v[144:147], v[96:99], a[36:39], 0
    v_mfma_f32_16x16x32_bf16 v[148:151], v[100:103], a[36:39], 0
    v_mfma_f32_16x16x32_bf16 v[152:155], v[92:95], a[40:43], 0
    v_mfma_f32_16x16x32_bf16 v[156:159], v[96:99], a[40:43], 0
    v_mfma_f32_16x16x32_bf16 v[160:163], v[100:103], a[40:43], 0
    v_mfma_f32_16x16x32_bf16 v[164:167], v[92:95], a[44:47], 0
    v_mfma_f32_16x16x32_bf16 v[168:171], v[96:99], a[44:47], 0
    v_mfma_f32_16x16x32_bf16 v[172:175], v[100:103], a[44:47], 0
    v_mfma_f32_16x16x32_bf16 v[176:179], v[92:95], a[48:51], 0
    v_mfma_f32_16x16x32_bf16 v[180:183], v[96:99], a[48:51], 0
    v_mfma_f32_16x16x32_bf16 v[184:187], v[100:103], a[48:51], 0
    v_mfma_f32_16x16x32_bf16 v[188:191], v[92:95], a[52:55], 0
    v_mfma_f32_16x16x32_bf16 v[192:195], v[96:99], a[52:55], 0
    v_mfma_f32_16x16x32_bf16 v[196:199], v[100:103], a[52:55], 0
    v_mfma_f32_16x16x32_bf16 v[200:203], v[92:95], a[56:59], 0
    v_mfma_f32_16x16x32_bf16 v[204:207], v[96:99], a[56:59], 0
    v_mfma_f32_16x16x32_bf16 v[208:211], v[100:103], a[56:59], 0
    v_mfma_f32_16x16x32_bf16 v[212:215], v[92:95], a[60:63], 0
    v_mfma_f32_16x16x32_bf16 v[216:219], v[96:99], a[60:63], 0
    v_mfma_f32_16x16x32_bf16 v[220:223], v[100:103], a[60:63], 0
    s_nop 7
    v_add_f32 v136, s63, v136
    v_rcp_f32 v136, v136
    s_nop 0
    v_mul_f32 v128, v128, v136
    v_mul_f32 v129, v129, v136
    v_mul_f32 v130, v130, v136
    v_mul_f32 v131, v131, v136
    v_mul_f32 v132, v132, v136
    v_mul_f32 v133, v133, v136
    v_mul_f32 v134, v134, v136
    v_mul_f32 v135, v135, v136
    v_cvt_pk_bf16_f32 v128, v128, v129
    v_cvt_pk_bf16_f32 v129, v130, v131
    v_cvt_pk_bf16_f32 v130, v132, v133
    v_cvt_pk_bf16_f32 v131, v134, v135
    v_and_b32 v129, v129, v11
    v_and_b32 v131, v131, v11
    ds_write_b128 v12, v[128:131] offset:8192
    v_add_f32 v148, s63, v148
    v_rcp_f32 v148, v148
    s_nop 0
    v_mul_f32 v140, v140, v148
    v_mul_f32 v141, v141, v148
    v_mul_f32 v142, v142, v148
    v_mul_f32 v143, v143, v148
    v_mul_f32 v144, v144, v148
    v_mul_f32 v145, v145, v148
    v_mul_f32 v146, v146, v148
    v_mul_f32 v147, v147, v148
    v_cvt_pk_bf16_f32 v140, v140, v141
    v_cvt_pk_bf16_f32 v141, v142, v143
    v_cvt_pk_bf16_f32 v142, v144, v145
    v_cvt_pk_bf16_f32 v143, v146, v147
    v_and_b32 v141, v141, v11
    v_and_b32 v143, v143, v11
    ds_write_b128 v12, v[140:143] offset:9216
    v_add_f32 v160, s63, v160
    v_rcp_f32 v160, v160
    s_nop 0
    v_mul_f32 v152, v152, v160
    v_mul_f32 v153, v153, v160
    v_mul_f32 v154, v154, v160
    v_mul_f32 v155, v155, v160
    v_mul_f32 v156, v156, v160
    v_mul_f32 v157, v157, v160
    v_mul_f32 v158, v158, v160
    v_mul_f32 v159, v159, v160
    v_cvt_pk_bf16_f32 v152, v152, v153
    v_cvt_pk_bf16_f32 v153, v154, v155
    v_cvt_pk_bf16_f32 v154, v156, v157
    v_cvt_pk_bf16_f32 v155, v158, v159
    v_and_b32 v153, v153, v11
    v_and_b32 v155, v155, v11
    ds_write_b128 v12, v[152:155] offset:10240
    v_add_f32 v172, s63, v172
    v_rcp_f32 v172, v172
    s_nop 0
    v_mul_f32 v164, v164, v172
    v_mul_f32 v165, v165, v172
    v_mul_f32 v166, v166, v172
    v_mul_f32 v167, v167, v172
    v_mul_f32 v168, v168, v172
    v_mul_f32 v169, v169, v172
    v_mul_f32 v170, v170, v172
    v_mul_f32 v171, v171, v172
    v_cvt_pk_bf16_f32 v164, v164, v165
    v_cvt_pk_bf16_f32 v165, v166, v167
    v_cvt_pk_bf16_f32 v166, v168, v169
    v_cvt_pk_bf16_f32 v167, v170, v171
    v_and_b32 v165, v165, v11
    v_and_b32 v167, v167, v11
    ds_write_b128 v12, v[164:167] offset:11264
    v_add_f32 v184, s63, v184
    v_rcp_f32 v184, v184
    s_nop 0
    v_mul_f32 v176, v176, v184
    v_mul_f32 v177, v177, v184
    v_mul_f32 v178, v178, v184
    v_mul_f32 v179, v179, v184
    v_mul_f32 v180, v180, v184
    v_mul_f32 v181, v181, v184
    v_mul_f32 v182, v182, v184
    v_mul_f32 v183, v183, v184
    v_cvt_pk_bf16_f32 v176, v176, v177
    v_cvt_pk_bf16_f32 v177, v178, v179
    v_cvt_pk_bf16_f32 v178, v180, v181
    v_cvt_pk_bf16_f32 v179, v182, v183
    v_and_b32 v177, v177, v11
    v_and_b32 v179, v179, v11
    ds_write_b128 v12, v[176:179] offset:12288
    v_add_f32 v196, s63, v196
    v_rcp_f32 v196, v196
    s_nop 0
    v_mul_f32 v188, v188, v196
    v_mul_f32 v189, v189, v196
    v_mul_f32 v190, v190, v196
    v_mul_f32 v191, v191, v196
    v_mul_f32 v192, v192, v196
    v_mul_f32 v193, v193, v196
    v_mul_f32 v194, v194, v196
    v_mul_f32 v195, v195, v196
    v_cvt_pk_bf16_f32 v188, v188, v189
    v_cvt_pk_bf16_f32 v189, v190, v191
    v_cvt_pk_bf16_f32 v190, v192, v193
    v_cvt_pk_bf16_f32 v191, v194, v195
    v_and_b32 v189, v189, v11
    v_and_b32 v191, v191, v11
    ds_write_b128 v12, v[188:191] offset:13312
    v_add_f32 v208, s63, v208
    v_rcp_f32 v208, v208
    s_nop 0
    v_mul_f32 v200, v200, v208
    v_mul_f32 v201, v201, v208
    v_mul_f32 v202, v202, v208
    v_mul_f32 v203, v203, v208
    v_mul_f32 v204, v204, v208
    v_mul_f32 v205, v205, v208
    v_mul_f32 v206, v206, v208
    v_mul_f32 v207, v207, v208
    v_cvt_pk_bf16_f32 v200, v200, v201
    v_cvt_pk_bf16_f32 v201, v202, v203
    v_cvt_pk_bf16_f32 v202, v204, v205
    v_cvt_pk_bf16_f32 v203, v206, v207
    v_and_b32 v201, v201, v11
    v_and_b32 v203, v203, v11
    ds_write_b128 v12, v[200:203] offset:14336
    v_add_f32 v220, s63, v220
    v_rcp_f32 v220, v220
    s_nop 0
    v_mul_f32 v212, v212, v220
    v_mul_f32 v213, v213, v220
    v_mul_f32 v214, v214, v220
    v_mul_f32 v215, v215, v220
    v_mul_f32 v216, v216, v220
    v_mul_f32 v217, v217, v220
    v_mul_f32 v218, v218, v220
    v_mul_f32 v219, v219, v220
    v_cvt_pk_bf16_f32 v212, v212, v213
    v_cvt_pk_bf16_f32 v213, v214, v215
    v_cvt_pk_bf16_f32 v214, v216, v217
    v_cvt_pk_bf16_f32 v215, v218, v219
    v_and_b32 v213, v213, v11
    v_and_b32 v215, v215, v11
    ds_write_b128 v12, v[212:215] offset:15360
    s_waitcnt lgkmcnt(0)
    v_mfma_f32_16x16x32_bf16 v[128:131], v[104:107], a[64:67], 0
    v_mfma_f32_16x16x32_bf16 v[132:135], v[108:111], a[64:67], 0
    v_mfma_f32_16x16x32_bf16 v[136:139], v[112:115], a[64:67], 0
    v_mfma_f32_16x16x32_bf16 v[140:143], v[104:107], a[68:71], 0
    v_mfma_f32_16x16x32_bf16 v[144:147], v[108:111], a[68:71], 0
    v_mfma_f32_16x16x32_bf16 v[148:151], v[112:115], a[68:71], 0
    v_mfma_f32_16x16x32_bf16 v[152:155], v[104:107], a[72:75], 0
    v_mfma_f32_16x16x32_bf16 v[156:159], v[108:111], a[72:75], 0
    v_mfma_f32_16x16x32_bf16 v[160:163], v[112:115], a[72:75], 0
    v_mfma_f32_16x16x32_bf16 v[164:167], v[104:107], a[76:79], 0
    v_mfma_f32_16x16x32_bf16 v[168:171], v[108:111], a[76:79], 0
    v_mfma_f32_16x16x32_bf16 v[172:175], v[112:115], a[76:79], 0
    v_mfma_f32_16x16x32_bf16 v[176:179], v[104:107], a[80:83], 0
    v_mfma_f32_16x16x32_bf16 v[180:183], v[108:111], a[80:83], 0
    v_mfma_f32_16x16x32_bf16 v[184:187], v[112:115], a[80:83], 0
    v_mfma_f32_16x16x32_bf16 v[188:191], v[104:107], a[84:87], 0
    v_mfma_f32_16x16x32_bf16 v[192:195], v[108:111], a[84:87], 0
    v_mfma_f32_16x16x32_bf16 v[196:199], v[112:115], a[84:87], 0
    v_mfma_f32_16x16x32_bf16 v[200:203], v[104:107], a[88:91], 0
    v_mfma_f32_16x16x32_bf16 v[204:207], v[108:111], a[88:91], 0
    v_mfma_f32_16x16x32_bf16 v[208:211], v[112:115], a[88:91], 0
    v_mfma_f32_16x16x32_bf16 v[212:215], v[104:107], a[92:95], 0
    v_mfma_f32_16x16x32_bf16 v[216:219], v[108:111], a[92:95], 0
    v_mfma_f32_16x16x32_bf16 v[220:223], v[112:115], a[92:95], 0
    s_nop 7
    v_add_f32 v136, s63, v136
    v_rcp_f32 v136, v136
    s_nop 0
    v_mul_f32 v128, v128, v136
    v_mul_f32 v129, v129, v136
    v_mul_f32 v130, v130, v136
    v_mul_f32 v131, v131, v136
    v_mul_f32 v132, v132, v136
    v_mul_f32 v133, v133, v136
    v_mul_f32 v134, v134, v136
    v_mul_f32 v135, v135, v136
    v_cvt_pk_bf16_f32 v128, v128, v129
    v_cvt_pk_bf16_f32 v129, v130, v131
    v_cvt_pk_bf16_f32 v130, v132, v133
    v_cvt_pk_bf16_f32 v131, v134, v135
    v_and_b32 v129, v129, v11
    v_and_b32 v131, v131, v11
    ds_write_b128 v12, v[128:131] offset:16384
    v_add_f32 v148, s63, v148
    v_rcp_f32 v148, v148
    s_nop 0
    v_mul_f32 v140, v140, v148
    v_mul_f32 v141, v141, v148
    v_mul_f32 v142, v142, v148
    v_mul_f32 v143, v143, v148
    v_mul_f32 v144, v144, v148
    v_mul_f32 v145, v145, v148
    v_mul_f32 v146, v146, v148
    v_mul_f32 v147, v147, v148
    v_cvt_pk_bf16_f32 v140, v140, v141
    v_cvt_pk_bf16_f32 v141, v142, v143
    v_cvt_pk_bf16_f32 v142, v144, v145
    v_cvt_pk_bf16_f32 v143, v146, v147
    v_and_b32 v141, v141, v11
    v_and_b32 v143, v143, v11
    ds_write_b128 v12, v[140:143] offset:17408
    v_add_f32 v160, s63, v160
    v_rcp_f32 v160, v160
    s_nop 0
    v_mul_f32 v152, v152, v160
    v_mul_f32 v153, v153, v160
    v_mul_f32 v154, v154, v160
    v_mul_f32 v155, v155, v160
    v_mul_f32 v156, v156, v160
    v_mul_f32 v157, v157, v160
    v_mul_f32 v158, v158, v160
    v_mul_f32 v159, v159, v160
    v_cvt_pk_bf16_f32 v152, v152, v153
    v_cvt_pk_bf16_f32 v153, v154, v155
    v_cvt_pk_bf16_f32 v154, v156, v157
    v_cvt_pk_bf16_f32 v155, v158, v159
    v_and_b32 v153, v153, v11
    v_and_b32 v155, v155, v11
    ds_write_b128 v12, v[152:155] offset:18432
    v_add_f32 v172, s63, v172
    v_rcp_f32 v172, v172
    s_nop 0
    v_mul_f32 v164, v164, v172
    v_mul_f32 v165, v165, v172
    v_mul_f32 v166, v166, v172
    v_mul_f32 v167, v167, v172
    v_mul_f32 v168, v168, v172
    v_mul_f32 v169, v169, v172
    v_mul_f32 v170, v170, v172
    v_mul_f32 v171, v171, v172
    v_cvt_pk_bf16_f32 v164, v164, v165
    v_cvt_pk_bf16_f32 v165, v166, v167
    v_cvt_pk_bf16_f32 v166, v168, v169
    v_cvt_pk_bf16_f32 v167, v170, v171
    v_and_b32 v165, v165, v11
    v_and_b32 v167, v167, v11
    ds_write_b128 v12, v[164:167] offset:19456
    v_add_f32 v184, s63, v184
    v_rcp_f32 v184, v184
    s_nop 0
    v_mul_f32 v176, v176, v184
    v_mul_f32 v177, v177, v184
    v_mul_f32 v178, v178, v184
    v_mul_f32 v179, v179, v184
    v_mul_f32 v180, v180, v184
    v_mul_f32 v181, v181, v184
    v_mul_f32 v182, v182, v184
    v_mul_f32 v183, v183, v184
    v_cvt_pk_bf16_f32 v176, v176, v177
    v_cvt_pk_bf16_f32 v177, v178, v179
    v_cvt_pk_bf16_f32 v178, v180, v181
    v_cvt_pk_bf16_f32 v179, v182, v183
    v_and_b32 v177, v177, v11
    v_and_b32 v179, v179, v11
    ds_write_b128 v12, v[176:179] offset:20480
    v_add_f32 v196, s63, v196
    v_rcp_f32 v196, v196
    s_nop 0
    v_mul_f32 v188, v188, v196
    v_mul_f32 v189, v189, v196
    v_mul_f32 v190, v190, v196
    v_mul_f32 v191, v191, v196
    v_mul_f32 v192, v192, v196
    v_mul_f32 v193, v193, v196
    v_mul_f32 v194, v194, v196
    v_mul_f32 v195, v195, v196
    v_cvt_pk_bf16_f32 v188, v188, v189
    v_cvt_pk_bf16_f32 v189, v190, v191
    v_cvt_pk_bf16_f32 v190, v192, v193
    v_cvt_pk_bf16_f32 v191, v194, v195
    v_and_b32 v189, v189, v11
    v_and_b32 v191, v191, v11
    ds_write_b128 v12, v[188:191] offset:21504
    v_add_f32 v208, s63, v208
    v_rcp_f32 v208, v208
    s_nop 0
    v_mul_f32 v200, v200, v208
    v_mul_f32 v201, v201, v208
    v_mul_f32 v202, v202, v208
    v_mul_f32 v203, v203, v208
    v_mul_f32 v204, v204, v208
    v_mul_f32 v205, v205, v208
    v_mul_f32 v206, v206, v208
    v_mul_f32 v207, v207, v208
    v_cvt_pk_bf16_f32 v200, v200, v201
    v_cvt_pk_bf16_f32 v201, v202, v203
    v_cvt_pk_bf16_f32 v202, v204, v205
    v_cvt_pk_bf16_f32 v203, v206, v207
    v_and_b32 v201, v201, v11
    v_and_b32 v203, v203, v11
    ds_write_b128 v12, v[200:203] offset:22528
    v_add_f32 v220, s63, v220
    v_rcp_f32 v220, v220
    s_nop 0
    v_mul_f32 v212, v212, v220
    v_mul_f32 v213, v213, v220
    v_mul_f32 v214, v214, v220
    v_mul_f32 v215, v215, v220
    v_mul_f32 v216, v216, v220
    v_mul_f32 v217, v217, v220
    v_mul_f32 v218, v218, v220
    v_mul_f32 v219, v219, v220
    v_cvt_pk_bf16_f32 v212, v212, v213
    v_cvt_pk_bf16_f32 v213, v214, v215
    v_cvt_pk_bf16_f32 v214, v216, v217
    v_cvt_pk_bf16_f32 v215, v218, v219
    v_and_b32 v213, v213, v11
    v_and_b32 v215, v215, v11
    ds_write_b128 v12, v[212:215] offset:23552
    s_waitcnt lgkmcnt(0)
    v_mfma_f32_16x16x32_bf16 v[128:131], v[116:119], a[96:99], 0
    v_mfma_f32_16x16x32_bf16 v[132:135], v[120:123], a[96:99], 0
    v_mfma_f32_16x16x32_bf16 v[136:139], v[124:127], a[96:99], 0
    v_mfma_f32_16x16x32_bf16 v[140:143], v[116:119], a[100:103], 0
    v_mfma_f32_16x16x32_bf16 v[144:147], v[120:123], a[100:103], 0
    v_mfma_f32_16x16x32_bf16 v[148:151], v[124:127], a[100:103], 0
    v_mfma_f32_16x16x32_bf16 v[152:155], v[116:119], a[104:107], 0
    v_mfma_f32_16x16x32_bf16 v[156:159], v[120:123], a[104:107], 0
    v_mfma_f32_16x16x32_bf16 v[160:163], v[124:127], a[104:107], 0
    v_mfma_f32_16x16x32_bf16 v[164:167], v[116:119], a[108:111], 0
    v_mfma_f32_16x16x32_bf16 v[168:171], v[120:123], a[108:111], 0
    v_mfma_f32_16x16x32_bf16 v[172:175], v[124:127], a[108:111], 0
    v_mfma_f32_16x16x32_bf16 v[176:179], v[116:119], a[112:115], 0
    v_mfma_f32_16x16x32_bf16 v[180:183], v[120:123], a[112:115], 0
    v_mfma_f32_16x16x32_bf16 v[184:187], v[124:127], a[112:115], 0
    v_mfma_f32_16x16x32_bf16 v[188:191], v[116:119], a[116:119], 0
    v_mfma_f32_16x16x32_bf16 v[192:195], v[120:123], a[116:119], 0
    v_mfma_f32_16x16x32_bf16 v[196:199], v[124:127], a[116:119], 0
    v_mfma_f32_16x16x32_bf16 v[200:203], v[116:119], a[120:123], 0
    v_mfma_f32_16x16x32_bf16 v[204:207], v[120:123], a[120:123], 0
    v_mfma_f32_16x16x32_bf16 v[208:211], v[124:127], a[120:123], 0
    v_mfma_f32_16x16x32_bf16 v[212:215], v[116:119], a[124:127], 0
    v_mfma_f32_16x16x32_bf16 v[216:219], v[120:123], a[124:127], 0
    v_mfma_f32_16x16x32_bf16 v[220:223], v[124:127], a[124:127], 0
    s_nop 7
    v_add_f32 v136, s63, v136
    v_rcp_f32 v136, v136
    s_nop 0
    v_mul_f32 v128, v128, v136
    v_mul_f32 v129, v129, v136
    v_mul_f32 v130, v130, v136
    v_mul_f32 v131, v131, v136
    v_mul_f32 v132, v132, v136
    v_mul_f32 v133, v133, v136
    v_mul_f32 v134, v134, v136
    v_mul_f32 v135, v135, v136
    v_cvt_pk_bf16_f32 v128, v128, v129
    v_cvt_pk_bf16_f32 v129, v130, v131
    v_cvt_pk_bf16_f32 v130, v132, v133
    v_cvt_pk_bf16_f32 v131, v134, v135
    v_and_b32 v129, v129, v11
    v_and_b32 v131, v131, v11
    ds_write_b128 v12, v[128:131] offset:24576
    v_add_f32 v148, s63, v148
    v_rcp_f32 v148, v148
    s_nop 0
    v_mul_f32 v140, v140, v148
    v_mul_f32 v141, v141, v148
    v_mul_f32 v142, v142, v148
    v_mul_f32 v143, v143, v148
    v_mul_f32 v144, v144, v148
    v_mul_f32 v145, v145, v148
    v_mul_f32 v146, v146, v148
    v_mul_f32 v147, v147, v148
    v_cvt_pk_bf16_f32 v140, v140, v141
    v_cvt_pk_bf16_f32 v141, v142, v143
    v_cvt_pk_bf16_f32 v142, v144, v145
    v_cvt_pk_bf16_f32 v143, v146, v147
    v_and_b32 v141, v141, v11
    v_and_b32 v143, v143, v11
    ds_write_b128 v12, v[140:143] offset:25600
    v_add_f32 v160, s63, v160
    v_rcp_f32 v160, v160
    s_nop 0
    v_mul_f32 v152, v152, v160
    v_mul_f32 v153, v153, v160
    v_mul_f32 v154, v154, v160
    v_mul_f32 v155, v155, v160
    v_mul_f32 v156, v156, v160
    v_mul_f32 v157, v157, v160
    v_mul_f32 v158, v158, v160
    v_mul_f32 v159, v159, v160
    v_cvt_pk_bf16_f32 v152, v152, v153
    v_cvt_pk_bf16_f32 v153, v154, v155
    v_cvt_pk_bf16_f32 v154, v156, v157
    v_cvt_pk_bf16_f32 v155, v158, v159
    v_and_b32 v153, v153, v11
    v_and_b32 v155, v155, v11
    ds_write_b128 v12, v[152:155] offset:26624
    v_add_f32 v172, s63, v172
    v_rcp_f32 v172, v172
    s_nop 0
    v_mul_f32 v164, v164, v172
    v_mul_f32 v165, v165, v172
    v_mul_f32 v166, v166, v172
    v_mul_f32 v167, v167, v172
    v_mul_f32 v168, v168, v172
    v_mul_f32 v169, v169, v172
    v_mul_f32 v170, v170, v172
    v_mul_f32 v171, v171, v172
    v_cvt_pk_bf16_f32 v164, v164, v165
    v_cvt_pk_bf16_f32 v165, v166, v167
    v_cvt_pk_bf16_f32 v166, v168, v169
    v_cvt_pk_bf16_f32 v167, v170, v171
    v_and_b32 v165, v165, v11
    v_and_b32 v167, v167, v11
    ds_write_b128 v12, v[164:167] offset:27648
    v_add_f32 v184, s63, v184
    v_rcp_f32 v184, v184
    s_nop 0
    v_mul_f32 v176, v176, v184
    v_mul_f32 v177, v177, v184
    v_mul_f32 v178, v178, v184
    v_mul_f32 v179, v179, v184
    v_mul_f32 v180, v180, v184
    v_mul_f32 v181, v181, v184
    v_mul_f32 v182, v182, v184
    v_mul_f32 v183, v183, v184
    v_cvt_pk_bf16_f32 v176, v176, v177
    v_cvt_pk_bf16_f32 v177, v178, v179
    v_cvt_pk_bf16_f32 v178, v180, v181
    v_cvt_pk_bf16_f32 v179, v182, v183
    v_and_b32 v177, v177, v11
    v_and_b32 v179, v179, v11
    ds_write_b128 v12, v[176:179] offset:28672
    v_add_f32 v196, s63, v196
    v_rcp_f32 v196, v196
    s_nop 0
    v_mul_f32 v188, v188, v196
    v_mul_f32 v189, v189, v196
    v_mul_f32 v190, v190, v196
    v_mul_f32 v191, v191, v196
    v_mul_f32 v192, v192, v196
    v_mul_f32 v193, v193, v196
    v_mul_f32 v194, v194, v196
    v_mul_f32 v195, v195, v196
    v_cvt_pk_bf16_f32 v188, v188, v189
    v_cvt_pk_bf16_f32 v189, v190, v191
    v_cvt_pk_bf16_f32 v190, v192, v193
    v_cvt_pk_bf16_f32 v191, v194, v195
    v_and_b32 v189, v189, v11
    v_and_b32 v191, v191, v11
    ds_write_b128 v12, v[188:191] offset:29696
    v_add_f32 v208, s63, v208
    v_rcp_f32 v208, v208
    s_nop 0
    v_mul_f32 v200, v200, v208
    v_mul_f32 v201, v201, v208
    v_mul_f32 v202, v202, v208
    v_mul_f32 v203, v203, v208
    v_mul_f32 v204, v204, v208
    v_mul_f32 v205, v205, v208
    v_mul_f32 v206, v206, v208
    v_mul_f32 v207, v207, v208
    v_cvt_pk_bf16_f32 v200, v200, v201
    v_cvt_pk_bf16_f32 v201, v202, v203
    v_cvt_pk_bf16_f32 v202, v204, v205
    v_cvt_pk_bf16_f32 v203, v206, v207
    v_and_b32 v201, v201, v11
    v_and_b32 v203, v203, v11
    ds_write_b128 v12, v[200:203] offset:30720
    v_add_f32 v220, s63, v220
    v_rcp_f32 v220, v220
    s_nop 0
    v_mul_f32 v212, v212, v220
    v_mul_f32 v213, v213, v220
    v_mul_f32 v214, v214, v220
    v_mul_f32 v215, v215, v220
    v_mul_f32 v216, v216, v220
    v_mul_f32 v217, v217, v220
    v_mul_f32 v218, v218, v220
    v_mul_f32 v219, v219, v220
    v_cvt_pk_bf16_f32 v212, v212, v213
    v_cvt_pk_bf16_f32 v213, v214, v215
    v_cvt_pk_bf16_f32 v214, v216, v217
    v_cvt_pk_bf16_f32 v215, v218, v219
    v_and_b32 v213, v213, v11
    v_and_b32 v215, v215, v11
    ds_write_b128 v12, v[212:215] offset:31744
    s_waitcnt lgkmcnt(0)
    s_barrier
    v_bfe_u32 v1, v0, 4, 2
    v_mul_u32_u24 v10, 7168, v1
    v_bfe_u32 v1, v0, 0, 4
    v_lshl_add_u32 v10, v1, 2, v10
    v_add_u32 v11, 3584, v10
    v_bfe_u32 v1, v0, 0, 4
    v_mul_u32_u24 v12, 1792, v1
    v_bfe_u32 v1, v0, 4, 2
    v_lshl_add_u32 v12, v1, 4, v12
    s_mov_b32 s31, s8
.b_p3_111:
    s_lshl_b32 s44, s31, 7
    buffer_load_dword v80, v10, s[36:39], s44 offen
    buffer_load_dword v81, v10, s[36:39], s44 offen offset:896
    buffer_load_dword v82, v10, s[36:39], s44 offen offset:1792
    buffer_load_dword v83, v10, s[36:39], s44 offen offset:2688
    buffer_load_dword v84, v11, s[36:39], s44 offen
    buffer_load_dword v85, v11, s[36:39], s44 offen offset:896
    buffer_load_dword v86, v11, s[36:39], s44 offen offset:1792
    buffer_load_dword v87, v11, s[36:39], s44 offen offset:2688
    buffer_load_dword v88, v10, s[36:39], s44 offen offset:64
    buffer_load_dword v89, v10, s[36:39], s44 offen offset:960
    buffer_load_dword v90, v10, s[36:39], s44 offen offset:1856
    buffer_load_dword v91, v10, s[36:39], s44 offen offset:2752
    buffer_load_dword v92, v11, s[36:39], s44 offen offset:64
    buffer_load_dword v93, v11, s[36:39], s44 offen offset:960
    buffer_load_dword v94, v11, s[36:39], s44 offen offset:1856
    buffer_load_dword v95, v11, s[36:39], s44 offen offset:2752
    s_add_u32 s44, s44, 25088
    v_mov_b32 v14, v9
    ds_read_b128 v[16:19], v14
    ds_read_b128 v[20:23], v14 offset:1024
    ds_read_b128 v[24:27], v14 offset:2048
    ds_read_b128 v[28:31], v14 offset:3072
    ds_read_b128 v[32:35], v14 offset:4096
    ds_read_b128 v[36:39], v14 offset:5120
    ds_read_b128 v[40:43], v14 offset:6144
    ds_read_b128 v[44:47], v14 offset:7168
    v_add_u32 v14, 0x2000, v14
    v_mov_b32 v128, 0
    v_mov_b32 v129, 0
    v_mov_b32 v130, 0
    v_mov_b32 v131, 0
    v_mov_b32 v132, 0
    v_mov_b32 v133, 0
    v_mov_b32 v134, 0
    v_mov_b32 v135, 0
    v_mov_b32 v136, 0
    v_mov_b32 v137, 0
    v_mov_b32 v138, 0
    v_mov_b32 v139, 0
    v_mov_b32 v140, 0
    v_mov_b32 v141, 0
    v_mov_b32 v142, 0
    v_mov_b32 v143, 0
    v_mov_b32 v144, 0
    v_mov_b32 v145, 0
    v_mov_b32 v146, 0
    v_mov_b32 v147, 0
    v_mov_b32 v148, 0
    v_mov_b32 v149, 0
    v_mov_b32 v150, 0
    v_mov_b32 v151, 0
    v_mov_b32 v152, 0
    v_mov_b32 v153, 0
    v_mov_b32 v154, 0
    v_mov_b32 v155, 0
    v_mov_b32 v156, 0
    v_mov_b32 v157, 0
    v_mov_b32 v158, 0
    v_mov_b32 v159, 0
    v_mov_b32 v160, 0
    v_mov_b32 v161, 0
    v_mov_b32 v162, 0
    v_mov_b32 v163, 0
    v_mov_b32 v164, 0
    v_mov_b32 v165, 0
    v_mov_b32 v166, 0
    v_mov_b32 v167, 0
    v_mov_b32 v168, 0
    v_mov_b32 v169, 0
    v_mov_b32 v170, 0
    v_mov_b32 v171, 0
    v_mov_b32 v172, 0
    v_mov_b32 v173, 0
    v_mov_b32 v174, 0
    v_mov_b32 v175, 0
    v_mov_b32 v176, 0
    v_mov_b32 v177, 0
    v_mov_b32 v178, 0
    v_mov_b32 v179, 0
    v_mov_b32 v180, 0
    v_mov_b32 v181, 0
    v_mov_b32 v182, 0
    v_mov_b32 v183, 0
    v_mov_b32 v184, 0
    v_mov_b32 v185, 0
    v_mov_b32 v186, 0
    v_mov_b32 v187, 0
    v_mov_b32 v188, 0
    v_mov_b32 v189, 0
    v_mov_b32 v190, 0
    v_mov_b32 v191, 0
    v_mov_b32 v192, 0
    v_mov_b32 v193, 0
    v_mov_b32 v194, 0
    v_mov_b32 v195, 0
    v_mov_b32 v196, 0
    v_mov_b32 v197, 0
    v_mov_b32 v198, 0
    v_mov_b32 v199, 0
    v_mov_b32 v200, 0
    v_mov_b32 v201, 0
    v_mov_b32 v202, 0
    v_mov_b32 v203, 0
    v_mov_b32 v204, 0
    v_mov_b32 v205, 0
    v_mov_b32 v206, 0
    v_mov_b32 v207, 0
    v_mov_b32 v208, 0
    v_mov_b32 v209, 0
    v_mov_b32 v210, 0
    v_mov_b32 v211, 0
    v_mov_b32 v212, 0
    v_mov_b32 v213, 0
    v_mov_b32 v214, 0
    v_mov_b32 v215, 0
    v_mov_b32 v216, 0
    v_mov_b32 v217, 0
    v_mov_b32 v218, 0
    v_mov_b32 v219, 0
    v_mov_b32 v220, 0
    v_mov_b32 v221, 0
    v_mov_b32 v222, 0
    v_mov_b32 v223, 0
    v_mov_b32 v224, 0
    v_mov_b32 v225, 0
    v_mov_b32 v226, 0
    v_mov_b32 v227, 0
    v_mov_b32 v228, 0
    v_mov_b32 v229, 0
    v_mov_b32 v230, 0
    v_mov_b32 v231, 0
    v_mov_b32 v232, 0
    v_mov_b32 v233, 0
    v_mov_b32 v234, 0
    v_mov_b32 v235, 0
    v_mov_b32 v236, 0
    v_mov_b32 v237, 0
    v_mov_b32 v238, 0
    v_mov_b32 v239, 0
    v_mov_b32 v240, 0
    v_mov_b32 v241, 0
    v_mov_b32 v242, 0
    v_mov_b32 v243, 0
    v_mov_b32 v244, 0
    v_mov_b32 v245, 0
    v_mov_b32 v246, 0
    v_mov_b32 v247, 0
    v_mov_b32 v248, 0
    v_mov_b32 v249, 0
    v_mov_b32 v250, 0
    v_mov_b32 v251, 0
    v_mov_b32 v252, 0
    v_mov_b32 v253, 0
    v_mov_b32 v254, 0
    v_mov_b32 v255, 0
    s_mov_b32 s45, 8
.bg_112:
    buffer_load_dword v96, v10, s[36:39], s44 offen
    buffer_load_dword v97, v10, s[36:39], s44 offen offset:896
    buffer_load_dword v98, v10, s[36:39], s44 offen offset:1792
    buffer_load_dword v99, v10, s[36:39], s44 offen offset:2688
    buffer_load_dword v100, v11, s[36:39], s44 offen
    buffer_load_dword v101, v11, s[36:39], s44 offen offset:896
    buffer_load_dword v102, v11, s[36:39], s44 offen offset:1792
    buffer_load_dword v103, v11, s[36:39], s44 offen offset:2688
    buffer_load_dword v104, v10, s[36:39], s44 offen offset:64
    buffer_load_dword v105, v10, s[36:39], s44 offen offset:960
    buffer_load_dword v106, v10, s[36:39], s44 offen offset:1856
    buffer_load_dword v107, v10, s[36:39], s44 offen offset:2752
    buffer_load_dword v108, v11, s[36:39], s44 offen offset:64
    buffer_load_dword v109, v11, s[36:39], s44 offen offset:960
    buffer_load_dword v110, v11, s[36:39], s44 offen offset:1856
    buffer_load_dword v111, v11, s[36:39], s44 offen offset:2752
    s_add_u32 s44, s44, 25088
    s_waitcnt vmcnt(16)
    v_perm_b32 v112, v82, v80, s60
    v_perm_b32 v113, v86, v84, s60
    v_perm_b32 v114, v83, v81, s60
    v_perm_b32 v115, v87, v85, s60
    v_perm_b32 v116, v82, v80, s61
    v_perm_b32 v117, v86, v84, s61
    v_perm_b32 v118, v83, v81, s61
    v_perm_b32 v119, v87, v85, s61
    v_perm_b32 v120, v90, v88, s60
    v_perm_b32 v121, v94, v92, s60
    v_perm_b32 v122, v91, v89, s60
    v_perm_b32 v123, v95, v93, s60
    v_perm_b32 v124, v90, v88, s61
    v_perm_b32 v125, v94, v92, s61
    v_perm_b32 v126, v91, v89, s61
    v_perm_b32 v127, v95, v93, s61
    s_waitcnt lgkmcnt(0)
    ds_read_b128 v[48:51], v14
    ds_read_b128 v[52:55], v14 offset:1024
    ds_read_b128 v[56:59], v14 offset:2048
    ds_read_b128 v[60:63], v14 offset:3072
    ds_read_b128 v[64:67], v14 offset:4096
    ds_read_b128 v[68:71], v14 offset:5120
    ds_read_b128 v[72:75], v14 offset:6144
    ds_read_b128 v[76:79], v14 offset:7168
    v_add_u32 v14, 0x2000, v14
    v_mfma_f32_16x16x32_bf16 v[128:131], v[112:115], v[16:19], v[128:131]
    v_mfma_f32_16x16x32_bf16 v[160:163], v[116:119], v[16:19], v[160:163]
    v_mfma_f32_16x16x32_bf16 v[192:195], v[120:123], v[16:19], v[192:195]
    v_mfma_f32_16x16x32_bf16 v[224:227], v[124:127], v[16:19], v[224:227]
    v_mfma_f32_16x16x32_bf16 v[132:135], v[112:115], v[20:23], v[132:135]
    v_mfma_f32_16x16x32_bf16 v[164:167], v[116:119], v[20:23], v[164:167]
    v_mfma_f32_16x16x32_bf16 v[196:199], v[120:123], v[20:23], v[196:199]
    v_mfma_f32_16x16x32_bf16 v[228:231], v[124:127], v[20:23], v[228:231]
    v_mfma_f32_16x16x32_bf16 v[136:139], v[112:115], v[24:27], v[136:139]
    v_mfma_f32_16x16x32_bf16 v[168:171], v[116:119], v[24:27], v[168:171]
    v_mfma_f32_16x16x32_bf16 v[200:203], v[120:123], v[24:27], v[200:203]
    v_mfma_f32_16x16x32_bf16 v[232:235], v[124:127], v[24:27], v[232:235]
    v_mfma_f32_16x16x32_bf16 v[140:143], v[112:115], v[28:31], v[140:143]
    v_mfma_f32_16x16x32_bf16 v[172:175], v[116:119], v[28:31], v[172:175]
    v_mfma_f32_16x16x32_bf16 v[204:207], v[120:123], v[28:31], v[204:207]
    v_mfma_f32_16x16x32_bf16 v[236:239], v[124:127], v[28:31], v[236:239]
    v_mfma_f32_16x16x32_bf16 v[144:147], v[112:115], v[32:35], v[144:147]
    v_mfma_f32_16x16x32_bf16 v[176:179], v[116:119], v[32:35], v[176:179]
    v_mfma_f32_16x16x32_bf16 v[208:211], v[120:123], v[32:35], v[208:211]
    v_mfma_f32_16x16x32_bf16 v[240:243], v[124:127], v[32:35], v[240:243]
    v_mfma_f32_16x16x32_bf16 v[148:151], v[112:115], v[36:39], v[148:151]
    v_mfma_f32_16x16x32_bf16 v[180:183], v[116:119], v[36:39], v[180:183]
    v_mfma_f32_16x16x32_bf16 v[212:215], v[120:123], v[36:39], v[212:215]
    v_mfma_f32_16x16x32_bf16 v[244:247], v[124:127], v[36:39], v[244:247]
    v_mfma_f32_16x16x32_bf16 v[152:155], v[112:115], v[40:43], v[152:155]
    v_mfma_f32_16x16x32_bf16 v[184:187], v[116:119], v[40:43], v[184:187]
    v_mfma_f32_16x16x32_bf16 v[216:219], v[120:123], v[40:43], v[216:219]
    v_mfma_f32_16x16x32_bf16 v[248:251], v[124:127], v[40:43], v[248:251]
    v_mfma_f32_16x16x32_bf16 v[156:159], v[112:115], v[44:47], v[156:159]
    v_mfma_f32_16x16x32_bf16 v[188:191], v[116:119], v[44:47], v[188:191]
    v_mfma_f32_16x16x32_bf16 v[220:223], v[120:123], v[44:47], v[220:223]
    v_mfma_f32_16x16x32_bf16 v[252:255], v[124:127], v[44:47], v[252:255]
    buffer_load_dword v80, v10, s[36:39], s44 offen
    buffer_load_dword v81, v10, s[36:39], s44 offen offset:896
    buffer_load_dword v82, v10, s[36:39], s44 offen offset:1792
    buffer_load_dword v83, v10, s[36:39], s44 offen offset:2688
    buffer_load_dword v84, v11, s[36:39], s44 offen
    buffer_load_dword v85, v11, s[36:39], s44 offen offset:896
    buffer_load_dword v86, v11, s[36:39], s44 offen offset:1792
    buffer_load_dword v87, v11, s[36:39], s44 offen offset:2688
    buffer_load_dword v88, v10, s[36:39], s44 offen offset:64
    buffer_load_dword v89, v10, s[36:39], s44 offen offset:960
    buffer_load_dword v90, v10, s[36:39], s44 offen offset:1856
    buffer_load_dword v91, v10, s[36:39], s44 offen offset:2752
    buffer_load_dword v92, v11, s[36:39], s44 offen offset:64
    buffer_load_dword v93, v11, s[36:39], s44 offen offset:960
    buffer_load_dword v94, v11, s[36:39], s44 offen offset:1856
    buffer_load_dword v95, v11, s[36:39], s44 offen offset:2752
    s_add_u32 s44, s44, 25088
    s_waitcnt vmcnt(16)
    v_perm_b32 v112, v98, v96, s60
    v_perm_b32 v113, v102, v100, s60
    v_perm_b32 v114, v99, v97, s60
    v_perm_b32 v115, v103, v101, s60
    v_perm_b32 v116, v98, v96, s61
    v_perm_b32 v117, v102, v100, s61
    v_perm_b32 v118, v99, v97, s61
    v_perm_b32 v119, v103, v101, s61
    v_perm_b32 v120, v106, v104, s60
    v_perm_b32 v121, v110, v108, s60
    v_perm_b32 v122, v107, v105, s60
    v_perm_b32 v123, v111, v109, s60
    v_perm_b32 v124, v106, v104, s61
    v_perm_b32 v125, v110, v108, s61
    v_perm_b32 v126, v107, v105, s61
    v_perm_b32 v127, v111, v109, s61
    s_waitcnt lgkmcnt(0)
    ds_read_b128 v[16:19], v14
    ds_read_b128 v[20:23], v14 offset:1024
    ds_read_b128 v[24:27], v14 offset:2048
    ds_read_b128 v[28:31], v14 offset:3072
    ds_read_b128 v[32:35], v14 offset:4096
    ds_read_b128 v[36:39], v14 offset:5120
    ds_read_b128 v[40:43], v14 offset:6144
    ds_read_b128 v[44:47], v14 offset:7168
    v_add_u32 v14, 0x2000, v14
    v_mfma_f32_16x16x32_bf16 v[128:131], v[112:115], v[48:51], v[128:131]
    v_mfma_f32_16x16x32_bf16 v[160:163], v[116:119], v[48:51], v[160:163]
    v_mfma_f32_16x16x32_bf16 v[192:195], v[120:123], v[48:51], v[192:195]
    v_mfma_f32_16x16x32_bf16 v[224:227], v[124:127], v[48:51], v[224:227]
    v_mfma_f32_16x16x32_bf16 v[132:135], v[112:115], v[52:55], v[132:135]
    v_mfma_f32_16x16x32_bf16 v[164:167], v[116:119], v[52:55], v[164:167]
    v_mfma_f32_16x16x32_bf16 v[196:199], v[120:123], v[52:55], v[196:199]
    v_mfma_f32_16x16x32_bf16 v[228:231], v[124:127], v[52:55], v[228:231]
    v_mfma_f32_16x16x32_bf16 v[136:139], v[112:115], v[56:59], v[136:139]
    v_mfma_f32_16x16x32_bf16 v[168:171], v[116:119], v[56:59], v[168:171]
    v_mfma_f32_16x16x32_bf16 v[200:203], v[120:123], v[56:59], v[200:203]
    v_mfma_f32_16x16x32_bf16 v[232:235], v[124:127], v[56:59], v[232:235]
    v_mfma_f32_16x16x32_bf16 v[140:143], v[112:115], v[60:63], v[140:143]
    v_mfma_f32_16x16x32_bf16 v[172:175], v[116:119], v[60:63], v[172:175]
    v_mfma_f32_16x16x32_bf16 v[204:207], v[120:123], v[60:63], v[204:207]
    v_mfma_f32_16x16x32_bf16 v[236:239], v[124:127], v[60:63], v[236:239]
    v_mfma_f32_16x16x32_bf16 v[144:147], v[112:115], v[64:67], v[144:147]
    v_mfma_f32_16x16x32_bf16 v[176:179], v[116:119], v[64:67], v[176:179]
    v_mfma_f32_16x16x32_bf16 v[208:211], v[120:123], v[64:67], v[208:211]
    v_mfma_f32_16x16x32_bf16 v[240:243], v[124:127], v[64:67], v[240:243]
    v_mfma_f32_16x16x32_bf16 v[148:151], v[112:115], v[68:71], v[148:151]
    v_mfma_f32_16x16x32_bf16 v[180:183], v[116:119], v[68:71], v[180:183]
    v_mfma_f32_16x16x32_bf16 v[212:215], v[120:123], v[68:71], v[212:215]
    v_mfma_f32_16x16x32_bf16 v[244:247], v[124:127], v[68:71], v[244:247]
    v_mfma_f32_16x16x32_bf16 v[152:155], v[112:115], v[72:75], v[152:155]
    v_mfma_f32_16x16x32_bf16 v[184:187], v[116:119], v[72:75], v[184:187]
    v_mfma_f32_16x16x32_bf16 v[216:219], v[120:123], v[72:75], v[216:219]
    v_mfma_f32_16x16x32_bf16 v[248:251], v[124:127], v[72:75], v[248:251]
    v_mfma_f32_16x16x32_bf16 v[156:159], v[112:115], v[76:79], v[156:159]
    v_mfma_f32_16x16x32_bf16 v[188:191], v[116:119], v[76:79], v[188:191]
    v_mfma_f32_16x16x32_bf16 v[220:223], v[120:123], v[76:79], v[220:223]
    v_mfma_f32_16x16x32_bf16 v[252:255], v[124:127], v[76:79], v[252:255]
    s_sub_u32 s45, s45, 1
    s_cmp_lg_u32 s45, 0
    s_cbranch_scc1 .bg_112
    s_waitcnt vmcnt(0) lgkmcnt(0)
    s_nop 7
    s_mul_i32 s22, s30, 229376
    s_lshl_b32 s23, s31, 7
    s_add_u32 s22, s22, s23
    s_add_u32 s22, s22, 896
    v_cvt_pk_bf16_f32 v16, v128, v160
    v_cvt_pk_bf16_f32 v17, v129, v161
    v_cvt_pk_bf16_f32 v18, v130, v162
    v_cvt_pk_bf16_f32 v19, v131, v163
    buffer_store_dwordx4 v[16:19], v12, s[40:43], s22 offen sc1
    v_cvt_pk_bf16_f32 v20, v192, v224
    v_cvt_pk_bf16_f32 v21, v193, v225
    v_cvt_pk_bf16_f32 v22, v194, v226
    v_cvt_pk_bf16_f32 v23, v195, v227
    buffer_store_dwordx4 v[20:23], v12, s[40:43], s22 offen offset:64 sc1
    s_add_u32 s22, s22, 28672
    v_cvt_pk_bf16_f32 v24, v132, v164
    v_cvt_pk_bf16_f32 v25, v133, v165
    v_cvt_pk_bf16_f32 v26, v134, v166
    v_cvt_pk_bf16_f32 v27, v135, v167
    buffer_store_dwordx4 v[24:27], v12, s[40:43], s22 offen sc1
    v_cvt_pk_bf16_f32 v28, v196, v228
    v_cvt_pk_bf16_f32 v29, v197, v229
    v_cvt_pk_bf16_f32 v30, v198, v230
    v_cvt_pk_bf16_f32 v31, v199, v231
    buffer_store_dwordx4 v[28:31], v12, s[40:43], s22 offen offset:64 sc1
    s_add_u32 s22, s22, 28672
    v_cvt_pk_bf16_f32 v32, v136, v168
    v_cvt_pk_bf16_f32 v33, v137, v169
    v_cvt_pk_bf16_f32 v34, v138, v170
    v_cvt_pk_bf16_f32 v35, v139, v171
    buffer_store_dwordx4 v[32:35], v12, s[40:43], s22 offen sc1
    v_cvt_pk_bf16_f32 v36, v200, v232
    v_cvt_pk_bf16_f32 v37, v201, v233
    v_cvt_pk_bf16_f32 v38, v202, v234
    v_cvt_pk_bf16_f32 v39, v203, v235
    buffer_store_dwordx4 v[36:39], v12, s[40:43], s22 offen offset:64 sc1
    s_add_u32 s22, s22, 28672
    v_cvt_pk_bf16_f32 v40, v140, v172
    v_cvt_pk_bf16_f32 v41, v141, v173
    v_cvt_pk_bf16_f32 v42, v142, v174
    v_cvt_pk_bf16_f32 v43, v143, v175
    buffer_store_dwordx4 v[40:43], v12, s[40:43], s22 offen sc1
    v_cvt_pk_bf16_f32 v44, v204, v236
    v_cvt_pk_bf16_f32 v45, v205, v237
    v_cvt_pk_bf16_f32 v46, v206, v238
    v_cvt_pk_bf16_f32 v47, v207, v239
    buffer_store_dwordx4 v[44:47], v12, s[40:43], s22 offen offset:64 sc1
    s_add_u32 s22, s22, 28672
    v_cvt_pk_bf16_f32 v48, v144, v176
    v_cvt_pk_bf16_f32 v49, v145, v177
    v_cvt_pk_bf16_f32 v50, v146, v178
    v_cvt_pk_bf16_f32 v51, v147, v179
    buffer_store_dwordx4 v[48:51], v12, s[40:43], s22 offen sc1
    v_cvt_pk_bf16_f32 v52, v208, v240
    v_cvt_pk_bf16_f32 v53, v209, v241
    v_cvt_pk_bf16_f32 v54, v210, v242
    v_cvt_pk_bf16_f32 v55, v211, v243
    buffer_store_dwordx4 v[52:55], v12, s[40:43], s22 offen offset:64 sc1
    s_add_u32 s22, s22, 28672
    v_cvt_pk_bf16_f32 v56, v148, v180
    v_cvt_pk_bf16_f32 v57, v149, v181
    v_cvt_pk_bf16_f32 v58, v150, v182
    v_cvt_pk_bf16_f32 v59, v151, v183
    buffer_store_dwordx4 v[56:59], v12, s[40:43], s22 offen sc1
    v_cvt_pk_bf16_f32 v60, v212, v244
    v_cvt_pk_bf16_f32 v61, v213, v245
    v_cvt_pk_bf16_f32 v62, v214, v246
    v_cvt_pk_bf16_f32 v63, v215, v247
    buffer_store_dwordx4 v[60:63], v12, s[40:43], s22 offen offset:64 sc1
    s_add_u32 s22, s22, 28672
    v_cvt_pk_bf16_f32 v64, v152, v184
    v_cvt_pk_bf16_f32 v65, v153, v185
    v_cvt_pk_bf16_f32 v66, v154, v186
    v_cvt_pk_bf16_f32 v67, v155, v187
    buffer_store_dwordx4 v[64:67], v12, s[40:43], s22 offen sc1
    v_cvt_pk_bf16_f32 v68, v216, v248
    v_cvt_pk_bf16_f32 v69, v217, v249
    v_cvt_pk_bf16_f32 v70, v218, v250
    v_cvt_pk_bf16_f32 v71, v219, v251
    buffer_store_dwordx4 v[68:71], v12, s[40:43], s22 offen offset:64 sc1
    s_add_u32 s22, s22, 28672
    v_cvt_pk_bf16_f32 v72, v156, v188
    v_cvt_pk_bf16_f32 v73, v157, v189
    v_cvt_pk_bf16_f32 v74, v158, v190
    v_cvt_pk_bf16_f32 v75, v159, v191
    buffer_store_dwordx4 v[72:75], v12, s[40:43], s22 offen sc1
    v_cvt_pk_bf16_f32 v76, v220, v252
    v_cvt_pk_bf16_f32 v77, v221, v253
    v_cvt_pk_bf16_f32 v78, v222, v254
    v_cvt_pk_bf16_f32 v79, v223, v255
    buffer_store_dwordx4 v[76:79], v12, s[40:43], s22 offen offset:64 sc1
    s_add_u32 s22, s22, 28672
    s_add_u32 s31, s31, 4
    s_cmp_lt_u32 s31, 7
    s_waitcnt vmcnt(0)
    s_cbranch_scc1 .b_p3_111
    s_endpgm
.section .rodata,"a"
.p2align 6
.amdhsa_kernel concat_heads__memory_aug_recurrent_mem_tr__linear_attn_block__prompt_kernel
  .amdhsa_next_free_vgpr 512
  .amdhsa_next_free_sgpr 102
  .amdhsa_accum_offset 256
  .amdhsa_group_segment_fixed_size 0
  .amdhsa_kernarg_size 104
  .amdhsa_user_sgpr_count 2
  .amdhsa_user_sgpr_kernarg_segment_ptr 1
  .amdhsa_system_sgpr_workgroup_id_x 1
.end_amdhsa_kernel
```
